```python
import torch

def _softmax(x, axis=-1):
    return torch.softmax(x, dim=axis)
def _gelu(x):
    return torch.nn.functional.gelu(x, approximate="tanh")
def _silu(x):
    return torch.nn.functional.silu(x)
def _sigmoid(x):
    return torch.sigmoid(x)
def _layernorm(x, axis=-1, eps=1e-5):
    m = x.mean(dim=axis, keepdim=True)
    v = x.var(dim=axis, keepdim=True, unbiased=False)
    return (x - m) / torch.sqrt(v + eps)
def _scatter_add(tgt, idx, src, axis=0):
    return tgt.clone().index_add_(axis, idx, src)
def _segment_sum(src, seg, n):
    out = torch.zeros((n,) + src.shape[1:], dtype=src.dtype)
    return out.index_add_(0, seg, src)
def _pad(x, pw):
    flat = tuple(v for pair in reversed(pw) for v in pair)
    return torch.nn.functional.pad(x, flat)

kernel_name = 'concat_heads__mha_block_cached__gqa_block_cached__near_ridge'

def setup_inputs():

    _w = (lambda a: (lambda t: t.to(torch.bfloat16) if t.is_floating_point() else t)(torch.as_tensor(a)))
    def _A_setup():
        B, Sq, D = 8, 224, 448
        H, Sk, Dh = 16, 512, 256
        return {
            "x": _w((lambda *s: torch.randn(*s, dtype=torch.bfloat16) * 0.8)(B, Sq, D)),
            "k_cache": _w((lambda *s: torch.randn(*s, dtype=torch.bfloat16) * 0.8)(B, H, Sk, Dh)),
            "v_cache": _w((lambda *s: torch.randn(*s, dtype=torch.bfloat16) * 0.05)(B, H, Sk, Dh)),
            "wq": _w((lambda *s: torch.randn(*s, dtype=torch.bfloat16) * 0.8)(D, H * Dh) * (D ** -0.5)),
            "wo": _w((lambda *s: torch.randn(*s, dtype=torch.bfloat16) * 0.05)(H * Dh, D) * ((H * Dh) ** -0.5)),
        }
    _A_in = _A_setup()

    def _B_setup():
        B, Sq, D = 8, 224, 448
        Hq, Hkv, Sk, Dh = 16, 16, 512, 256
        assert Hq % Hkv == 0, (Hq, Hkv)
        return {
            "x": _w((lambda *s: torch.randn(*s, dtype=torch.bfloat16) * 0.8)(B, Sq, D)),
            "k_cache": _w((lambda *s: torch.randn(*s, dtype=torch.bfloat16) * 0.8)(B, Hkv, Sk, Dh)),
            "v_cache": _w((lambda *s: torch.randn(*s, dtype=torch.bfloat16) * 0.05)(B, Hkv, Sk, Dh)),
            "wq": _w((lambda *s: torch.randn(*s, dtype=torch.bfloat16) * 0.8)(D, Hq * Dh) * (D ** -0.5)),
            "wo": _w((lambda *s: torch.randn(*s, dtype=torch.bfloat16) * 0.05)(Hq * Dh, D) * ((Hq * Dh) ** -0.5)),
        }
    _B_in = _B_setup()

    return {
        "A_x": _A_in["x"],
        "A_k_cache": _A_in["k_cache"],
        "A_v_cache": _A_in["v_cache"],
        "A_wq": _A_in["wq"],
        "A_wo": _A_in["wo"],
        "B_x": _B_in["x"],
        "B_k_cache": _B_in["k_cache"],
        "B_v_cache": _B_in["v_cache"],
        "B_wq": _B_in["wq"],
        "B_wo": _B_in["wo"],
    }

def reference(A_x, A_k_cache, A_v_cache, A_wq, A_wo, B_x, B_k_cache, B_v_cache, B_wq, B_wo):
    def _A_ref(x, k_cache, v_cache, wq, wo):
        B, Sq, D = x.shape
        H, Dh = 16, 256
        q = (lambda x, *d: x.permute(*d))((x @ wq).reshape(B, Sq, H, Dh), 0, 2, 1, 3)
        scores = torch.einsum("bhqd,bhkd->bhqk", q, k_cache) * (Dh ** -0.5)
        p = _softmax(scores, axis=-1)
        o = torch.einsum("bhqk,bhkd->bhqd", p, v_cache)
        return (lambda x, *d: x.permute(*d))(o, 0, 2, 1, 3).reshape(B, Sq, H * Dh) @ wo

    def _B_ref(x, k_cache, v_cache, wq, wo):
        B, Sq, D = x.shape
        Hq, Dh = 16, 256
        Hkv = k_cache.shape[1]
        rep = Hq // Hkv
        q = (lambda x, *d: x.permute(*d))((x @ wq).reshape(B, Sq, Hq, Dh), 0, 2, 1, 3)
        k = (lambda x, n, axis: torch.repeat_interleave(x, n, dim=axis))(k_cache, rep, axis=1)
        v = (lambda x, n, axis: torch.repeat_interleave(x, n, dim=axis))(v_cache, rep, axis=1)
        scores = torch.einsum("bhqd,bhkd->bhqk", q, k) * (Dh ** -0.5)
        p = _softmax(scores, axis=-1)
        o = torch.einsum("bhqk,bhkd->bhqd", p, v)
        return (lambda x, *d: x.permute(*d))(o, 0, 2, 1, 3).reshape(B, Sq, Hq * Dh) @ wo

    a = _A_ref(A_x, A_k_cache, A_v_cache, A_wq, A_wo)
    b = _B_ref(B_x, B_k_cache, B_v_cache, B_wq, B_wo)
    return torch.concatenate([a, b], axis=-1)
```

```asm
; @launch grid=(256,1,1) block=(512,1,1) lds=163840
.amdgcn_target "amdgcn-amd-amdhsa--gfx950"
.text
.globl concat_heads__mha_block_cached__gqa_block_cached__near_ridge_kernel
.p2align 8
.type concat_heads__mha_block_cached__gqa_block_cached__near_ridge_kernel,@function
concat_heads__mha_block_cached__gqa_block_cached__near_ridge_kernel:
    s_load_dwordx16 s[4:19], s[0:1], 0
    s_load_dwordx8 s[60:67], s[0:1], 64
    s_load_dwordx2 s[24:25], s[0:1], 96
    s_cmp_ge_u32 s2, 256
    s_cbranch_scc1 L_exit1
    v_lshrrev_b32 v2, 6, v0
    v_and_b32 v1, 63, v0
    s_lshr_b32 s26, s2, 4
    s_and_b32 s27, s2, 3
    s_lshl_b32 s27, s27, 1
    v_readfirstlane_b32 s3, v2
    s_lshr_b32 s28, s2, 3
    s_and_b32 s28, s28, 1
    s_add_u32 s27, s27, s28
    s_lshr_b32 s28, s2, 2
    s_and_b32 s28, s28, 1
    s_mul_i32 s30, s27, 200704
    s_lshl_b32 s32, s26, 9
    s_sub_u32 s42, 3670016, s32
    s_mov_b32 s43, 0x20000
    s_mov_b32 s38, 200704
    s_mov_b32 s39, 0x20000
    v_and_b32 v3, 31, v1
    v_lshlrev_b32 v3, 4, v3
    v_lshrrev_b32 v4, 5, v1
    v_lshl_add_u32 v242, v4, 15, v3
    v_lshl_add_u32 v241, v4, 13, v3
    v_lshrrev_b32 v5, 2, v1
    v_and_b32 v6, 3, v1
    s_lshl_b32 s71, s3, 5
    v_lshrrev_b32 v8, 3, v1
    v_add_u32 v4, s71, v8
    v_mul_u32_u24 v4, 896, v4
    v_lshrrev_b32 v7, 4, v1
    v_xor_b32 v7, v7, v1
    v_and_b32 v7, 7, v7
    v_lshl_add_u32 v253, v7, 4, v4
    v_xor_b32 v251, 64, v253
    v_add_u32 v251, 7168, v251
    s_movk_i32 s72, 14336
    s_lshl_b32 s74, s3, 12
    s_lshr_b32 s73, s3, 1
    s_lshl_b32 s73, s73, 16
    s_and_b32 s23, s3, 1
    s_lshl_b32 s23, s23, 14
    s_add_u32 s73, s73, s23
    s_mul_i32 s23, s3, 2112
    s_mov_b32 m0, s23
    s_lshl_b32 s29, s27, 4
    s_add_u32 s29, s29, s26
    s_lshl_b32 s31, s29, 18
    s_mul_i32 s33, s26, 229376
    s_lshl_b32 s34, s28, 3
    s_add_u32 s34, s34, s27
    s_lshl_b32 s20, s34, 15
    s_add_u32 s20, s20, 0x3800000
    s_mul_i32 s34, s34, 3211264
    s_mul_i32 s75, s26, 200704
    s_mul_i32 s21, s27, 401408
    s_mul_i32 s22, s28, 896
    s_add_u32 s21, s21, s22
    s_sub_u32 s22, 3211264, s21
    s_cmp_eq_u32 s28, 0
    s_waitcnt lgkmcnt(0)
    s_cselect_b64 s[10:11], s[10:11], s[60:61]
    s_cselect_b64 s[4:5], s[4:5], s[14:15]
    s_cselect_b64 s[6:7], s[6:7], s[16:17]
    s_cselect_b64 s[8:9], s[8:9], s[18:19]
    s_cselect_b64 s[12:13], s[12:13], s[62:63]
    s_add_u32 s40, s10, s32
    s_addc_u32 s41, s11, 0
    s_add_u32 s36, s4, s30
    s_addc_u32 s37, s5, 0
    buffer_load_dwordx4 v242, s[40:43], s73 offen lds
    s_addk_i32 m0, 1056
    s_addk_i32 s73, 8192
    buffer_load_dwordx4 v242, s[40:43], s73 offen lds
    s_cmp_eq_u32 s3, 7
    s_cbranch_scc1 L_loader
L_compute:
    s_add_u32 m0, s74, 101376
    s_nop 0
    buffer_load_dwordx4 v253, s[36:39], 0 offen offset:0 lds
    s_add_u32 m0, s74, 102400
    s_nop 0
    buffer_load_dwordx4 v251, s[36:39], 0 offen offset:0 lds
    s_add_u32 m0, s74, 103424
    s_nop 0
    buffer_load_dwordx4 v253, s[36:39], s72 offen offset:0 lds
    s_add_u32 m0, s74, 104448
    s_nop 0
    buffer_load_dwordx4 v251, s[36:39], s72 offen offset:0 lds
    s_add_u32 m0, s23, 16896
    s_add_u32 s73, s73, 253952
    buffer_load_dwordx4 v242, s[40:43], s73 offen lds
    s_addk_i32 m0, 1056
    s_addk_i32 s73, 8192
    buffer_load_dwordx4 v242, s[40:43], s73 offen lds
    s_add_u32 s44, s6, s31
    s_addc_u32 s45, s7, 0
    s_mov_b32 s46, 0x40000
    s_mov_b32 s47, 0x20000
    s_add_u32 s48, s8, s31
    s_addc_u32 s49, s9, 0
    s_mov_b32 s50, 0x40000
    s_mov_b32 s51, 0x20000
    s_add_u32 s52, s12, s33
    s_addc_u32 s53, s13, 0
    s_mov_b32 s54, 0x38000
    s_mov_b32 s55, 0x20000
    s_add_u32 s56, s24, s34
    s_addc_u32 s57, s25, 0
    s_mov_b32 s58, 0x310000
    s_mov_b32 s59, 0x20000
    s_add_u32 s92, s24, s20
    s_addc_u32 s93, s25, 0
    s_mov_b32 s94, 0x8000
    s_mov_b32 s95, 0x20000
    s_add_u32 s96, s64, s21
    s_addc_u32 s97, s65, 0
    s_mov_b32 s98, s22
    s_mov_b32 s99, 0x20000
    v_mul_u32_u24 v5, 1056, v5
    v_lshl_add_u32 v249, v6, 3, v5
    v_xor_b32 v252, 16, v249
    v_and_b32 v2, 15, v1
    v_lshrrev_b32 v3, 4, v1
    v_lshrrev_b32 v6, 1, v2
    v_xor_b32 v6, v6, v3
    v_lshl_add_u32 v6, v2, 3, v6
    v_lshlrev_b32 v6, 4, v6
    v_add_u32 v6, s74, v6
    v_add_u32 v254, 0x18c00, v6
    v_xor_b32 v255, 64, v254
    v_lshlrev_b32 v6, 1, v3
    v_mov_b32 v7, 0x9c
    v_lshrrev_b32 v6, v6, v7
    v_and_b32 v6, 3, v6
    v_mul_u32_u24 v5, 1056, v2
    v_lshl_add_u32 v248, v6, 4, v5
    v_add_u32 v248, 0x18c00, v248
    v_mov_b32 v250, 0x3db8aa3b
    s_mov_b32 s62, 0x47800000
    s_mov_b32 s67, 33792
    s_mov_b32 s68, -118272
    s_waitcnt vmcnt(2)
    ds_read_b128 v[128:131], v254 offset:0
    ds_read_b128 v[132:135], v254 offset:2048
    ds_read_b128 v[136:139], v255 offset:0
    ds_read_b128 v[140:143], v255 offset:2048
    s_barrier
    ds_read_b64_tr_b16 v[224:225], v249 offset:0
    ds_read_b64_tr_b16 v[226:227], v249 offset:512
    ds_read_b64_tr_b16 v[228:229], v252 offset:32
    ds_read_b64_tr_b16 v[230:231], v252 offset:544
    ds_read_b64_tr_b16 v[232:233], v249 offset:64
    ds_read_b64_tr_b16 v[234:235], v249 offset:576
    ds_read_b64_tr_b16 v[236:237], v252 offset:96
    ds_read_b64_tr_b16 v[238:239], v252 offset:608
    ds_read_b64_tr_b16 v[240:241], v249 offset:128
    s_buffer_load_dword s90, s[92:95], 0x380
    s_waitcnt lgkmcnt(7)
    v_mfma_f32_16x16x32_bf16 v[0:3], v[224:227], v[128:131], 0
    ds_read_b64_tr_b16 v[242:243], v249 offset:640
    s_add_u32 m0, s74, 135040
    v_mfma_f32_16x16x32_bf16 v[4:7], v[224:227], v[132:135], 0
    ds_read_b64_tr_b16 v[244:245], v252 offset:160
    buffer_load_dwordx4 v253, s[36:39], 0 offen offset:128 lds
    s_waitcnt lgkmcnt(7)
    v_mfma_f32_16x16x32_bf16 v[8:11], v[228:231], v[128:131], 0
    ds_read_b64_tr_b16 v[246:247], v252 offset:672
    s_add_u32 m0, s74, 136064
    v_mfma_f32_16x16x32_bf16 v[12:15], v[228:231], v[132:135], 0
    ds_read_b64_tr_b16 v[224:225], v249 offset:192
    buffer_load_dwordx4 v251, s[36:39], 0 offen offset:128 lds
    s_waitcnt lgkmcnt(7)
    v_mfma_f32_16x16x32_bf16 v[16:19], v[232:235], v[128:131], 0
    ds_read_b64_tr_b16 v[226:227], v249 offset:704
    s_add_u32 m0, s74, 137088
    v_mfma_f32_16x16x32_bf16 v[20:23], v[232:235], v[132:135], 0
    ds_read_b64_tr_b16 v[228:229], v252 offset:224
    buffer_load_dwordx4 v253, s[36:39], s72 offen offset:128 lds
    s_waitcnt lgkmcnt(7)
    v_mfma_f32_16x16x32_bf16 v[24:27], v[236:239], v[128:131], 0
    ds_read_b64_tr_b16 v[230:231], v252 offset:736
    s_add_u32 m0, s74, 138112
    v_mfma_f32_16x16x32_bf16 v[28:31], v[236:239], v[132:135], 0
    ds_read_b64_tr_b16 v[232:233], v249 offset:256
    buffer_load_dwordx4 v251, s[36:39], s72 offen offset:128 lds
    s_waitcnt lgkmcnt(7)
    v_mfma_f32_16x16x32_bf16 v[32:35], v[240:243], v[128:131], 0
    ds_read_b64_tr_b16 v[234:235], v249 offset:768
    v_mfma_f32_16x16x32_bf16 v[36:39], v[240:243], v[132:135], 0
    ds_read_b64_tr_b16 v[236:237], v252 offset:288
    s_waitcnt lgkmcnt(7)
    v_mfma_f32_16x16x32_bf16 v[40:43], v[244:247], v[128:131], 0
    ds_read_b64_tr_b16 v[238:239], v252 offset:800
    v_mfma_f32_16x16x32_bf16 v[44:47], v[244:247], v[132:135], 0
    ds_read_b64_tr_b16 v[240:241], v249 offset:320
    s_waitcnt lgkmcnt(7)
    v_mfma_f32_16x16x32_bf16 v[48:51], v[224:227], v[128:131], 0
    ds_read_b64_tr_b16 v[242:243], v249 offset:832
    v_mfma_f32_16x16x32_bf16 v[52:55], v[224:227], v[132:135], 0
    ds_read_b64_tr_b16 v[224:225], v252 offset:352
    s_waitcnt lgkmcnt(7)
    v_mfma_f32_16x16x32_bf16 v[56:59], v[228:231], v[128:131], 0
    ds_read_b64_tr_b16 v[226:227], v252 offset:864
    v_mfma_f32_16x16x32_bf16 v[60:63], v[228:231], v[132:135], 0
    ds_read_b64_tr_b16 v[228:229], v249 offset:384
    s_waitcnt lgkmcnt(7)
    v_mfma_f32_16x16x32_bf16 v[64:67], v[232:235], v[128:131], 0
    ds_read_b64_tr_b16 v[230:231], v249 offset:896
    v_mfma_f32_16x16x32_bf16 v[68:71], v[232:235], v[132:135], 0
    ds_read_b64_tr_b16 v[232:233], v252 offset:416
    s_waitcnt lgkmcnt(7)
    v_mfma_f32_16x16x32_bf16 v[72:75], v[236:239], v[128:131], 0
    ds_read_b64_tr_b16 v[234:235], v252 offset:928
    v_mfma_f32_16x16x32_bf16 v[76:79], v[236:239], v[132:135], 0
    ds_read_b64_tr_b16 v[236:237], v249 offset:448
    s_waitcnt vmcnt(4)
    s_barrier
    s_waitcnt lgkmcnt(7)
    v_mfma_f32_16x16x32_bf16 v[80:83], v[240:243], v[128:131], 0
    ds_read_b64_tr_b16 v[238:239], v249 offset:960
    v_mfma_f32_16x16x32_bf16 v[84:87], v[240:243], v[132:135], 0
    ds_read_b64_tr_b16 v[240:241], v252 offset:480
    s_waitcnt lgkmcnt(7)
    v_mfma_f32_16x16x32_bf16 v[88:91], v[224:227], v[128:131], 0
    ds_read_b64_tr_b16 v[242:243], v252 offset:992
    s_add_u32 m0, s74, 101120
    v_mfma_f32_16x16x32_bf16 v[92:95], v[224:227], v[132:135], 0
    v_add_u32 v249, 0x4200, v249
    v_add_u32 v252, 0x4200, v252
    ds_read_b64_tr_b16 v[224:225], v249 offset:0
    buffer_load_dwordx4 v253, s[36:39], 0 offen offset:256 lds
    s_waitcnt lgkmcnt(7)
    v_mfma_f32_16x16x32_bf16 v[96:99], v[228:231], v[128:131], 0
    ds_read_b64_tr_b16 v[226:227], v249 offset:512
    s_add_u32 m0, s74, 102144
    v_mfma_f32_16x16x32_bf16 v[100:103], v[228:231], v[132:135], 0
    ds_read_b64_tr_b16 v[228:229], v252 offset:32
    buffer_load_dwordx4 v251, s[36:39], 0 offen offset:256 lds
    s_waitcnt lgkmcnt(7)
    v_mfma_f32_16x16x32_bf16 v[104:107], v[232:235], v[128:131], 0
    ds_read_b64_tr_b16 v[230:231], v252 offset:544
    s_add_u32 m0, s74, 103168
    v_mfma_f32_16x16x32_bf16 v[108:111], v[232:235], v[132:135], 0
    ds_read_b64_tr_b16 v[232:233], v249 offset:64
    buffer_load_dwordx4 v253, s[36:39], s72 offen offset:256 lds
    s_waitcnt lgkmcnt(7)
    v_mfma_f32_16x16x32_bf16 v[112:115], v[236:239], v[128:131], 0
    ds_read_b64_tr_b16 v[234:235], v249 offset:576
    s_add_u32 m0, s74, 104192
    v_mfma_f32_16x16x32_bf16 v[116:119], v[236:239], v[132:135], 0
    ds_read_b64_tr_b16 v[236:237], v252 offset:96
    buffer_load_dwordx4 v251, s[36:39], s72 offen offset:256 lds
    s_waitcnt lgkmcnt(7)
    v_mfma_f32_16x16x32_bf16 v[120:123], v[240:243], v[128:131], 0
    ds_read_b64_tr_b16 v[238:239], v252 offset:608
    v_mfma_f32_16x16x32_bf16 v[124:127], v[240:243], v[132:135], 0
    ds_read_b64_tr_b16 v[240:241], v249 offset:128
    s_barrier
    s_waitcnt lgkmcnt(0)
    v_mfma_f32_16x16x32_bf16 v[0:3], v[224:227], v[136:139], v[0:3]
    ds_read_b64_tr_b16 v[242:243], v249 offset:640
    s_waitcnt lgkmcnt(0)
    v_mfma_f32_16x16x32_bf16 v[4:7], v[224:227], v[140:143], v[4:7]
    ds_read_b64_tr_b16 v[244:245], v252 offset:160
    s_waitcnt lgkmcnt(0)
    v_mfma_f32_16x16x32_bf16 v[8:11], v[228:231], v[136:139], v[8:11]
    ds_read_b64_tr_b16 v[246:247], v252 offset:672
    v_mfma_f32_16x16x32_bf16 v[12:15], v[228:231], v[140:143], v[12:15]
    ds_read_b64_tr_b16 v[224:225], v249 offset:192
    s_waitcnt lgkmcnt(0)
    v_mfma_f32_16x16x32_bf16 v[16:19], v[232:235], v[136:139], v[16:19]
    ds_read_b64_tr_b16 v[226:227], v249 offset:704
    s_waitcnt lgkmcnt(0)
    v_mfma_f32_16x16x32_bf16 v[20:23], v[232:235], v[140:143], v[20:23]
    ds_read_b64_tr_b16 v[228:229], v252 offset:224
    s_waitcnt lgkmcnt(0)
    v_mfma_f32_16x16x32_bf16 v[24:27], v[236:239], v[136:139], v[24:27]
    ds_read_b64_tr_b16 v[230:231], v252 offset:736
    v_mfma_f32_16x16x32_bf16 v[28:31], v[236:239], v[140:143], v[28:31]
    ds_read_b64_tr_b16 v[232:233], v249 offset:256
    s_waitcnt vmcnt(4)
    s_waitcnt lgkmcnt(0)
    v_mfma_f32_16x16x32_bf16 v[32:35], v[240:243], v[136:139], v[32:35]
    ds_read_b64_tr_b16 v[234:235], v249 offset:768
    ds_read_b128 v[144:147], v254 offset:33792
    s_waitcnt lgkmcnt(0)
    v_mfma_f32_16x16x32_bf16 v[36:39], v[240:243], v[140:143], v[36:39]
    ds_read_b64_tr_b16 v[236:237], v252 offset:288
    s_waitcnt lgkmcnt(0)
    v_mfma_f32_16x16x32_bf16 v[40:43], v[244:247], v[136:139], v[40:43]
    ds_read_b64_tr_b16 v[238:239], v252 offset:800
    ds_read_b128 v[148:151], v254 offset:35840
    v_mfma_f32_16x16x32_bf16 v[44:47], v[244:247], v[140:143], v[44:47]
    ds_read_b64_tr_b16 v[240:241], v249 offset:320
    s_waitcnt lgkmcnt(0)
    v_mfma_f32_16x16x32_bf16 v[48:51], v[224:227], v[136:139], v[48:51]
    ds_read_b64_tr_b16 v[242:243], v249 offset:832
    ds_read_b128 v[152:155], v255 offset:33792
    s_waitcnt lgkmcnt(0)
    v_mfma_f32_16x16x32_bf16 v[52:55], v[224:227], v[140:143], v[52:55]
    ds_read_b64_tr_b16 v[224:225], v252 offset:352
    s_waitcnt lgkmcnt(0)
    v_mfma_f32_16x16x32_bf16 v[56:59], v[228:231], v[136:139], v[56:59]
    ds_read_b64_tr_b16 v[226:227], v252 offset:864
    ds_read_b128 v[156:159], v255 offset:35840
    v_mfma_f32_16x16x32_bf16 v[60:63], v[228:231], v[140:143], v[60:63]
    ds_read_b64_tr_b16 v[228:229], v249 offset:384
    s_waitcnt lgkmcnt(0)
    v_mfma_f32_16x16x32_bf16 v[64:67], v[232:235], v[136:139], v[64:67]
    ds_read_b64_tr_b16 v[230:231], v249 offset:896
    s_waitcnt lgkmcnt(0)
    v_mfma_f32_16x16x32_bf16 v[68:71], v[232:235], v[140:143], v[68:71]
    ds_read_b64_tr_b16 v[232:233], v252 offset:416
    s_waitcnt lgkmcnt(0)
    v_mfma_f32_16x16x32_bf16 v[72:75], v[236:239], v[136:139], v[72:75]
    ds_read_b64_tr_b16 v[234:235], v252 offset:928
    v_mfma_f32_16x16x32_bf16 v[76:79], v[236:239], v[140:143], v[76:79]
    ds_read_b64_tr_b16 v[236:237], v249 offset:448
    s_waitcnt vmcnt(0)
    s_waitcnt lgkmcnt(0)
    v_mfma_f32_16x16x32_bf16 v[80:83], v[240:243], v[136:139], v[80:83]
    ds_read_b64_tr_b16 v[238:239], v249 offset:960
    ds_read_b128 v[160:163], v254 offset:0
    s_waitcnt lgkmcnt(0)
    v_mfma_f32_16x16x32_bf16 v[84:87], v[240:243], v[140:143], v[84:87]
    ds_read_b64_tr_b16 v[240:241], v252 offset:480
    s_waitcnt lgkmcnt(0)
    v_mfma_f32_16x16x32_bf16 v[88:91], v[224:227], v[136:139], v[88:91]
    ds_read_b64_tr_b16 v[242:243], v252 offset:992
    ds_read_b128 v[164:167], v254 offset:2048
    s_add_u32 m0, s74, 134784
    v_mfma_f32_16x16x32_bf16 v[92:95], v[224:227], v[140:143], v[92:95]
    v_add_u32 v249, 0x4200, v249
    v_add_u32 v252, 0x4200, v252
    ds_read_b64_tr_b16 v[224:225], v249 offset:0
    buffer_load_dwordx4 v253, s[36:39], 0 offen offset:384 lds
    s_waitcnt lgkmcnt(0)
    v_mfma_f32_16x16x32_bf16 v[96:99], v[228:231], v[136:139], v[96:99]
    ds_read_b64_tr_b16 v[226:227], v249 offset:512
    ds_read_b128 v[168:171], v255 offset:0
    s_add_u32 m0, s74, 135808
    s_waitcnt lgkmcnt(0)
    v_mfma_f32_16x16x32_bf16 v[100:103], v[228:231], v[140:143], v[100:103]
    ds_read_b64_tr_b16 v[228:229], v252 offset:32
    buffer_load_dwordx4 v251, s[36:39], 0 offen offset:384 lds
    s_waitcnt lgkmcnt(0)
    v_mfma_f32_16x16x32_bf16 v[104:107], v[232:235], v[136:139], v[104:107]
    ds_read_b64_tr_b16 v[230:231], v252 offset:544
    ds_read_b128 v[172:175], v255 offset:2048
    s_add_u32 m0, s74, 136832
    v_mfma_f32_16x16x32_bf16 v[108:111], v[232:235], v[140:143], v[108:111]
    ds_read_b64_tr_b16 v[232:233], v249 offset:64
    buffer_load_dwordx4 v253, s[36:39], s72 offen offset:384 lds
    s_waitcnt lgkmcnt(0)
    v_mfma_f32_16x16x32_bf16 v[112:115], v[236:239], v[136:139], v[112:115]
    ds_read_b64_tr_b16 v[234:235], v249 offset:576
    s_add_u32 m0, s74, 137856
    s_waitcnt lgkmcnt(0)
    v_mfma_f32_16x16x32_bf16 v[116:119], v[236:239], v[140:143], v[116:119]
    ds_read_b64_tr_b16 v[236:237], v252 offset:96
    buffer_load_dwordx4 v251, s[36:39], s72 offen offset:384 lds
    s_waitcnt lgkmcnt(0)
    v_mfma_f32_16x16x32_bf16 v[120:123], v[240:243], v[136:139], v[120:123]
    ds_read_b64_tr_b16 v[238:239], v252 offset:608
    v_mfma_f32_16x16x32_bf16 v[124:127], v[240:243], v[140:143], v[124:127]
    ds_read_b64_tr_b16 v[240:241], v249 offset:128
    s_barrier
    s_waitcnt lgkmcnt(0)
    v_mfma_f32_16x16x32_bf16 v[0:3], v[224:227], v[144:147], v[0:3]
    ds_read_b64_tr_b16 v[242:243], v249 offset:640
    s_waitcnt lgkmcnt(0)
    v_mfma_f32_16x16x32_bf16 v[4:7], v[224:227], v[148:151], v[4:7]
    ds_read_b64_tr_b16 v[244:245], v252 offset:160
    s_waitcnt lgkmcnt(0)
    v_mfma_f32_16x16x32_bf16 v[8:11], v[228:231], v[144:147], v[8:11]
    ds_read_b64_tr_b16 v[246:247], v252 offset:672
    v_mfma_f32_16x16x32_bf16 v[12:15], v[228:231], v[148:151], v[12:15]
    ds_read_b64_tr_b16 v[224:225], v249 offset:192
    s_waitcnt lgkmcnt(0)
    v_mfma_f32_16x16x32_bf16 v[16:19], v[232:235], v[144:147], v[16:19]
    ds_read_b64_tr_b16 v[226:227], v249 offset:704
    s_waitcnt lgkmcnt(0)
    v_mfma_f32_16x16x32_bf16 v[20:23], v[232:235], v[148:151], v[20:23]
    ds_read_b64_tr_b16 v[228:229], v252 offset:224
    s_waitcnt lgkmcnt(0)
    v_mfma_f32_16x16x32_bf16 v[24:27], v[236:239], v[144:147], v[24:27]
    ds_read_b64_tr_b16 v[230:231], v252 offset:736
    v_mfma_f32_16x16x32_bf16 v[28:31], v[236:239], v[148:151], v[28:31]
    ds_read_b64_tr_b16 v[232:233], v249 offset:256
    s_waitcnt lgkmcnt(0)
    v_mfma_f32_16x16x32_bf16 v[32:35], v[240:243], v[144:147], v[32:35]
    ds_read_b64_tr_b16 v[234:235], v249 offset:768
    s_waitcnt lgkmcnt(0)
    v_mfma_f32_16x16x32_bf16 v[36:39], v[240:243], v[148:151], v[36:39]
    ds_read_b64_tr_b16 v[236:237], v252 offset:288
    s_waitcnt lgkmcnt(0)
    v_mfma_f32_16x16x32_bf16 v[40:43], v[244:247], v[144:147], v[40:43]
    ds_read_b64_tr_b16 v[238:239], v252 offset:800
    v_mfma_f32_16x16x32_bf16 v[44:47], v[244:247], v[148:151], v[44:47]
    ds_read_b64_tr_b16 v[240:241], v249 offset:320
    s_waitcnt lgkmcnt(0)
    v_mfma_f32_16x16x32_bf16 v[48:51], v[224:227], v[144:147], v[48:51]
    ds_read_b64_tr_b16 v[242:243], v249 offset:832
    s_waitcnt lgkmcnt(0)
    v_mfma_f32_16x16x32_bf16 v[52:55], v[224:227], v[148:151], v[52:55]
    ds_read_b64_tr_b16 v[224:225], v252 offset:352
    s_waitcnt lgkmcnt(0)
    v_mfma_f32_16x16x32_bf16 v[56:59], v[228:231], v[144:147], v[56:59]
    ds_read_b64_tr_b16 v[226:227], v252 offset:864
    v_mfma_f32_16x16x32_bf16 v[60:63], v[228:231], v[148:151], v[60:63]
    ds_read_b64_tr_b16 v[228:229], v249 offset:384
    s_waitcnt lgkmcnt(0)
    v_mfma_f32_16x16x32_bf16 v[64:67], v[232:235], v[144:147], v[64:67]
    ds_read_b64_tr_b16 v[230:231], v249 offset:896
    s_waitcnt lgkmcnt(0)
    v_mfma_f32_16x16x32_bf16 v[68:71], v[232:235], v[148:151], v[68:71]
    ds_read_b64_tr_b16 v[232:233], v252 offset:416
    s_waitcnt lgkmcnt(0)
    v_mfma_f32_16x16x32_bf16 v[72:75], v[236:239], v[144:147], v[72:75]
    ds_read_b64_tr_b16 v[234:235], v252 offset:928
    v_mfma_f32_16x16x32_bf16 v[76:79], v[236:239], v[148:151], v[76:79]
    ds_read_b64_tr_b16 v[236:237], v249 offset:448
    s_waitcnt lgkmcnt(0)
    v_mfma_f32_16x16x32_bf16 v[80:83], v[240:243], v[144:147], v[80:83]
    ds_read_b64_tr_b16 v[238:239], v249 offset:960
    s_waitcnt lgkmcnt(0)
    v_mfma_f32_16x16x32_bf16 v[84:87], v[240:243], v[148:151], v[84:87]
    ds_read_b64_tr_b16 v[240:241], v252 offset:480
    s_waitcnt lgkmcnt(0)
    v_mfma_f32_16x16x32_bf16 v[88:91], v[224:227], v[144:147], v[88:91]
    ds_read_b64_tr_b16 v[242:243], v252 offset:992
    v_mfma_f32_16x16x32_bf16 v[92:95], v[224:227], v[148:151], v[92:95]
    v_add_u32 v249, 0x4200, v249
    v_add_u32 v252, 0x4200, v252
    ds_read_b64_tr_b16 v[224:225], v249 offset:0
    s_waitcnt lgkmcnt(0)
    v_mfma_f32_16x16x32_bf16 v[96:99], v[228:231], v[144:147], v[96:99]
    ds_read_b64_tr_b16 v[226:227], v249 offset:512
    s_waitcnt lgkmcnt(0)
    v_mfma_f32_16x16x32_bf16 v[100:103], v[228:231], v[148:151], v[100:103]
    ds_read_b64_tr_b16 v[228:229], v252 offset:32
    s_waitcnt lgkmcnt(0)
    v_mfma_f32_16x16x32_bf16 v[104:107], v[232:235], v[144:147], v[104:107]
    ds_read_b64_tr_b16 v[230:231], v252 offset:544
    v_mfma_f32_16x16x32_bf16 v[108:111], v[232:235], v[148:151], v[108:111]
    ds_read_b64_tr_b16 v[232:233], v249 offset:64
    s_waitcnt lgkmcnt(0)
    v_mfma_f32_16x16x32_bf16 v[112:115], v[236:239], v[144:147], v[112:115]
    ds_read_b64_tr_b16 v[234:235], v249 offset:576
    s_waitcnt lgkmcnt(0)
    v_mfma_f32_16x16x32_bf16 v[116:119], v[236:239], v[148:151], v[116:119]
    ds_read_b64_tr_b16 v[236:237], v252 offset:96
    s_waitcnt lgkmcnt(0)
    v_mfma_f32_16x16x32_bf16 v[120:123], v[240:243], v[144:147], v[120:123]
    ds_read_b64_tr_b16 v[238:239], v252 offset:608
    v_mfma_f32_16x16x32_bf16 v[124:127], v[240:243], v[148:151], v[124:127]
    ds_read_b64_tr_b16 v[240:241], v249 offset:128
    s_waitcnt lgkmcnt(0)
    v_mfma_f32_16x16x32_bf16 v[0:3], v[224:227], v[152:155], v[0:3]
    ds_read_b64_tr_b16 v[242:243], v249 offset:640
    s_waitcnt lgkmcnt(0)
    v_mfma_f32_16x16x32_bf16 v[4:7], v[224:227], v[156:159], v[4:7]
    ds_read_b64_tr_b16 v[244:245], v252 offset:160
    s_waitcnt vmcnt(0)
    s_waitcnt lgkmcnt(0)
    v_mfma_f32_16x16x32_bf16 v[8:11], v[228:231], v[152:155], v[8:11]
    ds_read_b64_tr_b16 v[246:247], v252 offset:672
    ds_read_b128 v[176:179], v254 offset:33792
    v_mfma_f32_16x16x32_bf16 v[12:15], v[228:231], v[156:159], v[12:15]
    ds_read_b64_tr_b16 v[224:225], v249 offset:192
    s_waitcnt lgkmcnt(0)
    v_mfma_f32_16x16x32_bf16 v[16:19], v[232:235], v[152:155], v[16:19]
    ds_read_b64_tr_b16 v[226:227], v249 offset:704
    ds_read_b128 v[180:183], v254 offset:35840
    s_waitcnt lgkmcnt(0)
    v_mfma_f32_16x16x32_bf16 v[20:23], v[232:235], v[156:159], v[20:23]
    ds_read_b64_tr_b16 v[228:229], v252 offset:224
    s_waitcnt lgkmcnt(0)
    v_mfma_f32_16x16x32_bf16 v[24:27], v[236:239], v[152:155], v[24:27]
    ds_read_b64_tr_b16 v[230:231], v252 offset:736
    ds_read_b128 v[184:187], v255 offset:33792
    v_mfma_f32_16x16x32_bf16 v[28:31], v[236:239], v[156:159], v[28:31]
    ds_read_b64_tr_b16 v[232:233], v249 offset:256
    s_waitcnt lgkmcnt(0)
    v_mfma_f32_16x16x32_bf16 v[32:35], v[240:243], v[152:155], v[32:35]
    ds_read_b64_tr_b16 v[234:235], v249 offset:768
    ds_read_b128 v[188:191], v255 offset:35840
    s_waitcnt lgkmcnt(0)
    v_mfma_f32_16x16x32_bf16 v[36:39], v[240:243], v[156:159], v[36:39]
    ds_read_b64_tr_b16 v[236:237], v252 offset:288
    s_waitcnt lgkmcnt(0)
    v_mfma_f32_16x16x32_bf16 v[40:43], v[244:247], v[152:155], v[40:43]
    ds_read_b64_tr_b16 v[238:239], v252 offset:800
    v_mfma_f32_16x16x32_bf16 v[44:47], v[244:247], v[156:159], v[44:47]
    ds_read_b64_tr_b16 v[240:241], v249 offset:320
    s_waitcnt lgkmcnt(0)
    v_mfma_f32_16x16x32_bf16 v[48:51], v[224:227], v[152:155], v[48:51]
    ds_read_b64_tr_b16 v[242:243], v249 offset:832
    s_waitcnt lgkmcnt(0)
    v_mfma_f32_16x16x32_bf16 v[52:55], v[224:227], v[156:159], v[52:55]
    ds_read_b64_tr_b16 v[224:225], v252 offset:352
    s_waitcnt lgkmcnt(0)
    v_mfma_f32_16x16x32_bf16 v[56:59], v[228:231], v[152:155], v[56:59]
    ds_read_b64_tr_b16 v[226:227], v252 offset:864
    v_mfma_f32_16x16x32_bf16 v[60:63], v[228:231], v[156:159], v[60:63]
    ds_read_b64_tr_b16 v[228:229], v249 offset:384
    s_waitcnt lgkmcnt(0)
    v_mfma_f32_16x16x32_bf16 v[64:67], v[232:235], v[152:155], v[64:67]
    ds_read_b64_tr_b16 v[230:231], v249 offset:896
    s_add_u32 m0, s74, 134656
    s_waitcnt lgkmcnt(0)
    v_mfma_f32_16x16x32_bf16 v[68:71], v[232:235], v[156:159], v[68:71]
    ds_read_b64_tr_b16 v[232:233], v252 offset:416
    buffer_load_dwordx4 v253, s[36:39], 0 offen offset:512 lds
    s_waitcnt lgkmcnt(0)
    v_mfma_f32_16x16x32_bf16 v[72:75], v[236:239], v[152:155], v[72:75]
    ds_read_b64_tr_b16 v[234:235], v252 offset:928
    s_add_u32 m0, s74, 135680
    v_mfma_f32_16x16x32_bf16 v[76:79], v[236:239], v[156:159], v[76:79]
    ds_read_b64_tr_b16 v[236:237], v249 offset:448
    buffer_load_dwordx4 v251, s[36:39], 0 offen offset:512 lds
    s_waitcnt lgkmcnt(0)
    v_mfma_f32_16x16x32_bf16 v[80:83], v[240:243], v[152:155], v[80:83]
    ds_read_b64_tr_b16 v[238:239], v249 offset:960
    s_add_u32 m0, s74, 136704
    s_waitcnt lgkmcnt(0)
    v_mfma_f32_16x16x32_bf16 v[84:87], v[240:243], v[156:159], v[84:87]
    ds_read_b64_tr_b16 v[240:241], v252 offset:480
    buffer_load_dwordx4 v253, s[36:39], s72 offen offset:512 lds
    s_waitcnt lgkmcnt(0)
    v_mfma_f32_16x16x32_bf16 v[88:91], v[224:227], v[152:155], v[88:91]
    ds_read_b64_tr_b16 v[242:243], v252 offset:992
    s_add_u32 m0, s74, 137728
    v_mfma_f32_16x16x32_bf16 v[92:95], v[224:227], v[156:159], v[92:95]
    v_add_u32 v249, 0x4200, v249
    v_add_u32 v252, 0x4200, v252
    ds_read_b64_tr_b16 v[224:225], v249 offset:0
    buffer_load_dwordx4 v251, s[36:39], s72 offen offset:512 lds
    s_waitcnt lgkmcnt(0)
    v_mfma_f32_16x16x32_bf16 v[96:99], v[228:231], v[152:155], v[96:99]
    ds_read_b64_tr_b16 v[226:227], v249 offset:512
    s_waitcnt lgkmcnt(0)
    v_mfma_f32_16x16x32_bf16 v[100:103], v[228:231], v[156:159], v[100:103]
    ds_read_b64_tr_b16 v[228:229], v252 offset:32
    s_waitcnt lgkmcnt(0)
    v_mfma_f32_16x16x32_bf16 v[104:107], v[232:235], v[152:155], v[104:107]
    ds_read_b64_tr_b16 v[230:231], v252 offset:544
    v_mfma_f32_16x16x32_bf16 v[108:111], v[232:235], v[156:159], v[108:111]
    ds_read_b64_tr_b16 v[232:233], v249 offset:64
    s_waitcnt lgkmcnt(0)
    v_mfma_f32_16x16x32_bf16 v[112:115], v[236:239], v[152:155], v[112:115]
    ds_read_b64_tr_b16 v[234:235], v249 offset:576
    s_waitcnt lgkmcnt(0)
    v_mfma_f32_16x16x32_bf16 v[116:119], v[236:239], v[156:159], v[116:119]
    ds_read_b64_tr_b16 v[236:237], v252 offset:96
    s_waitcnt lgkmcnt(0)
    v_mfma_f32_16x16x32_bf16 v[120:123], v[240:243], v[152:155], v[120:123]
    ds_read_b64_tr_b16 v[238:239], v252 offset:608
    v_mfma_f32_16x16x32_bf16 v[124:127], v[240:243], v[156:159], v[124:127]
    ds_read_b64_tr_b16 v[240:241], v249 offset:128
    s_barrier
    v_mfma_f32_16x16x32_bf16 v[0:3], v[224:227], v[160:163], v[0:3]
    ds_read_b64_tr_b16 v[242:243], v249 offset:640
    v_mfma_f32_16x16x32_bf16 v[4:7], v[224:227], v[164:167], v[4:7]
    ds_read_b64_tr_b16 v[244:245], v252 offset:160
    v_mfma_f32_16x16x32_bf16 v[8:11], v[228:231], v[160:163], v[8:11]
    ds_read_b64_tr_b16 v[246:247], v252 offset:672
    v_mfma_f32_16x16x32_bf16 v[12:15], v[228:231], v[164:167], v[12:15]
    ds_read_b64_tr_b16 v[224:225], v249 offset:192
    v_mfma_f32_16x16x32_bf16 v[16:19], v[232:235], v[160:163], v[16:19]
    ds_read_b64_tr_b16 v[226:227], v249 offset:704
    v_mfma_f32_16x16x32_bf16 v[20:23], v[232:235], v[164:167], v[20:23]
    ds_read_b64_tr_b16 v[228:229], v252 offset:224
    s_waitcnt lgkmcnt(7)
    v_mfma_f32_16x16x32_bf16 v[24:27], v[236:239], v[160:163], v[24:27]
    ds_read_b64_tr_b16 v[230:231], v252 offset:736
    v_mfma_f32_16x16x32_bf16 v[28:31], v[236:239], v[164:167], v[28:31]
    ds_read_b64_tr_b16 v[232:233], v249 offset:256
    s_waitcnt lgkmcnt(7)
    v_mfma_f32_16x16x32_bf16 v[32:35], v[240:243], v[160:163], v[32:35]
    ds_read_b64_tr_b16 v[234:235], v249 offset:768
    v_mfma_f32_16x16x32_bf16 v[36:39], v[240:243], v[164:167], v[36:39]
    ds_read_b64_tr_b16 v[236:237], v252 offset:288
    s_waitcnt lgkmcnt(7)
    v_mfma_f32_16x16x32_bf16 v[40:43], v[244:247], v[160:163], v[40:43]
    ds_read_b64_tr_b16 v[238:239], v252 offset:800
    v_mfma_f32_16x16x32_bf16 v[44:47], v[244:247], v[164:167], v[44:47]
    ds_read_b64_tr_b16 v[240:241], v249 offset:320
    s_waitcnt lgkmcnt(7)
    v_mfma_f32_16x16x32_bf16 v[48:51], v[224:227], v[160:163], v[48:51]
    ds_read_b64_tr_b16 v[242:243], v249 offset:832
    v_mfma_f32_16x16x32_bf16 v[52:55], v[224:227], v[164:167], v[52:55]
    ds_read_b64_tr_b16 v[224:225], v252 offset:352
    s_waitcnt lgkmcnt(7)
    v_mfma_f32_16x16x32_bf16 v[56:59], v[228:231], v[160:163], v[56:59]
    ds_read_b64_tr_b16 v[226:227], v252 offset:864
    v_mfma_f32_16x16x32_bf16 v[60:63], v[228:231], v[164:167], v[60:63]
    ds_read_b64_tr_b16 v[228:229], v249 offset:384
    s_waitcnt lgkmcnt(7)
    v_mfma_f32_16x16x32_bf16 v[64:67], v[232:235], v[160:163], v[64:67]
    ds_read_b64_tr_b16 v[230:231], v249 offset:896
    v_mfma_f32_16x16x32_bf16 v[68:71], v[232:235], v[164:167], v[68:71]
    ds_read_b64_tr_b16 v[232:233], v252 offset:416
    s_waitcnt lgkmcnt(7)
    v_mfma_f32_16x16x32_bf16 v[72:75], v[236:239], v[160:163], v[72:75]
    ds_read_b64_tr_b16 v[234:235], v252 offset:928
    v_mfma_f32_16x16x32_bf16 v[76:79], v[236:239], v[164:167], v[76:79]
    ds_read_b64_tr_b16 v[236:237], v249 offset:448
    s_waitcnt lgkmcnt(7)
    v_mfma_f32_16x16x32_bf16 v[80:83], v[240:243], v[160:163], v[80:83]
    ds_read_b64_tr_b16 v[238:239], v249 offset:960
    v_mfma_f32_16x16x32_bf16 v[84:87], v[240:243], v[164:167], v[84:87]
    ds_read_b64_tr_b16 v[240:241], v252 offset:480
    s_waitcnt lgkmcnt(7)
    v_mfma_f32_16x16x32_bf16 v[88:91], v[224:227], v[160:163], v[88:91]
    ds_read_b64_tr_b16 v[242:243], v252 offset:992
    v_mfma_f32_16x16x32_bf16 v[92:95], v[224:227], v[164:167], v[92:95]
    v_add_u32 v249, 0x4200, v249
    v_add_u32 v252, 0x4200, v252
    ds_read_b64_tr_b16 v[224:225], v249 offset:0
    s_waitcnt lgkmcnt(7)
    v_mfma_f32_16x16x32_bf16 v[96:99], v[228:231], v[160:163], v[96:99]
    ds_read_b64_tr_b16 v[226:227], v249 offset:512
    v_mfma_f32_16x16x32_bf16 v[100:103], v[228:231], v[164:167], v[100:103]
    ds_read_b64_tr_b16 v[228:229], v252 offset:32
    s_waitcnt lgkmcnt(7)
    v_mfma_f32_16x16x32_bf16 v[104:107], v[232:235], v[160:163], v[104:107]
    ds_read_b64_tr_b16 v[230:231], v252 offset:544
    v_mfma_f32_16x16x32_bf16 v[108:111], v[232:235], v[164:167], v[108:111]
    ds_read_b64_tr_b16 v[232:233], v249 offset:64
    s_waitcnt lgkmcnt(7)
    v_mfma_f32_16x16x32_bf16 v[112:115], v[236:239], v[160:163], v[112:115]
    ds_read_b64_tr_b16 v[234:235], v249 offset:576
    v_mfma_f32_16x16x32_bf16 v[116:119], v[236:239], v[164:167], v[116:119]
    ds_read_b64_tr_b16 v[236:237], v252 offset:96
    s_waitcnt lgkmcnt(7)
    v_mfma_f32_16x16x32_bf16 v[120:123], v[240:243], v[160:163], v[120:123]
    ds_read_b64_tr_b16 v[238:239], v252 offset:608
    v_mfma_f32_16x16x32_bf16 v[124:127], v[240:243], v[164:167], v[124:127]
    ds_read_b64_tr_b16 v[240:241], v249 offset:128
    s_waitcnt lgkmcnt(0)
    s_mul_i32 s90, s90, 0x9e3779b1
    s_add_u32 s90, s90, 0x7f4a7c15
    v_mfma_f32_16x16x32_bf16 v[0:3], v[224:227], v[168:171], v[0:3]
    ds_read_b64_tr_b16 v[242:243], v249 offset:640
    v_mfma_f32_16x16x32_bf16 v[4:7], v[224:227], v[172:175], v[4:7]
    ds_read_b64_tr_b16 v[244:245], v252 offset:160
    s_waitcnt vmcnt(0)
    v_mfma_f32_16x16x32_bf16 v[8:11], v[228:231], v[168:171], v[8:11]
    ds_read_b64_tr_b16 v[246:247], v252 offset:672
    ds_read_b128 v[128:131], v254 offset:33792
    v_mfma_f32_16x16x32_bf16 v[12:15], v[228:231], v[172:175], v[12:15]
    ds_read_b64_tr_b16 v[224:225], v249 offset:192
    v_mfma_f32_16x16x32_bf16 v[16:19], v[232:235], v[168:171], v[16:19]
    ds_read_b64_tr_b16 v[226:227], v249 offset:704
    ds_read_b128 v[132:135], v254 offset:35840
    v_mfma_f32_16x16x32_bf16 v[20:23], v[232:235], v[172:175], v[20:23]
    ds_read_b64_tr_b16 v[228:229], v252 offset:224
    v_mfma_f32_16x16x32_bf16 v[24:27], v[236:239], v[168:171], v[24:27]
    ds_read_b64_tr_b16 v[230:231], v252 offset:736
    ds_read_b128 v[136:139], v255 offset:33792
    v_mfma_f32_16x16x32_bf16 v[28:31], v[236:239], v[172:175], v[28:31]
    ds_read_b64_tr_b16 v[232:233], v249 offset:256
    s_waitcnt lgkmcnt(10)
    v_mfma_f32_16x16x32_bf16 v[32:35], v[240:243], v[168:171], v[32:35]
    ds_read_b64_tr_b16 v[234:235], v249 offset:768
    ds_read_b128 v[140:143], v255 offset:35840
    v_mfma_f32_16x16x32_bf16 v[36:39], v[240:243], v[172:175], v[36:39]
    ds_read_b64_tr_b16 v[236:237], v252 offset:288
    s_waitcnt lgkmcnt(11)
    v_mfma_f32_16x16x32_bf16 v[40:43], v[244:247], v[168:171], v[40:43]
    ds_read_b64_tr_b16 v[238:239], v252 offset:800
    v_mfma_f32_16x16x32_bf16 v[44:47], v[244:247], v[172:175], v[44:47]
    ds_read_b64_tr_b16 v[240:241], v249 offset:320
    s_waitcnt lgkmcnt(10)
    v_mfma_f32_16x16x32_bf16 v[48:51], v[224:227], v[168:171], v[48:51]
    ds_read_b64_tr_b16 v[242:243], v249 offset:832
    v_mfma_f32_16x16x32_bf16 v[52:55], v[224:227], v[172:175], v[52:55]
    ds_read_b64_tr_b16 v[224:225], v252 offset:352
    s_waitcnt lgkmcnt(9)
    v_mfma_f32_16x16x32_bf16 v[56:59], v[228:231], v[168:171], v[56:59]
    ds_read_b64_tr_b16 v[226:227], v252 offset:864
    v_mfma_f32_16x16x32_bf16 v[60:63], v[228:231], v[172:175], v[60:63]
    ds_read_b64_tr_b16 v[228:229], v249 offset:384
    s_waitcnt lgkmcnt(7)
    v_mfma_f32_16x16x32_bf16 v[64:67], v[232:235], v[168:171], v[64:67]
    ds_read_b64_tr_b16 v[230:231], v249 offset:896
    s_add_u32 m0, s74, 134528
    v_mfma_f32_16x16x32_bf16 v[68:71], v[232:235], v[172:175], v[68:71]
    ds_read_b64_tr_b16 v[232:233], v252 offset:416
    buffer_load_dwordx4 v253, s[36:39], 0 offen offset:640 lds
    s_waitcnt lgkmcnt(7)
    v_mfma_f32_16x16x32_bf16 v[72:75], v[236:239], v[168:171], v[72:75]
    ds_read_b64_tr_b16 v[234:235], v252 offset:928
    s_add_u32 m0, s74, 135552
    v_mfma_f32_16x16x32_bf16 v[76:79], v[236:239], v[172:175], v[76:79]
    ds_read_b64_tr_b16 v[236:237], v249 offset:448
    buffer_load_dwordx4 v251, s[36:39], 0 offen offset:640 lds
    s_waitcnt lgkmcnt(7)
    v_mfma_f32_16x16x32_bf16 v[80:83], v[240:243], v[168:171], v[80:83]
    ds_read_b64_tr_b16 v[238:239], v249 offset:960
    s_add_u32 m0, s74, 136576
    v_mfma_f32_16x16x32_bf16 v[84:87], v[240:243], v[172:175], v[84:87]
    ds_read_b64_tr_b16 v[240:241], v252 offset:480
    buffer_load_dwordx4 v253, s[36:39], s72 offen offset:640 lds
    s_waitcnt lgkmcnt(7)
    v_mfma_f32_16x16x32_bf16 v[88:91], v[224:227], v[168:171], v[88:91]
    ds_read_b64_tr_b16 v[242:243], v252 offset:992
    s_add_u32 m0, s74, 137600
    v_mfma_f32_16x16x32_bf16 v[92:95], v[224:227], v[172:175], v[92:95]
    v_add_u32 v249, 0x4200, v249
    v_add_u32 v252, 0x4200, v252
    ds_read_b64_tr_b16 v[224:225], v249 offset:0
    buffer_load_dwordx4 v251, s[36:39], s72 offen offset:640 lds
    s_waitcnt lgkmcnt(7)
    v_mfma_f32_16x16x32_bf16 v[96:99], v[228:231], v[168:171], v[96:99]
    ds_read_b64_tr_b16 v[226:227], v249 offset:512
    v_mfma_f32_16x16x32_bf16 v[100:103], v[228:231], v[172:175], v[100:103]
    ds_read_b64_tr_b16 v[228:229], v252 offset:32
    s_waitcnt lgkmcnt(7)
    v_mfma_f32_16x16x32_bf16 v[104:107], v[232:235], v[168:171], v[104:107]
    ds_read_b64_tr_b16 v[230:231], v252 offset:544
    v_mfma_f32_16x16x32_bf16 v[108:111], v[232:235], v[172:175], v[108:111]
    ds_read_b64_tr_b16 v[232:233], v249 offset:64
    s_waitcnt lgkmcnt(7)
    v_mfma_f32_16x16x32_bf16 v[112:115], v[236:239], v[168:171], v[112:115]
    ds_read_b64_tr_b16 v[234:235], v249 offset:576
    v_mfma_f32_16x16x32_bf16 v[116:119], v[236:239], v[172:175], v[116:119]
    ds_read_b64_tr_b16 v[236:237], v252 offset:96
    s_waitcnt lgkmcnt(7)
    v_mfma_f32_16x16x32_bf16 v[120:123], v[240:243], v[168:171], v[120:123]
    ds_read_b64_tr_b16 v[238:239], v252 offset:608
    v_mfma_f32_16x16x32_bf16 v[124:127], v[240:243], v[172:175], v[124:127]
    ds_read_b64_tr_b16 v[240:241], v249 offset:128
    s_barrier
    s_waitcnt lgkmcnt(7)
    v_mfma_f32_16x16x32_bf16 v[0:3], v[224:227], v[176:179], v[0:3]
    ds_read_b64_tr_b16 v[242:243], v249 offset:640
    v_mfma_f32_16x16x32_bf16 v[4:7], v[224:227], v[180:183], v[4:7]
    ds_read_b64_tr_b16 v[244:245], v252 offset:160
    s_waitcnt lgkmcnt(7)
    v_mfma_f32_16x16x32_bf16 v[8:11], v[228:231], v[176:179], v[8:11]
    ds_read_b64_tr_b16 v[246:247], v252 offset:672
    v_mfma_f32_16x16x32_bf16 v[12:15], v[228:231], v[180:183], v[12:15]
    ds_read_b64_tr_b16 v[224:225], v249 offset:192
    s_waitcnt lgkmcnt(7)
    v_mfma_f32_16x16x32_bf16 v[16:19], v[232:235], v[176:179], v[16:19]
    ds_read_b64_tr_b16 v[226:227], v249 offset:704
    v_mfma_f32_16x16x32_bf16 v[20:23], v[232:235], v[180:183], v[20:23]
    ds_read_b64_tr_b16 v[228:229], v252 offset:224
    s_waitcnt lgkmcnt(7)
    v_mfma_f32_16x16x32_bf16 v[24:27], v[236:239], v[176:179], v[24:27]
    ds_read_b64_tr_b16 v[230:231], v252 offset:736
    v_mfma_f32_16x16x32_bf16 v[28:31], v[236:239], v[180:183], v[28:31]
    ds_read_b64_tr_b16 v[232:233], v249 offset:256
    s_waitcnt lgkmcnt(7)
    v_mfma_f32_16x16x32_bf16 v[32:35], v[240:243], v[176:179], v[32:35]
    ds_read_b64_tr_b16 v[234:235], v249 offset:768
    v_mfma_f32_16x16x32_bf16 v[36:39], v[240:243], v[180:183], v[36:39]
    ds_read_b64_tr_b16 v[236:237], v252 offset:288
    s_waitcnt lgkmcnt(7)
    v_mfma_f32_16x16x32_bf16 v[40:43], v[244:247], v[176:179], v[40:43]
    ds_read_b64_tr_b16 v[238:239], v252 offset:800
    v_mfma_f32_16x16x32_bf16 v[44:47], v[244:247], v[180:183], v[44:47]
    ds_read_b64_tr_b16 v[240:241], v249 offset:320
    s_waitcnt lgkmcnt(7)
    v_mfma_f32_16x16x32_bf16 v[48:51], v[224:227], v[176:179], v[48:51]
    ds_read_b64_tr_b16 v[242:243], v249 offset:832
    v_mfma_f32_16x16x32_bf16 v[52:55], v[224:227], v[180:183], v[52:55]
    ds_read_b64_tr_b16 v[224:225], v252 offset:352
    s_waitcnt lgkmcnt(7)
    v_mfma_f32_16x16x32_bf16 v[56:59], v[228:231], v[176:179], v[56:59]
    ds_read_b64_tr_b16 v[226:227], v252 offset:864
    v_mfma_f32_16x16x32_bf16 v[60:63], v[228:231], v[180:183], v[60:63]
    ds_read_b64_tr_b16 v[228:229], v249 offset:384
    s_waitcnt lgkmcnt(7)
    v_mfma_f32_16x16x32_bf16 v[64:67], v[232:235], v[176:179], v[64:67]
    ds_read_b64_tr_b16 v[230:231], v249 offset:896
    v_mfma_f32_16x16x32_bf16 v[68:71], v[232:235], v[180:183], v[68:71]
    ds_read_b64_tr_b16 v[232:233], v252 offset:416
    s_waitcnt lgkmcnt(7)
    v_mfma_f32_16x16x32_bf16 v[72:75], v[236:239], v[176:179], v[72:75]
    ds_read_b64_tr_b16 v[234:235], v252 offset:928
    v_mfma_f32_16x16x32_bf16 v[76:79], v[236:239], v[180:183], v[76:79]
    ds_read_b64_tr_b16 v[236:237], v249 offset:448
    s_waitcnt lgkmcnt(7)
    v_mfma_f32_16x16x32_bf16 v[80:83], v[240:243], v[176:179], v[80:83]
    ds_read_b64_tr_b16 v[238:239], v249 offset:960
    v_mfma_f32_16x16x32_bf16 v[84:87], v[240:243], v[180:183], v[84:87]
    ds_read_b64_tr_b16 v[240:241], v252 offset:480
    s_waitcnt lgkmcnt(7)
    v_mfma_f32_16x16x32_bf16 v[88:91], v[224:227], v[176:179], v[88:91]
    ds_read_b64_tr_b16 v[242:243], v252 offset:992
    v_mfma_f32_16x16x32_bf16 v[92:95], v[224:227], v[180:183], v[92:95]
    v_add_u32 v249, 0x4200, v249
    v_add_u32 v252, 0x4200, v252
    ds_read_b64_tr_b16 v[224:225], v249 offset:0
    s_waitcnt lgkmcnt(7)
    v_mfma_f32_16x16x32_bf16 v[96:99], v[228:231], v[176:179], v[96:99]
    ds_read_b64_tr_b16 v[226:227], v249 offset:512
    v_mfma_f32_16x16x32_bf16 v[100:103], v[228:231], v[180:183], v[100:103]
    ds_read_b64_tr_b16 v[228:229], v252 offset:32
    s_waitcnt lgkmcnt(7)
    v_mfma_f32_16x16x32_bf16 v[104:107], v[232:235], v[176:179], v[104:107]
    ds_read_b64_tr_b16 v[230:231], v252 offset:544
    v_mfma_f32_16x16x32_bf16 v[108:111], v[232:235], v[180:183], v[108:111]
    ds_read_b64_tr_b16 v[232:233], v249 offset:64
    s_waitcnt lgkmcnt(7)
    v_mfma_f32_16x16x32_bf16 v[112:115], v[236:239], v[176:179], v[112:115]
    ds_read_b64_tr_b16 v[234:235], v249 offset:576
    v_mfma_f32_16x16x32_bf16 v[116:119], v[236:239], v[180:183], v[116:119]
    ds_read_b64_tr_b16 v[236:237], v252 offset:96
    s_waitcnt lgkmcnt(7)
    v_mfma_f32_16x16x32_bf16 v[120:123], v[240:243], v[176:179], v[120:123]
    ds_read_b64_tr_b16 v[238:239], v252 offset:608
    v_mfma_f32_16x16x32_bf16 v[124:127], v[240:243], v[180:183], v[124:127]
    ds_read_b64_tr_b16 v[240:241], v249 offset:128
    s_waitcnt lgkmcnt(7)
    v_mfma_f32_16x16x32_bf16 v[0:3], v[224:227], v[184:187], v[0:3]
    ds_read_b64_tr_b16 v[242:243], v249 offset:640
    v_mfma_f32_16x16x32_bf16 v[4:7], v[224:227], v[188:191], v[4:7]
    ds_read_b64_tr_b16 v[244:245], v252 offset:160
    s_waitcnt vmcnt(0)
    s_waitcnt lgkmcnt(7)
    v_mfma_f32_16x16x32_bf16 v[8:11], v[228:231], v[184:187], v[8:11]
    ds_read_b64_tr_b16 v[246:247], v252 offset:672
    ds_read_b128 v[192:195], v254 offset:33792
    v_mfma_f32_16x16x32_bf16 v[12:15], v[228:231], v[188:191], v[12:15]
    ds_read_b64_tr_b16 v[224:225], v249 offset:192
    s_waitcnt lgkmcnt(8)
    v_mfma_f32_16x16x32_bf16 v[16:19], v[232:235], v[184:187], v[16:19]
    ds_read_b64_tr_b16 v[226:227], v249 offset:704
    ds_read_b128 v[196:199], v254 offset:35840
    v_mfma_f32_16x16x32_bf16 v[20:23], v[232:235], v[188:191], v[20:23]
    ds_read_b64_tr_b16 v[228:229], v252 offset:224
    s_waitcnt lgkmcnt(9)
    v_mfma_f32_16x16x32_bf16 v[24:27], v[236:239], v[184:187], v[24:27]
    ds_read_b64_tr_b16 v[230:231], v252 offset:736
    ds_read_b128 v[200:203], v255 offset:33792
    v_mfma_f32_16x16x32_bf16 v[28:31], v[236:239], v[188:191], v[28:31]
    ds_read_b64_tr_b16 v[232:233], v249 offset:256
    s_waitcnt lgkmcnt(10)
    v_mfma_f32_16x16x32_bf16 v[32:35], v[240:243], v[184:187], v[32:35]
    ds_read_b64_tr_b16 v[234:235], v249 offset:768
    ds_read_b128 v[204:207], v255 offset:35840
    v_mfma_f32_16x16x32_bf16 v[36:39], v[240:243], v[188:191], v[36:39]
    ds_read_b64_tr_b16 v[236:237], v252 offset:288
    s_waitcnt lgkmcnt(11)
    v_mfma_f32_16x16x32_bf16 v[40:43], v[244:247], v[184:187], v[40:43]
    ds_read_b64_tr_b16 v[238:239], v252 offset:800
    v_mfma_f32_16x16x32_bf16 v[44:47], v[244:247], v[188:191], v[44:47]
    ds_read_b64_tr_b16 v[240:241], v249 offset:320
    s_waitcnt lgkmcnt(10)
    v_mfma_f32_16x16x32_bf16 v[48:51], v[224:227], v[184:187], v[48:51]
    ds_read_b64_tr_b16 v[242:243], v249 offset:832
    v_mfma_f32_16x16x32_bf16 v[52:55], v[224:227], v[188:191], v[52:55]
    ds_read_b64_tr_b16 v[224:225], v252 offset:352
    s_waitcnt lgkmcnt(9)
    v_mfma_f32_16x16x32_bf16 v[56:59], v[228:231], v[184:187], v[56:59]
    ds_read_b64_tr_b16 v[226:227], v252 offset:864
    v_mfma_f32_16x16x32_bf16 v[60:63], v[228:231], v[188:191], v[60:63]
    ds_read_b64_tr_b16 v[228:229], v249 offset:384
    s_waitcnt lgkmcnt(7)
    v_mfma_f32_16x16x32_bf16 v[64:67], v[232:235], v[184:187], v[64:67]
    ds_read_b64_tr_b16 v[230:231], v249 offset:896
    s_add_u32 m0, s74, 134400
    v_mfma_f32_16x16x32_bf16 v[68:71], v[232:235], v[188:191], v[68:71]
    ds_read_b64_tr_b16 v[232:233], v252 offset:416
    buffer_load_dwordx4 v253, s[36:39], 0 offen offset:768 lds
    s_waitcnt lgkmcnt(7)
    v_mfma_f32_16x16x32_bf16 v[72:75], v[236:239], v[184:187], v[72:75]
    ds_read_b64_tr_b16 v[234:235], v252 offset:928
    s_add_u32 m0, s74, 135424
    v_mfma_f32_16x16x32_bf16 v[76:79], v[236:239], v[188:191], v[76:79]
    ds_read_b64_tr_b16 v[236:237], v249 offset:448
    buffer_load_dwordx4 v251, s[36:39], 0 offen offset:768 lds
    s_waitcnt lgkmcnt(7)
    v_mfma_f32_16x16x32_bf16 v[80:83], v[240:243], v[184:187], v[80:83]
    ds_read_b64_tr_b16 v[238:239], v249 offset:960
    s_add_u32 m0, s74, 136448
    v_mfma_f32_16x16x32_bf16 v[84:87], v[240:243], v[188:191], v[84:87]
    ds_read_b64_tr_b16 v[240:241], v252 offset:480
    buffer_load_dwordx4 v253, s[36:39], s72 offen offset:768 lds
    s_waitcnt lgkmcnt(7)
    v_mfma_f32_16x16x32_bf16 v[88:91], v[224:227], v[184:187], v[88:91]
    ds_read_b64_tr_b16 v[242:243], v252 offset:992
    s_add_u32 m0, s74, 137472
    v_mfma_f32_16x16x32_bf16 v[92:95], v[224:227], v[188:191], v[92:95]
    v_add_u32 v249, 0xfffe3200, v249
    v_add_u32 v252, 0xfffe3200, v252
    ds_read_b64_tr_b16 v[224:225], v249 offset:0
    buffer_load_dwordx4 v251, s[36:39], s72 offen offset:768 lds
    s_waitcnt lgkmcnt(7)
    v_mfma_f32_16x16x32_bf16 v[96:99], v[228:231], v[184:187], v[96:99]
    ds_read_b64_tr_b16 v[226:227], v249 offset:512
    v_mfma_f32_16x16x32_bf16 v[100:103], v[228:231], v[188:191], v[100:103]
    ds_read_b64_tr_b16 v[228:229], v252 offset:32
    s_waitcnt lgkmcnt(7)
    v_mfma_f32_16x16x32_bf16 v[104:107], v[232:235], v[184:187], v[104:107]
    ds_read_b64_tr_b16 v[230:231], v252 offset:544
    v_mfma_f32_16x16x32_bf16 v[108:111], v[232:235], v[188:191], v[108:111]
    ds_read_b64_tr_b16 v[232:233], v249 offset:64
    s_waitcnt lgkmcnt(7)
    v_mfma_f32_16x16x32_bf16 v[112:115], v[236:239], v[184:187], v[112:115]
    ds_read_b64_tr_b16 v[234:235], v249 offset:576
    v_mfma_f32_16x16x32_bf16 v[116:119], v[236:239], v[188:191], v[116:119]
    ds_read_b64_tr_b16 v[236:237], v252 offset:96
    s_waitcnt lgkmcnt(7)
    v_mfma_f32_16x16x32_bf16 v[120:123], v[240:243], v[184:187], v[120:123]
    ds_read_b64_tr_b16 v[238:239], v252 offset:608
    v_mfma_f32_16x16x32_bf16 v[124:127], v[240:243], v[188:191], v[124:127]
    ds_read_b64_tr_b16 v[240:241], v249 offset:128
    s_barrier
    s_waitcnt lgkmcnt(7)
    v_mfma_f32_16x16x32_bf16 v[0:3], v[224:227], v[128:131], v[0:3]
    ds_read_b64_tr_b16 v[242:243], v249 offset:640
    v_mfma_f32_16x16x32_bf16 v[4:7], v[224:227], v[132:135], v[4:7]
    ds_read_b64_tr_b16 v[244:245], v252 offset:160
    s_waitcnt lgkmcnt(7)
    v_mfma_f32_16x16x32_bf16 v[8:11], v[228:231], v[128:131], v[8:11]
    ds_read_b64_tr_b16 v[246:247], v252 offset:672
    v_mfma_f32_16x16x32_bf16 v[12:15], v[228:231], v[132:135], v[12:15]
    ds_read_b64_tr_b16 v[224:225], v249 offset:192
    s_waitcnt lgkmcnt(7)
    v_mfma_f32_16x16x32_bf16 v[16:19], v[232:235], v[128:131], v[16:19]
    ds_read_b64_tr_b16 v[226:227], v249 offset:704
    v_mfma_f32_16x16x32_bf16 v[20:23], v[232:235], v[132:135], v[20:23]
    ds_read_b64_tr_b16 v[228:229], v252 offset:224
    s_waitcnt lgkmcnt(7)
    v_mfma_f32_16x16x32_bf16 v[24:27], v[236:239], v[128:131], v[24:27]
    ds_read_b64_tr_b16 v[230:231], v252 offset:736
    v_mfma_f32_16x16x32_bf16 v[28:31], v[236:239], v[132:135], v[28:31]
    ds_read_b64_tr_b16 v[232:233], v249 offset:256
    s_waitcnt lgkmcnt(7)
    v_mfma_f32_16x16x32_bf16 v[32:35], v[240:243], v[128:131], v[32:35]
    ds_read_b64_tr_b16 v[234:235], v249 offset:768
    v_mfma_f32_16x16x32_bf16 v[36:39], v[240:243], v[132:135], v[36:39]
    ds_read_b64_tr_b16 v[236:237], v252 offset:288
    s_waitcnt lgkmcnt(7)
    v_mfma_f32_16x16x32_bf16 v[40:43], v[244:247], v[128:131], v[40:43]
    ds_read_b64_tr_b16 v[238:239], v252 offset:800
    v_mfma_f32_16x16x32_bf16 v[44:47], v[244:247], v[132:135], v[44:47]
    ds_read_b64_tr_b16 v[240:241], v249 offset:320
    s_waitcnt lgkmcnt(7)
    v_mfma_f32_16x16x32_bf16 v[48:51], v[224:227], v[128:131], v[48:51]
    ds_read_b64_tr_b16 v[242:243], v249 offset:832
    v_mfma_f32_16x16x32_bf16 v[52:55], v[224:227], v[132:135], v[52:55]
    ds_read_b64_tr_b16 v[224:225], v252 offset:352
    s_waitcnt lgkmcnt(7)
    v_mfma_f32_16x16x32_bf16 v[56:59], v[228:231], v[128:131], v[56:59]
    ds_read_b64_tr_b16 v[226:227], v252 offset:864
    v_mfma_f32_16x16x32_bf16 v[60:63], v[228:231], v[132:135], v[60:63]
    ds_read_b64_tr_b16 v[228:229], v249 offset:384
    s_waitcnt lgkmcnt(7)
    v_mfma_f32_16x16x32_bf16 v[64:67], v[232:235], v[128:131], v[64:67]
    ds_read_b64_tr_b16 v[230:231], v249 offset:896
    v_mfma_f32_16x16x32_bf16 v[68:71], v[232:235], v[132:135], v[68:71]
    ds_read_b64_tr_b16 v[232:233], v252 offset:416
    s_waitcnt lgkmcnt(7)
    v_mfma_f32_16x16x32_bf16 v[72:75], v[236:239], v[128:131], v[72:75]
    ds_read_b64_tr_b16 v[234:235], v252 offset:928
    v_mfma_f32_16x16x32_bf16 v[76:79], v[236:239], v[132:135], v[76:79]
    ds_read_b64_tr_b16 v[236:237], v249 offset:448
    s_waitcnt lgkmcnt(7)
    v_mfma_f32_16x16x32_bf16 v[80:83], v[240:243], v[128:131], v[80:83]
    ds_read_b64_tr_b16 v[238:239], v249 offset:960
    v_mfma_f32_16x16x32_bf16 v[84:87], v[240:243], v[132:135], v[84:87]
    ds_read_b64_tr_b16 v[240:241], v252 offset:480
    s_waitcnt lgkmcnt(7)
    v_mfma_f32_16x16x32_bf16 v[88:91], v[224:227], v[128:131], v[88:91]
    ds_read_b64_tr_b16 v[242:243], v252 offset:992
    v_mfma_f32_16x16x32_bf16 v[92:95], v[224:227], v[132:135], v[92:95]
    v_add_u32 v249, 0x4200, v249
    v_add_u32 v252, 0x4200, v252
    ds_read_b64_tr_b16 v[224:225], v249 offset:0
    s_waitcnt lgkmcnt(7)
    v_mfma_f32_16x16x32_bf16 v[96:99], v[228:231], v[128:131], v[96:99]
    ds_read_b64_tr_b16 v[226:227], v249 offset:512
    v_mfma_f32_16x16x32_bf16 v[100:103], v[228:231], v[132:135], v[100:103]
    ds_read_b64_tr_b16 v[228:229], v252 offset:32
    s_waitcnt lgkmcnt(7)
    v_mfma_f32_16x16x32_bf16 v[104:107], v[232:235], v[128:131], v[104:107]
    ds_read_b64_tr_b16 v[230:231], v252 offset:544
    v_mfma_f32_16x16x32_bf16 v[108:111], v[232:235], v[132:135], v[108:111]
    ds_read_b64_tr_b16 v[232:233], v249 offset:64
    s_waitcnt lgkmcnt(7)
    v_mfma_f32_16x16x32_bf16 v[112:115], v[236:239], v[128:131], v[112:115]
    ds_read_b64_tr_b16 v[234:235], v249 offset:576
    v_mfma_f32_16x16x32_bf16 v[116:119], v[236:239], v[132:135], v[116:119]
    ds_read_b64_tr_b16 v[236:237], v252 offset:96
    s_waitcnt lgkmcnt(7)
    v_mfma_f32_16x16x32_bf16 v[120:123], v[240:243], v[128:131], v[120:123]
    ds_read_b64_tr_b16 v[238:239], v252 offset:608
    v_mfma_f32_16x16x32_bf16 v[124:127], v[240:243], v[132:135], v[124:127]
    ds_read_b64_tr_b16 v[240:241], v249 offset:128
    s_waitcnt lgkmcnt(7)
    v_mfma_f32_16x16x32_bf16 v[0:3], v[224:227], v[136:139], v[0:3]
    ds_read_b64_tr_b16 v[242:243], v249 offset:640
    v_mfma_f32_16x16x32_bf16 v[4:7], v[224:227], v[140:143], v[4:7]
    ds_read_b64_tr_b16 v[244:245], v252 offset:160
    s_waitcnt vmcnt(0)
    s_waitcnt lgkmcnt(7)
    v_mfma_f32_16x16x32_bf16 v[8:11], v[228:231], v[136:139], v[8:11]
    ds_read_b64_tr_b16 v[246:247], v252 offset:672
    ds_read_b128 v[208:211], v254 offset:33792
    v_mfma_f32_16x16x32_bf16 v[12:15], v[228:231], v[140:143], v[12:15]
    ds_read_b64_tr_b16 v[224:225], v249 offset:192
    s_waitcnt lgkmcnt(8)
    v_mfma_f32_16x16x32_bf16 v[16:19], v[232:235], v[136:139], v[16:19]
    ds_read_b64_tr_b16 v[226:227], v249 offset:704
    ds_read_b128 v[212:215], v254 offset:35840
    v_mfma_f32_16x16x32_bf16 v[20:23], v[232:235], v[140:143], v[20:23]
    ds_read_b64_tr_b16 v[228:229], v252 offset:224
    s_waitcnt lgkmcnt(9)
    v_mfma_f32_16x16x32_bf16 v[24:27], v[236:239], v[136:139], v[24:27]
    ds_read_b64_tr_b16 v[230:231], v252 offset:736
    ds_read_b128 v[216:219], v255 offset:33792
    v_mfma_f32_16x16x32_bf16 v[28:31], v[236:239], v[140:143], v[28:31]
    ds_read_b64_tr_b16 v[232:233], v249 offset:256
    s_waitcnt lgkmcnt(10)
    v_mfma_f32_16x16x32_bf16 v[32:35], v[240:243], v[136:139], v[32:35]
    ds_read_b64_tr_b16 v[234:235], v249 offset:768
    ds_read_b128 v[220:223], v255 offset:35840
    v_mfma_f32_16x16x32_bf16 v[36:39], v[240:243], v[140:143], v[36:39]
    ds_read_b64_tr_b16 v[236:237], v252 offset:288
    s_waitcnt lgkmcnt(11)
    v_mfma_f32_16x16x32_bf16 v[40:43], v[244:247], v[136:139], v[40:43]
    ds_read_b64_tr_b16 v[238:239], v252 offset:800
    v_mfma_f32_16x16x32_bf16 v[44:47], v[244:247], v[140:143], v[44:47]
    ds_read_b64_tr_b16 v[240:241], v249 offset:320
    s_waitcnt lgkmcnt(10)
    v_mfma_f32_16x16x32_bf16 v[48:51], v[224:227], v[136:139], v[48:51]
    ds_read_b64_tr_b16 v[242:243], v249 offset:832
    v_mfma_f32_16x16x32_bf16 v[52:55], v[224:227], v[140:143], v[52:55]
    ds_read_b64_tr_b16 v[224:225], v252 offset:352
    s_waitcnt lgkmcnt(9)
    v_mfma_f32_16x16x32_bf16 v[56:59], v[228:231], v[136:139], v[56:59]
    ds_read_b64_tr_b16 v[226:227], v252 offset:864
    v_mfma_f32_16x16x32_bf16 v[60:63], v[228:231], v[140:143], v[60:63]
    ds_read_b64_tr_b16 v[228:229], v249 offset:384
    s_waitcnt lgkmcnt(7)
    v_mfma_f32_16x16x32_bf16 v[64:67], v[232:235], v[136:139], v[64:67]
    ds_read_b64_tr_b16 v[230:231], v249 offset:896
    v_mfma_f32_16x16x32_bf16 v[68:71], v[232:235], v[140:143], v[68:71]
    ds_read_b64_tr_b16 v[232:233], v252 offset:416
    s_waitcnt lgkmcnt(7)
    v_mfma_f32_16x16x32_bf16 v[72:75], v[236:239], v[136:139], v[72:75]
    ds_read_b64_tr_b16 v[234:235], v252 offset:928
    v_mfma_f32_16x16x32_bf16 v[76:79], v[236:239], v[140:143], v[76:79]
    ds_read_b64_tr_b16 v[236:237], v249 offset:448
    s_waitcnt lgkmcnt(7)
    v_mfma_f32_16x16x32_bf16 v[80:83], v[240:243], v[136:139], v[80:83]
    ds_read_b64_tr_b16 v[238:239], v249 offset:960
    v_mfma_f32_16x16x32_bf16 v[84:87], v[240:243], v[140:143], v[84:87]
    ds_read_b64_tr_b16 v[240:241], v252 offset:480
    s_waitcnt lgkmcnt(7)
    v_mfma_f32_16x16x32_bf16 v[88:91], v[224:227], v[136:139], v[88:91]
    ds_read_b64_tr_b16 v[242:243], v252 offset:992
    v_mfma_f32_16x16x32_bf16 v[92:95], v[224:227], v[140:143], v[92:95]
    v_add_u32 v249, 0x4200, v249
    v_add_u32 v252, 0x4200, v252
    ds_read_b64_tr_b16 v[224:225], v249 offset:0
    s_waitcnt lgkmcnt(7)
    v_mfma_f32_16x16x32_bf16 v[96:99], v[228:231], v[136:139], v[96:99]
    ds_read_b64_tr_b16 v[226:227], v249 offset:256
    v_mfma_f32_16x16x32_bf16 v[100:103], v[228:231], v[140:143], v[100:103]
    ds_read_b64_tr_b16 v[228:229], v249 offset:512
    s_waitcnt lgkmcnt(7)
    v_mfma_f32_16x16x32_bf16 v[104:107], v[232:235], v[136:139], v[104:107]
    ds_read_b64_tr_b16 v[230:231], v249 offset:768
    v_mfma_f32_16x16x32_bf16 v[108:111], v[232:235], v[140:143], v[108:111]
    ds_read_b64_tr_b16 v[232:233], v249 offset:16896
    s_waitcnt lgkmcnt(7)
    v_mfma_f32_16x16x32_bf16 v[112:115], v[236:239], v[136:139], v[112:115]
    ds_read_b64_tr_b16 v[234:235], v249 offset:17152
    v_mfma_f32_16x16x32_bf16 v[116:119], v[236:239], v[140:143], v[116:119]
    ds_read_b64_tr_b16 v[236:237], v249 offset:17408
    s_waitcnt lgkmcnt(7)
    v_mfma_f32_16x16x32_bf16 v[120:123], v[240:243], v[136:139], v[120:123]
    ds_read_b64_tr_b16 v[238:239], v249 offset:17664
    v_mfma_f32_16x16x32_bf16 v[124:127], v[240:243], v[140:143], v[124:127]
    ds_read_b64_tr_b16 v[240:241], v252 offset:32
    s_barrier
    s_waitcnt lgkmcnt(7)
    v_mfma_f32_16x16x32_bf16 v[0:3], v[224:227], v[192:195], v[0:3]
    ds_read_b64_tr_b16 v[242:243], v252 offset:288
    v_mfma_f32_16x16x32_bf16 v[4:7], v[224:227], v[196:199], v[4:7]
    ds_read_b64_tr_b16 v[244:245], v252 offset:544
    s_waitcnt lgkmcnt(7)
    v_mfma_f32_16x16x32_bf16 v[0:3], v[228:231], v[200:203], v[0:3]
    ds_read_b64_tr_b16 v[246:247], v252 offset:800
    v_mfma_f32_16x16x32_bf16 v[4:7], v[228:231], v[204:207], v[4:7]
    ds_read_b64_tr_b16 v[224:225], v252 offset:16928
    s_waitcnt lgkmcnt(7)
    v_mfma_f32_16x16x32_bf16 v[0:3], v[232:235], v[208:211], v[0:3]
    ds_read_b64_tr_b16 v[226:227], v252 offset:17184
    v_mfma_f32_16x16x32_bf16 v[4:7], v[232:235], v[212:215], v[4:7]
    ds_read_b64_tr_b16 v[228:229], v252 offset:17440
    s_waitcnt lgkmcnt(7)
    v_mfma_f32_16x16x32_bf16 v[0:3], v[236:239], v[216:219], v[0:3]
    ds_read_b64_tr_b16 v[230:231], v252 offset:17696
    v_mfma_f32_16x16x32_bf16 v[4:7], v[236:239], v[220:223], v[4:7]
    ds_read_b64_tr_b16 v[232:233], v249 offset:64
    s_waitcnt lgkmcnt(7)
    v_mfma_f32_16x16x32_bf16 v[8:11], v[240:243], v[192:195], v[8:11]
    ds_read_b64_tr_b16 v[234:235], v249 offset:320
    v_mfma_f32_16x16x32_bf16 v[12:15], v[240:243], v[196:199], v[12:15]
    ds_read_b64_tr_b16 v[236:237], v249 offset:576
    s_waitcnt lgkmcnt(7)
    v_mfma_f32_16x16x32_bf16 v[8:11], v[244:247], v[200:203], v[8:11]
    ds_read_b64_tr_b16 v[238:239], v249 offset:832
    v_mfma_f32_16x16x32_bf16 v[12:15], v[244:247], v[204:207], v[12:15]
    ds_read_b64_tr_b16 v[240:241], v249 offset:16960
    s_waitcnt lgkmcnt(7)
    v_mfma_f32_16x16x32_bf16 v[8:11], v[224:227], v[208:211], v[8:11]
    ds_read_b64_tr_b16 v[242:243], v249 offset:17216
    v_mfma_f32_16x16x32_bf16 v[12:15], v[224:227], v[212:215], v[12:15]
    ds_read_b64_tr_b16 v[224:225], v249 offset:17472
    s_waitcnt lgkmcnt(7)
    v_mfma_f32_16x16x32_bf16 v[8:11], v[228:231], v[216:219], v[8:11]
    ds_read_b64_tr_b16 v[226:227], v249 offset:17728
    v_mfma_f32_16x16x32_bf16 v[12:15], v[228:231], v[220:223], v[12:15]
    ds_read_b64_tr_b16 v[228:229], v252 offset:96
    s_waitcnt lgkmcnt(7)
    v_mfma_f32_16x16x32_bf16 v[16:19], v[232:235], v[192:195], v[16:19]
    ds_read_b64_tr_b16 v[230:231], v252 offset:352
    v_mfma_f32_16x16x32_bf16 v[20:23], v[232:235], v[196:199], v[20:23]
    ds_read_b64_tr_b16 v[232:233], v252 offset:608
    s_waitcnt lgkmcnt(7)
    v_mfma_f32_16x16x32_bf16 v[16:19], v[236:239], v[200:203], v[16:19]
    ds_read_b64_tr_b16 v[234:235], v252 offset:864
    v_mfma_f32_16x16x32_bf16 v[20:23], v[236:239], v[204:207], v[20:23]
    v_mul_f32 v0, v250, v0
    v_mul_f32 v1, v250, v1
    ds_read_b64_tr_b16 v[236:237], v252 offset:16992
    s_waitcnt lgkmcnt(7)
    v_mfma_f32_16x16x32_bf16 v[16:19], v[240:243], v[208:211], v[16:19]
    v_mul_f32 v2, v250, v2
    v_mul_f32 v3, v250, v3
    ds_read_b64_tr_b16 v[238:239], v252 offset:17248
    v_mfma_f32_16x16x32_bf16 v[20:23], v[240:243], v[212:215], v[20:23]
    v_mul_f32 v4, v250, v4
    v_mul_f32 v5, v250, v5
    ds_read_b64_tr_b16 v[240:241], v252 offset:17504
    s_waitcnt lgkmcnt(7)
    v_mfma_f32_16x16x32_bf16 v[16:19], v[224:227], v[216:219], v[16:19]
    v_mul_f32 v6, v250, v6
    v_mul_f32 v7, v250, v7
    ds_read_b64_tr_b16 v[242:243], v252 offset:17760
    v_mfma_f32_16x16x32_bf16 v[20:23], v[224:227], v[220:223], v[20:23]
    v_cvt_pk_bf16_f32 v128, v0, v1
    v_cvt_pk_bf16_f32 v129, v2, v3
    ds_read_b64_tr_b16 v[224:225], v249 offset:128
    s_waitcnt lgkmcnt(7)
    v_mfma_f32_16x16x32_bf16 v[24:27], v[228:231], v[192:195], v[24:27]
    v_mul_f32 v8, v250, v8
    v_mul_f32 v9, v250, v9
    ds_read_b64_tr_b16 v[226:227], v249 offset:384
    v_mfma_f32_16x16x32_bf16 v[28:31], v[228:231], v[196:199], v[28:31]
    v_mul_f32 v10, v250, v10
    v_mul_f32 v11, v250, v11
    ds_read_b64_tr_b16 v[228:229], v249 offset:640
    s_waitcnt lgkmcnt(7)
    v_mfma_f32_16x16x32_bf16 v[24:27], v[232:235], v[200:203], v[24:27]
    v_cvt_pk_bf16_f32 v160, v4, v5
    v_cvt_pk_bf16_f32 v161, v6, v7
    ds_read_b64_tr_b16 v[230:231], v249 offset:896
    v_mfma_f32_16x16x32_bf16 v[28:31], v[232:235], v[204:207], v[28:31]
    v_mul_f32 v12, v250, v12
    v_mul_f32 v13, v250, v13
    ds_read_b64_tr_b16 v[232:233], v249 offset:17024
    s_waitcnt lgkmcnt(7)
    v_mfma_f32_16x16x32_bf16 v[24:27], v[236:239], v[208:211], v[24:27]
    v_mul_f32 v14, v250, v14
    v_mul_f32 v15, v250, v15
    ds_read_b64_tr_b16 v[234:235], v249 offset:17280
    v_mfma_f32_16x16x32_bf16 v[28:31], v[236:239], v[212:215], v[28:31]
    v_cvt_pk_bf16_f32 v130, v8, v9
    v_cvt_pk_bf16_f32 v131, v10, v11
    ds_read_b64_tr_b16 v[236:237], v249 offset:17536
    s_waitcnt lgkmcnt(7)
    v_mfma_f32_16x16x32_bf16 v[24:27], v[240:243], v[216:219], v[24:27]
    v_cvt_pk_bf16_f32 v162, v12, v13
    v_cvt_pk_bf16_f32 v163, v14, v15
    ds_read_b64_tr_b16 v[238:239], v249 offset:17792
    v_mfma_f32_16x16x32_bf16 v[28:31], v[240:243], v[220:223], v[28:31]
    v_permlane16_swap_b32 v128, v130
    ds_read_b64_tr_b16 v[240:241], v252 offset:160
    s_waitcnt lgkmcnt(7)
    v_mfma_f32_16x16x32_bf16 v[32:35], v[224:227], v[192:195], v[32:35]
    v_permlane16_swap_b32 v129, v131
    ds_read_b64_tr_b16 v[242:243], v252 offset:416
    v_mfma_f32_16x16x32_bf16 v[36:39], v[224:227], v[196:199], v[36:39]
    v_permlane16_swap_b32 v160, v162
    ds_read_b64_tr_b16 v[244:245], v252 offset:672
    s_waitcnt lgkmcnt(7)
    v_mfma_f32_16x16x32_bf16 v[32:35], v[228:231], v[200:203], v[32:35]
    v_permlane16_swap_b32 v161, v163
    ds_read_b64_tr_b16 v[246:247], v252 offset:928
    v_mfma_f32_16x16x32_bf16 v[36:39], v[228:231], v[204:207], v[36:39]
    v_mul_f32 v16, v250, v16
    v_mul_f32 v17, v250, v17
    ds_read_b64_tr_b16 v[224:225], v252 offset:17056
    s_waitcnt lgkmcnt(7)
    v_mfma_f32_16x16x32_bf16 v[32:35], v[232:235], v[208:211], v[32:35]
    v_mul_f32 v18, v250, v18
    v_mul_f32 v19, v250, v19
    ds_read_b64_tr_b16 v[226:227], v252 offset:17312
    v_mfma_f32_16x16x32_bf16 v[36:39], v[232:235], v[212:215], v[36:39]
    v_mul_f32 v20, v250, v20
    v_mul_f32 v21, v250, v21
    ds_read_b64_tr_b16 v[228:229], v252 offset:17568
    s_waitcnt lgkmcnt(7)
    v_mfma_f32_16x16x32_bf16 v[32:35], v[236:239], v[216:219], v[32:35]
    v_mul_f32 v22, v250, v22
    v_mul_f32 v23, v250, v23
    ds_read_b64_tr_b16 v[230:231], v252 offset:17824
    v_mfma_f32_16x16x32_bf16 v[36:39], v[236:239], v[220:223], v[36:39]
    v_cvt_pk_bf16_f32 v132, v16, v17
    v_cvt_pk_bf16_f32 v133, v18, v19
    ds_read_b64_tr_b16 v[232:233], v249 offset:192
    s_waitcnt lgkmcnt(7)
    v_mfma_f32_16x16x32_bf16 v[40:43], v[240:243], v[192:195], v[40:43]
    v_mul_f32 v24, v250, v24
    v_mul_f32 v25, v250, v25
    ds_read_b64_tr_b16 v[234:235], v249 offset:448
    v_mfma_f32_16x16x32_bf16 v[44:47], v[240:243], v[196:199], v[44:47]
    v_mul_f32 v26, v250, v26
    v_mul_f32 v27, v250, v27
    ds_read_b64_tr_b16 v[236:237], v249 offset:704
    s_waitcnt lgkmcnt(7)
    v_mfma_f32_16x16x32_bf16 v[40:43], v[244:247], v[200:203], v[40:43]
    v_cvt_pk_bf16_f32 v164, v20, v21
    v_cvt_pk_bf16_f32 v165, v22, v23
    ds_read_b64_tr_b16 v[238:239], v249 offset:960
    v_mfma_f32_16x16x32_bf16 v[44:47], v[244:247], v[204:207], v[44:47]
    v_mul_f32 v28, v250, v28
    v_mul_f32 v29, v250, v29
    ds_read_b64_tr_b16 v[240:241], v249 offset:17088
    s_waitcnt lgkmcnt(7)
    v_mfma_f32_16x16x32_bf16 v[40:43], v[224:227], v[208:211], v[40:43]
    v_mul_f32 v30, v250, v30
    v_mul_f32 v31, v250, v31
    ds_read_b64_tr_b16 v[242:243], v249 offset:17344
    v_mfma_f32_16x16x32_bf16 v[44:47], v[224:227], v[212:215], v[44:47]
    v_cvt_pk_bf16_f32 v134, v24, v25
    v_cvt_pk_bf16_f32 v135, v26, v27
    ds_read_b64_tr_b16 v[224:225], v249 offset:17600
    s_waitcnt lgkmcnt(7)
    v_mfma_f32_16x16x32_bf16 v[40:43], v[228:231], v[216:219], v[40:43]
    v_cvt_pk_bf16_f32 v166, v28, v29
    v_cvt_pk_bf16_f32 v167, v30, v31
    ds_read_b64_tr_b16 v[226:227], v249 offset:17856
    v_mfma_f32_16x16x32_bf16 v[44:47], v[228:231], v[220:223], v[44:47]
    v_permlane16_swap_b32 v132, v134
    ds_read_b64_tr_b16 v[228:229], v252 offset:224
    s_waitcnt lgkmcnt(7)
    v_mfma_f32_16x16x32_bf16 v[48:51], v[232:235], v[192:195], v[48:51]
    v_permlane16_swap_b32 v133, v135
    ds_read_b64_tr_b16 v[230:231], v252 offset:480
    v_mfma_f32_16x16x32_bf16 v[52:55], v[232:235], v[196:199], v[52:55]
    v_permlane16_swap_b32 v164, v166
    ds_read_b64_tr_b16 v[232:233], v252 offset:736
    s_waitcnt lgkmcnt(7)
    v_mfma_f32_16x16x32_bf16 v[48:51], v[236:239], v[200:203], v[48:51]
    v_permlane16_swap_b32 v165, v167
    ds_read_b64_tr_b16 v[234:235], v252 offset:992
    v_mfma_f32_16x16x32_bf16 v[52:55], v[236:239], v[204:207], v[52:55]
    v_mul_f32 v32, v250, v32
    v_mul_f32 v33, v250, v33
    ds_read_b64_tr_b16 v[236:237], v252 offset:17120
    s_waitcnt lgkmcnt(7)
    v_mfma_f32_16x16x32_bf16 v[48:51], v[240:243], v[208:211], v[48:51]
    v_mul_f32 v34, v250, v34
    v_mul_f32 v35, v250, v35
    ds_read_b64_tr_b16 v[238:239], v252 offset:17376
    v_mfma_f32_16x16x32_bf16 v[52:55], v[240:243], v[212:215], v[52:55]
    v_mul_f32 v36, v250, v36
    v_mul_f32 v37, v250, v37
    ds_read_b64_tr_b16 v[240:241], v252 offset:17632
    s_waitcnt lgkmcnt(7)
    v_mfma_f32_16x16x32_bf16 v[48:51], v[224:227], v[216:219], v[48:51]
    v_mul_f32 v38, v250, v38
    v_mul_f32 v39, v250, v39
    ds_read_b64_tr_b16 v[242:243], v252 offset:17888
    v_mfma_f32_16x16x32_bf16 v[52:55], v[224:227], v[220:223], v[52:55]
    v_cvt_pk_bf16_f32 v136, v32, v33
    v_cvt_pk_bf16_f32 v137, v34, v35
    v_add_u32 v249, 0x8400, v249
    v_add_u32 v252, 0x8400, v252
    ds_read_b64_tr_b16 v[224:225], v249 offset:0
    s_waitcnt lgkmcnt(7)
    v_mfma_f32_16x16x32_bf16 v[56:59], v[228:231], v[192:195], v[56:59]
    v_mul_f32 v40, v250, v40
    v_mul_f32 v41, v250, v41
    ds_read_b64_tr_b16 v[226:227], v249 offset:256
    v_mfma_f32_16x16x32_bf16 v[60:63], v[228:231], v[196:199], v[60:63]
    v_mul_f32 v42, v250, v42
    v_mul_f32 v43, v250, v43
    ds_read_b64_tr_b16 v[228:229], v249 offset:512
    s_waitcnt lgkmcnt(7)
    v_mfma_f32_16x16x32_bf16 v[56:59], v[232:235], v[200:203], v[56:59]
    v_cvt_pk_bf16_f32 v168, v36, v37
    v_cvt_pk_bf16_f32 v169, v38, v39
    ds_read_b64_tr_b16 v[230:231], v249 offset:768
    v_mfma_f32_16x16x32_bf16 v[60:63], v[232:235], v[204:207], v[60:63]
    v_mul_f32 v44, v250, v44
    v_mul_f32 v45, v250, v45
    ds_read_b64_tr_b16 v[232:233], v249 offset:16896
    s_waitcnt lgkmcnt(7)
    v_mfma_f32_16x16x32_bf16 v[56:59], v[236:239], v[208:211], v[56:59]
    v_mul_f32 v46, v250, v46
    v_mul_f32 v47, v250, v47
    ds_read_b64_tr_b16 v[234:235], v249 offset:17152
    v_mfma_f32_16x16x32_bf16 v[60:63], v[236:239], v[212:215], v[60:63]
    v_cvt_pk_bf16_f32 v138, v40, v41
    v_cvt_pk_bf16_f32 v139, v42, v43
    ds_read_b64_tr_b16 v[236:237], v249 offset:17408
    s_waitcnt lgkmcnt(7)
    v_mfma_f32_16x16x32_bf16 v[56:59], v[240:243], v[216:219], v[56:59]
    v_cvt_pk_bf16_f32 v170, v44, v45
    v_cvt_pk_bf16_f32 v171, v46, v47
    ds_read_b64_tr_b16 v[238:239], v249 offset:17664
    v_mfma_f32_16x16x32_bf16 v[60:63], v[240:243], v[220:223], v[60:63]
    v_permlane16_swap_b32 v136, v138
    ds_read_b64_tr_b16 v[240:241], v252 offset:32
    s_barrier
    s_waitcnt lgkmcnt(7)
    v_mfma_f32_16x16x32_bf16 v[64:67], v[224:227], v[192:195], v[64:67]
    v_permlane16_swap_b32 v137, v139
    ds_read_b64_tr_b16 v[242:243], v252 offset:288
    v_mfma_f32_16x16x32_bf16 v[68:71], v[224:227], v[196:199], v[68:71]
    v_permlane16_swap_b32 v168, v170
    ds_read_b64_tr_b16 v[244:245], v252 offset:544
    s_waitcnt lgkmcnt(7)
    v_mfma_f32_16x16x32_bf16 v[64:67], v[228:231], v[200:203], v[64:67]
    v_permlane16_swap_b32 v169, v171
    ds_read_b64_tr_b16 v[246:247], v252 offset:800
    v_mfma_f32_16x16x32_bf16 v[68:71], v[228:231], v[204:207], v[68:71]
    v_mul_f32 v48, v250, v48
    v_mul_f32 v49, v250, v49
    ds_read_b64_tr_b16 v[224:225], v252 offset:16928
    s_waitcnt lgkmcnt(7)
    v_mfma_f32_16x16x32_bf16 v[64:67], v[232:235], v[208:211], v[64:67]
    v_mul_f32 v50, v250, v50
    v_mul_f32 v51, v250, v51
    ds_read_b64_tr_b16 v[226:227], v252 offset:17184
    v_mfma_f32_16x16x32_bf16 v[68:71], v[232:235], v[212:215], v[68:71]
    v_mul_f32 v52, v250, v52
    v_mul_f32 v53, v250, v53
    ds_read_b64_tr_b16 v[228:229], v252 offset:17440
    s_waitcnt lgkmcnt(7)
    v_mfma_f32_16x16x32_bf16 v[64:67], v[236:239], v[216:219], v[64:67]
    v_mul_f32 v54, v250, v54
    v_mul_f32 v55, v250, v55
    ds_read_b64_tr_b16 v[230:231], v252 offset:17696
    v_mfma_f32_16x16x32_bf16 v[68:71], v[236:239], v[220:223], v[68:71]
    v_cvt_pk_bf16_f32 v140, v48, v49
    v_cvt_pk_bf16_f32 v141, v50, v51
    ds_read_b64_tr_b16 v[232:233], v249 offset:64
    s_waitcnt lgkmcnt(7)
    v_mfma_f32_16x16x32_bf16 v[72:75], v[240:243], v[192:195], v[72:75]
    v_mul_f32 v56, v250, v56
    v_mul_f32 v57, v250, v57
    ds_read_b64_tr_b16 v[234:235], v249 offset:320
    v_mfma_f32_16x16x32_bf16 v[76:79], v[240:243], v[196:199], v[76:79]
    v_mul_f32 v58, v250, v58
    v_mul_f32 v59, v250, v59
    ds_read_b64_tr_b16 v[236:237], v249 offset:576
    s_waitcnt lgkmcnt(7)
    v_mfma_f32_16x16x32_bf16 v[72:75], v[244:247], v[200:203], v[72:75]
    v_cvt_pk_bf16_f32 v172, v52, v53
    v_cvt_pk_bf16_f32 v173, v54, v55
    ds_read_b64_tr_b16 v[238:239], v249 offset:832
    v_mfma_f32_16x16x32_bf16 v[76:79], v[244:247], v[204:207], v[76:79]
    v_mul_f32 v60, v250, v60
    v_mul_f32 v61, v250, v61
    ds_read_b64_tr_b16 v[240:241], v249 offset:16960
    s_waitcnt lgkmcnt(7)
    v_mfma_f32_16x16x32_bf16 v[72:75], v[224:227], v[208:211], v[72:75]
    v_mul_f32 v62, v250, v62
    v_mul_f32 v63, v250, v63
    ds_read_b64_tr_b16 v[242:243], v249 offset:17216
    v_mfma_f32_16x16x32_bf16 v[76:79], v[224:227], v[212:215], v[76:79]
    v_cvt_pk_bf16_f32 v142, v56, v57
    v_cvt_pk_bf16_f32 v143, v58, v59
    ds_read_b64_tr_b16 v[224:225], v249 offset:17472
    s_waitcnt lgkmcnt(7)
    v_mfma_f32_16x16x32_bf16 v[72:75], v[228:231], v[216:219], v[72:75]
    v_cvt_pk_bf16_f32 v174, v60, v61
    v_cvt_pk_bf16_f32 v175, v62, v63
    ds_read_b64_tr_b16 v[226:227], v249 offset:17728
    v_mfma_f32_16x16x32_bf16 v[76:79], v[228:231], v[220:223], v[76:79]
    v_permlane16_swap_b32 v140, v142
    ds_read_b64_tr_b16 v[228:229], v252 offset:96
    s_waitcnt lgkmcnt(7)
    v_mfma_f32_16x16x32_bf16 v[80:83], v[232:235], v[192:195], v[80:83]
    v_permlane16_swap_b32 v141, v143
    ds_read_b64_tr_b16 v[230:231], v252 offset:352
    v_mfma_f32_16x16x32_bf16 v[84:87], v[232:235], v[196:199], v[84:87]
    v_permlane16_swap_b32 v172, v174
    ds_read_b64_tr_b16 v[232:233], v252 offset:608
    s_waitcnt lgkmcnt(7)
    v_mfma_f32_16x16x32_bf16 v[80:83], v[236:239], v[200:203], v[80:83]
    v_permlane16_swap_b32 v173, v175
    ds_read_b64_tr_b16 v[234:235], v252 offset:864
    v_mfma_f32_16x16x32_bf16 v[84:87], v[236:239], v[204:207], v[84:87]
    v_mul_f32 v64, v250, v64
    v_mul_f32 v65, v250, v65
    ds_read_b64_tr_b16 v[236:237], v252 offset:16992
    s_waitcnt lgkmcnt(7)
    v_mfma_f32_16x16x32_bf16 v[80:83], v[240:243], v[208:211], v[80:83]
    v_mul_f32 v66, v250, v66
    v_mul_f32 v67, v250, v67
    ds_read_b64_tr_b16 v[238:239], v252 offset:17248
    v_mfma_f32_16x16x32_bf16 v[84:87], v[240:243], v[212:215], v[84:87]
    v_mul_f32 v68, v250, v68
    v_mul_f32 v69, v250, v69
    ds_read_b64_tr_b16 v[240:241], v252 offset:17504
    s_waitcnt lgkmcnt(7)
    v_mfma_f32_16x16x32_bf16 v[80:83], v[224:227], v[216:219], v[80:83]
    v_mul_f32 v70, v250, v70
    v_mul_f32 v71, v250, v71
    ds_read_b64_tr_b16 v[242:243], v252 offset:17760
    v_mfma_f32_16x16x32_bf16 v[84:87], v[224:227], v[220:223], v[84:87]
    v_cvt_pk_bf16_f32 v144, v64, v65
    v_cvt_pk_bf16_f32 v145, v66, v67
    ds_read_b64_tr_b16 v[224:225], v249 offset:128
    s_waitcnt lgkmcnt(7)
    v_mfma_f32_16x16x32_bf16 v[88:91], v[228:231], v[192:195], v[88:91]
    v_mul_f32 v72, v250, v72
    v_mul_f32 v73, v250, v73
    ds_read_b64_tr_b16 v[226:227], v249 offset:384
    v_mfma_f32_16x16x32_bf16 v[92:95], v[228:231], v[196:199], v[92:95]
    v_mul_f32 v74, v250, v74
    v_mul_f32 v75, v250, v75
    ds_read_b64_tr_b16 v[228:229], v249 offset:640
    s_waitcnt lgkmcnt(7)
    v_mfma_f32_16x16x32_bf16 v[88:91], v[232:235], v[200:203], v[88:91]
    v_cvt_pk_bf16_f32 v176, v68, v69
    v_cvt_pk_bf16_f32 v177, v70, v71
    ds_read_b64_tr_b16 v[230:231], v249 offset:896
    v_mfma_f32_16x16x32_bf16 v[92:95], v[232:235], v[204:207], v[92:95]
    v_mul_f32 v76, v250, v76
    v_mul_f32 v77, v250, v77
    ds_read_b64_tr_b16 v[232:233], v249 offset:17024
    s_waitcnt lgkmcnt(7)
    v_mfma_f32_16x16x32_bf16 v[88:91], v[236:239], v[208:211], v[88:91]
    v_mul_f32 v78, v250, v78
    v_mul_f32 v79, v250, v79
    ds_read_b64_tr_b16 v[234:235], v249 offset:17280
    v_mfma_f32_16x16x32_bf16 v[92:95], v[236:239], v[212:215], v[92:95]
    v_cvt_pk_bf16_f32 v146, v72, v73
    v_cvt_pk_bf16_f32 v147, v74, v75
    ds_read_b64_tr_b16 v[236:237], v249 offset:17536
    s_waitcnt lgkmcnt(7)
    v_mfma_f32_16x16x32_bf16 v[88:91], v[240:243], v[216:219], v[88:91]
    v_cvt_pk_bf16_f32 v178, v76, v77
    v_cvt_pk_bf16_f32 v179, v78, v79
    ds_read_b64_tr_b16 v[238:239], v249 offset:17792
    v_mfma_f32_16x16x32_bf16 v[92:95], v[240:243], v[220:223], v[92:95]
    v_permlane16_swap_b32 v144, v146
    ds_read_b64_tr_b16 v[240:241], v252 offset:160
    s_waitcnt lgkmcnt(7)
    v_mfma_f32_16x16x32_bf16 v[96:99], v[224:227], v[192:195], v[96:99]
    v_permlane16_swap_b32 v145, v147
    ds_read_b64_tr_b16 v[242:243], v252 offset:416
    v_mfma_f32_16x16x32_bf16 v[100:103], v[224:227], v[196:199], v[100:103]
    v_permlane16_swap_b32 v176, v178
    ds_read_b64_tr_b16 v[244:245], v252 offset:672
    s_waitcnt lgkmcnt(7)
    v_mfma_f32_16x16x32_bf16 v[96:99], v[228:231], v[200:203], v[96:99]
    v_permlane16_swap_b32 v177, v179
    ds_read_b64_tr_b16 v[246:247], v252 offset:928
    v_mfma_f32_16x16x32_bf16 v[100:103], v[228:231], v[204:207], v[100:103]
    v_mul_f32 v80, v250, v80
    v_mul_f32 v81, v250, v81
    ds_read_b64_tr_b16 v[224:225], v252 offset:17056
    s_waitcnt lgkmcnt(7)
    v_mfma_f32_16x16x32_bf16 v[96:99], v[232:235], v[208:211], v[96:99]
    v_mul_f32 v82, v250, v82
    v_mul_f32 v83, v250, v83
    ds_read_b64_tr_b16 v[226:227], v252 offset:17312
    v_mfma_f32_16x16x32_bf16 v[100:103], v[232:235], v[212:215], v[100:103]
    v_mul_f32 v84, v250, v84
    v_mul_f32 v85, v250, v85
    ds_read_b64_tr_b16 v[228:229], v252 offset:17568
    s_waitcnt lgkmcnt(7)
    v_mfma_f32_16x16x32_bf16 v[96:99], v[236:239], v[216:219], v[96:99]
    v_mul_f32 v86, v250, v86
    v_mul_f32 v87, v250, v87
    ds_read_b64_tr_b16 v[230:231], v252 offset:17824
    v_mfma_f32_16x16x32_bf16 v[100:103], v[236:239], v[220:223], v[100:103]
    v_cvt_pk_bf16_f32 v148, v80, v81
    v_cvt_pk_bf16_f32 v149, v82, v83
    ds_read_b64_tr_b16 v[232:233], v249 offset:192
    s_waitcnt lgkmcnt(7)
    v_mfma_f32_16x16x32_bf16 v[104:107], v[240:243], v[192:195], v[104:107]
    v_mul_f32 v88, v250, v88
    v_mul_f32 v89, v250, v89
    ds_read_b64_tr_b16 v[234:235], v249 offset:448
    v_mfma_f32_16x16x32_bf16 v[108:111], v[240:243], v[196:199], v[108:111]
    v_mul_f32 v90, v250, v90
    v_mul_f32 v91, v250, v91
    ds_read_b64_tr_b16 v[236:237], v249 offset:704
    s_waitcnt lgkmcnt(7)
    v_mfma_f32_16x16x32_bf16 v[104:107], v[244:247], v[200:203], v[104:107]
    v_cvt_pk_bf16_f32 v180, v84, v85
    v_cvt_pk_bf16_f32 v181, v86, v87
    ds_read_b64_tr_b16 v[238:239], v249 offset:960
    v_mfma_f32_16x16x32_bf16 v[108:111], v[244:247], v[204:207], v[108:111]
    v_mul_f32 v92, v250, v92
    v_mul_f32 v93, v250, v93
    ds_read_b64_tr_b16 v[240:241], v249 offset:17088
    s_waitcnt lgkmcnt(7)
    v_mfma_f32_16x16x32_bf16 v[104:107], v[224:227], v[208:211], v[104:107]
    v_mul_f32 v94, v250, v94
    v_mul_f32 v95, v250, v95
    ds_read_b64_tr_b16 v[242:243], v249 offset:17344
    v_mfma_f32_16x16x32_bf16 v[108:111], v[224:227], v[212:215], v[108:111]
    v_cvt_pk_bf16_f32 v150, v88, v89
    v_cvt_pk_bf16_f32 v151, v90, v91
    ds_read_b64_tr_b16 v[224:225], v249 offset:17600
    s_waitcnt lgkmcnt(7)
    v_mfma_f32_16x16x32_bf16 v[104:107], v[228:231], v[216:219], v[104:107]
    v_cvt_pk_bf16_f32 v182, v92, v93
    v_cvt_pk_bf16_f32 v183, v94, v95
    ds_read_b64_tr_b16 v[226:227], v249 offset:17856
    v_mfma_f32_16x16x32_bf16 v[108:111], v[228:231], v[220:223], v[108:111]
    v_permlane16_swap_b32 v148, v150
    ds_read_b64_tr_b16 v[228:229], v252 offset:224
    s_waitcnt lgkmcnt(7)
    v_mfma_f32_16x16x32_bf16 v[112:115], v[232:235], v[192:195], v[112:115]
    v_permlane16_swap_b32 v149, v151
    ds_read_b64_tr_b16 v[230:231], v252 offset:480
    v_mfma_f32_16x16x32_bf16 v[116:119], v[232:235], v[196:199], v[116:119]
    v_permlane16_swap_b32 v180, v182
    ds_read_b64_tr_b16 v[232:233], v252 offset:736
    s_waitcnt lgkmcnt(7)
    v_mfma_f32_16x16x32_bf16 v[112:115], v[236:239], v[200:203], v[112:115]
    v_permlane16_swap_b32 v181, v183
    ds_read_b64_tr_b16 v[234:235], v252 offset:992
    v_mfma_f32_16x16x32_bf16 v[116:119], v[236:239], v[204:207], v[116:119]
    v_mul_f32 v96, v250, v96
    v_mul_f32 v97, v250, v97
    ds_read_b64_tr_b16 v[236:237], v252 offset:17120
    s_waitcnt lgkmcnt(7)
    v_mfma_f32_16x16x32_bf16 v[112:115], v[240:243], v[208:211], v[112:115]
    v_mul_f32 v98, v250, v98
    v_mul_f32 v99, v250, v99
    ds_read_b64_tr_b16 v[238:239], v252 offset:17376
    v_mfma_f32_16x16x32_bf16 v[116:119], v[240:243], v[212:215], v[116:119]
    v_mul_f32 v100, v250, v100
    v_mul_f32 v101, v250, v101
    ds_read_b64_tr_b16 v[240:241], v252 offset:17632
    s_waitcnt lgkmcnt(7)
    v_mfma_f32_16x16x32_bf16 v[112:115], v[224:227], v[216:219], v[112:115]
    v_mul_f32 v102, v250, v102
    v_mul_f32 v103, v250, v103
    ds_read_b64_tr_b16 v[242:243], v252 offset:17888
    v_mfma_f32_16x16x32_bf16 v[116:119], v[224:227], v[220:223], v[116:119]
    v_cvt_pk_bf16_f32 v152, v96, v97
    v_cvt_pk_bf16_f32 v153, v98, v99
    s_waitcnt lgkmcnt(6)
    v_mfma_f32_16x16x32_bf16 v[120:123], v[228:231], v[192:195], v[120:123]
    v_mul_f32 v104, v250, v104
    v_mul_f32 v105, v250, v105
    ds_read_b128 v[224:227], v248 offset:0
    v_mfma_f32_16x16x32_bf16 v[124:127], v[228:231], v[196:199], v[124:127]
    v_mul_f32 v106, v250, v106
    v_mul_f32 v107, v250, v107
    s_waitcnt lgkmcnt(5)
    v_mfma_f32_16x16x32_bf16 v[120:123], v[232:235], v[200:203], v[120:123]
    v_cvt_pk_bf16_f32 v184, v100, v101
    v_cvt_pk_bf16_f32 v185, v102, v103
    ds_read_b128 v[228:231], v248 offset:512
    v_mfma_f32_16x16x32_bf16 v[124:127], v[232:235], v[204:207], v[124:127]
    v_mul_f32 v108, v250, v108
    v_mul_f32 v109, v250, v109
    s_waitcnt lgkmcnt(4)
    v_mfma_f32_16x16x32_bf16 v[120:123], v[236:239], v[208:211], v[120:123]
    v_mul_f32 v110, v250, v110
    v_mul_f32 v111, v250, v111
    ds_read_b128 v[232:235], v248 offset:64
    v_mfma_f32_16x16x32_bf16 v[124:127], v[236:239], v[212:215], v[124:127]
    v_cvt_pk_bf16_f32 v154, v104, v105
    v_cvt_pk_bf16_f32 v155, v106, v107
    s_waitcnt lgkmcnt(3)
    v_mfma_f32_16x16x32_bf16 v[120:123], v[240:243], v[216:219], v[120:123]
    v_cvt_pk_bf16_f32 v186, v108, v109
    v_cvt_pk_bf16_f32 v187, v110, v111
    ds_read_b128 v[236:239], v248 offset:576
    v_mfma_f32_16x16x32_bf16 v[124:127], v[240:243], v[220:223], v[124:127]
    v_permlane16_swap_b32 v152, v154
    s_barrier
    s_waitcnt lgkmcnt(3)
    v_mfma_f32_16x16x32_bf16 v[0:3], v[224:227], v[128:131], 0
    v_permlane16_swap_b32 v153, v155
    ds_read_b128 v[240:243], v248 offset:128
    v_mfma_f32_16x16x32_bf16 v[8:11], v[224:227], v[160:163], 0
    v_permlane16_swap_b32 v184, v186
    s_waitcnt lgkmcnt(3)
    v_mfma_f32_16x16x32_bf16 v[4:7], v[228:231], v[128:131], 0
    v_permlane16_swap_b32 v185, v187
    ds_read_b128 v[244:247], v248 offset:640
    v_mfma_f32_16x16x32_bf16 v[12:15], v[228:231], v[160:163], 0
    v_mul_f32 v112, v250, v112
    v_mul_f32 v113, v250, v113
    s_waitcnt lgkmcnt(3)
    v_mfma_f32_16x16x32_bf16 v[0:3], v[232:235], v[132:135], v[0:3]
    v_mul_f32 v114, v250, v114
    v_mul_f32 v115, v250, v115
    ds_read_b128 v[224:227], v248 offset:192
    v_mfma_f32_16x16x32_bf16 v[8:11], v[232:235], v[164:167], v[8:11]
    v_mul_f32 v116, v250, v116
    v_mul_f32 v117, v250, v117
    s_waitcnt lgkmcnt(3)
    v_mfma_f32_16x16x32_bf16 v[4:7], v[236:239], v[132:135], v[4:7]
    v_mul_f32 v118, v250, v118
    v_mul_f32 v119, v250, v119
    ds_read_b128 v[228:231], v248 offset:704
    v_mfma_f32_16x16x32_bf16 v[12:15], v[236:239], v[164:167], v[12:15]
    v_cvt_pk_bf16_f32 v156, v112, v113
    v_cvt_pk_bf16_f32 v157, v114, v115
    s_waitcnt lgkmcnt(3)
    v_mfma_f32_16x16x32_bf16 v[0:3], v[240:243], v[136:139], v[0:3]
    v_mul_f32 v120, v250, v120
    v_mul_f32 v121, v250, v121
    ds_read_b128 v[232:235], v248 offset:256
    v_mfma_f32_16x16x32_bf16 v[8:11], v[240:243], v[168:171], v[8:11]
    v_mul_f32 v122, v250, v122
    v_mul_f32 v123, v250, v123
    s_waitcnt lgkmcnt(3)
    v_mfma_f32_16x16x32_bf16 v[4:7], v[244:247], v[136:139], v[4:7]
    v_cvt_pk_bf16_f32 v188, v116, v117
    v_cvt_pk_bf16_f32 v189, v118, v119
    ds_read_b128 v[236:239], v248 offset:768
    v_mfma_f32_16x16x32_bf16 v[12:15], v[244:247], v[168:171], v[12:15]
    v_mul_f32 v124, v250, v124
    v_mul_f32 v125, v250, v125
    s_waitcnt lgkmcnt(3)
    v_mfma_f32_16x16x32_bf16 v[0:3], v[224:227], v[140:143], v[0:3]
    v_mul_f32 v126, v250, v126
    v_mul_f32 v127, v250, v127
    ds_read_b128 v[240:243], v248 offset:320
    v_mfma_f32_16x16x32_bf16 v[8:11], v[224:227], v[172:175], v[8:11]
    v_cvt_pk_bf16_f32 v158, v120, v121
    v_cvt_pk_bf16_f32 v159, v122, v123
    s_waitcnt lgkmcnt(3)
    v_mfma_f32_16x16x32_bf16 v[4:7], v[228:231], v[140:143], v[4:7]
    v_cvt_pk_bf16_f32 v190, v124, v125
    v_cvt_pk_bf16_f32 v191, v126, v127
    ds_read_b128 v[224:227], v248 offset:832
    v_mfma_f32_16x16x32_bf16 v[12:15], v[228:231], v[172:175], v[12:15]
    v_permlane16_swap_b32 v156, v158
    s_waitcnt lgkmcnt(3)
    v_mfma_f32_16x16x32_bf16 v[0:3], v[232:235], v[144:147], v[0:3]
    v_permlane16_swap_b32 v157, v159
    ds_read_b128 v[228:231], v248 offset:384
    v_mfma_f32_16x16x32_bf16 v[8:11], v[232:235], v[176:179], v[8:11]
    v_permlane16_swap_b32 v188, v190
    s_waitcnt lgkmcnt(3)
    v_mfma_f32_16x16x32_bf16 v[4:7], v[236:239], v[144:147], v[4:7]
    v_permlane16_swap_b32 v189, v191
    ds_read_b128 v[232:235], v248 offset:896
    v_mfma_f32_16x16x32_bf16 v[12:15], v[236:239], v[176:179], v[12:15]
    s_waitcnt lgkmcnt(3)
    v_mfma_f32_16x16x32_bf16 v[0:3], v[240:243], v[148:151], v[0:3]
    ds_read_b128 v[236:239], v248 offset:448
    v_mfma_f32_16x16x32_bf16 v[8:11], v[240:243], v[180:183], v[8:11]
    s_waitcnt lgkmcnt(3)
    v_mfma_f32_16x16x32_bf16 v[4:7], v[224:227], v[148:151], v[4:7]
    ds_read_b128 v[240:243], v248 offset:960
    v_mfma_f32_16x16x32_bf16 v[12:15], v[224:227], v[180:183], v[12:15]
    v_add_u32 v248, 0x4200, v248
    s_waitcnt lgkmcnt(3)
    v_mfma_f32_16x16x32_bf16 v[0:3], v[228:231], v[152:155], v[0:3]
    ds_read_b128 v[224:227], v248 offset:0
    v_mfma_f32_16x16x32_bf16 v[8:11], v[228:231], v[184:187], v[8:11]
    s_waitcnt lgkmcnt(3)
    v_mfma_f32_16x16x32_bf16 v[4:7], v[232:235], v[152:155], v[4:7]
    ds_read_b128 v[228:231], v248 offset:512
    v_mfma_f32_16x16x32_bf16 v[12:15], v[232:235], v[184:187], v[12:15]
    s_mov_b32 s63, 16896
    s_mov_b32 s64, 0
    s_waitcnt lgkmcnt(3)
    v_mfma_f32_16x16x32_bf16 v[0:3], v[236:239], v[156:159], v[0:3]
    ds_read_b128 v[232:235], v248 offset:64
    s_mov_b32 s69, 13
    s_mov_b32 s70, 0
    v_mfma_f32_16x16x32_bf16 v[8:11], v[236:239], v[188:191], v[8:11]
    s_mov_b32 s61, 16384
    s_waitcnt lgkmcnt(3)
    v_mfma_f32_16x16x32_bf16 v[4:7], v[240:243], v[156:159], v[4:7]
    ds_read_b128 v[236:239], v248 offset:576
    v_mfma_f32_16x16x32_bf16 v[12:15], v[240:243], v[188:191], v[12:15]
    v_max3_f32 v216, v0, v1, v2
    s_nop 1
    v_max3_f32 v220, v8, v9, v10
    s_nop 1
    v_max3_f32 v216, v216, v3, v4
    s_nop 0
    v_max3_f32 v220, v220, v11, v12
    v_max3_f32 v216, v216, v5, v6
    v_max3_f32 v220, v220, v13, v14
    v_max_f32 v216, v216, v7
    v_max_f32 v220, v220, v15
    v_mov_b32 v254, v216
    v_mov_b32 v255, v220
    s_nop 0
    v_permlane16_swap_b32 v216, v254
    v_permlane16_swap_b32 v220, v255
    v_max_f32 v216, v216, v254
    v_max_f32 v220, v220, v255
    v_mov_b32 v254, v216
    v_mov_b32 v255, v220
    s_nop 0
    v_permlane32_swap_b32 v216, v254
    v_permlane32_swap_b32 v220, v255
    v_max_f32 v216, v216, v254
    v_max_f32 v220, v220, v255
    v_sub_f32 v216, 0, v216
    v_sub_f32 v220, 0, v220
    v_mov_b32 v217, v216
    v_mov_b32 v221, v220
    v_mov_b32 v218, v216
    v_mov_b32 v222, v220
    v_mov_b32 v219, v216
    v_mov_b32 v223, v220
    s_waitcnt lgkmcnt(3)
    v_mfma_f32_16x16x32_bf16 v[192:195], v[224:227], v[128:131], v[216:219]
    v_add_f32 v0, v0, v216
    v_add_f32 v8, v8, v220
    ds_read_b128 v[240:243], v248 offset:128
    v_mfma_f32_16x16x32_bf16 v[200:203], v[224:227], v[160:163], v[220:223]
    v_add_f32 v1, v1, v216
    v_add_f32 v9, v9, v220
    s_waitcnt lgkmcnt(3)
    v_mfma_f32_16x16x32_bf16 v[196:199], v[228:231], v[128:131], v[216:219]
    v_exp_f32 v0, v0
    ds_read_b128 v[244:247], v248 offset:640
    v_mfma_f32_16x16x32_bf16 v[204:207], v[228:231], v[160:163], v[220:223]
    v_exp_f32 v8, v8
    s_waitcnt lgkmcnt(3)
    v_mfma_f32_16x16x32_bf16 v[192:195], v[232:235], v[132:135], v[192:195]
    v_add_f32 v2, v2, v216
    v_add_f32 v10, v10, v220
    ds_read_b128 v[224:227], v248 offset:192
    v_mfma_f32_16x16x32_bf16 v[200:203], v[232:235], v[164:167], v[200:203]
    v_exp_f32 v1, v1
    s_waitcnt lgkmcnt(3)
    v_mfma_f32_16x16x32_bf16 v[196:199], v[236:239], v[132:135], v[196:199]
    v_exp_f32 v9, v9
    ds_read_b128 v[228:231], v248 offset:704
    v_mfma_f32_16x16x32_bf16 v[204:207], v[236:239], v[164:167], v[204:207]
    v_add_f32 v3, v3, v216
    v_add_f32 v11, v11, v220
    s_waitcnt lgkmcnt(3)
    v_mfma_f32_16x16x32_bf16 v[192:195], v[240:243], v[136:139], v[192:195]
    v_exp_f32 v2, v2
    ds_read_b128 v[232:235], v248 offset:256
    v_mfma_f32_16x16x32_bf16 v[200:203], v[240:243], v[168:171], v[200:203]
    v_exp_f32 v10, v10
    s_waitcnt lgkmcnt(3)
    v_mfma_f32_16x16x32_bf16 v[196:199], v[244:247], v[136:139], v[196:199]
    v_add_f32 v4, v4, v216
    v_add_f32 v12, v12, v220
    ds_read_b128 v[236:239], v248 offset:768
    v_mfma_f32_16x16x32_bf16 v[204:207], v[244:247], v[168:171], v[204:207]
    v_add_f32 v252, v0, v1
    v_add_f32 v253, v8, v9
    s_waitcnt lgkmcnt(3)
    v_mfma_f32_16x16x32_bf16 v[192:195], v[224:227], v[140:143], v[192:195]
    v_exp_f32 v3, v3
    ds_read_b128 v[240:243], v248 offset:320
    v_mfma_f32_16x16x32_bf16 v[200:203], v[224:227], v[172:175], v[200:203]
    v_exp_f32 v11, v11
    s_waitcnt lgkmcnt(3)
    v_mfma_f32_16x16x32_bf16 v[196:199], v[228:231], v[140:143], v[196:199]
    v_add_f32 v5, v5, v216
    v_add_f32 v13, v13, v220
    ds_read_b128 v[224:227], v248 offset:832
    v_mfma_f32_16x16x32_bf16 v[204:207], v[228:231], v[172:175], v[204:207]
    v_add_f32 v252, v252, v2
    v_add_f32 v253, v253, v10
    s_waitcnt lgkmcnt(3)
    v_mfma_f32_16x16x32_bf16 v[192:195], v[232:235], v[144:147], v[192:195]
    v_exp_f32 v4, v4
    ds_read_b128 v[228:231], v248 offset:384
    v_mfma_f32_16x16x32_bf16 v[200:203], v[232:235], v[176:179], v[200:203]
    v_exp_f32 v12, v12
    s_waitcnt lgkmcnt(3)
    v_mfma_f32_16x16x32_bf16 v[196:199], v[236:239], v[144:147], v[196:199]
    v_add_f32 v6, v6, v216
    v_add_f32 v14, v14, v220
    ds_read_b128 v[232:235], v248 offset:896
    v_mfma_f32_16x16x32_bf16 v[204:207], v[236:239], v[176:179], v[204:207]
    v_add_f32 v252, v252, v3
    v_add_f32 v253, v253, v11
    s_waitcnt lgkmcnt(3)
    v_mfma_f32_16x16x32_bf16 v[192:195], v[240:243], v[148:151], v[192:195]
    v_exp_f32 v5, v5
    ds_read_b128 v[236:239], v248 offset:448
    v_mfma_f32_16x16x32_bf16 v[200:203], v[240:243], v[180:183], v[200:203]
    v_exp_f32 v13, v13
    s_waitcnt lgkmcnt(3)
    v_mfma_f32_16x16x32_bf16 v[196:199], v[224:227], v[148:151], v[196:199]
    v_add_f32 v7, v7, v216
    v_add_f32 v15, v15, v220
    ds_read_b128 v[240:243], v248 offset:960
    v_mfma_f32_16x16x32_bf16 v[204:207], v[224:227], v[180:183], v[204:207]
    v_add_f32 v252, v252, v4
    v_add_f32 v253, v253, v12
    v_add_u32 v249, 0xfffef800, v249
    ds_read_b64_tr_b16 v[224:225], v249 offset:0
    s_waitcnt lgkmcnt(4)
    v_mfma_f32_16x16x32_bf16 v[192:195], v[228:231], v[152:155], v[192:195]
    v_exp_f32 v6, v6
    ds_read_b64_tr_b16 v[226:227], v249 offset:512
    v_mfma_f32_16x16x32_bf16 v[200:203], v[228:231], v[184:187], v[200:203]
    v_exp_f32 v14, v14
    ds_read_b64_tr_b16 v[228:229], v249 offset:32
    s_waitcnt lgkmcnt(5)
    v_mfma_f32_16x16x32_bf16 v[196:199], v[232:235], v[152:155], v[196:199]
    v_add_f32 v252, v252, v5
    v_add_f32 v253, v253, v13
    ds_read_b64_tr_b16 v[230:231], v249 offset:544
    v_mfma_f32_16x16x32_bf16 v[204:207], v[232:235], v[184:187], v[204:207]
    v_exp_f32 v7, v7
    ds_read_b64_tr_b16 v[232:233], v249 offset:64
    s_waitcnt lgkmcnt(6)
    v_mfma_f32_16x16x32_bf16 v[192:195], v[236:239], v[156:159], v[192:195]
    v_exp_f32 v15, v15
    ds_read_b64_tr_b16 v[234:235], v249 offset:576
    v_mfma_f32_16x16x32_bf16 v[200:203], v[236:239], v[188:191], v[200:203]
    v_add_f32 v252, v252, v6
    v_add_f32 v253, v253, v14
    ds_read_b64_tr_b16 v[236:237], v249 offset:96
    s_waitcnt lgkmcnt(7)
    v_mfma_f32_16x16x32_bf16 v[196:199], v[240:243], v[156:159], v[196:199]
    v_add_f32 v252, v252, v7
    v_add_f32 v253, v253, v15
    ds_read_b64_tr_b16 v[238:239], v249 offset:608
    v_mfma_f32_16x16x32_bf16 v[204:207], v[240:243], v[188:191], v[204:207]
    v_cvt_pk_bf16_f32 v208, v0, v1
    v_cvt_pk_bf16_f32 v209, v2, v3
    ds_read_b64_tr_b16 v[240:241], v249 offset:128
    v_cvt_pk_bf16_f32 v212, v8, v9
    v_cvt_pk_bf16_f32 v213, v10, v11
    v_cvt_pk_bf16_f32 v210, v4, v5
    v_cvt_pk_bf16_f32 v211, v6, v7
    v_cvt_pk_bf16_f32 v214, v12, v13
    v_cvt_pk_bf16_f32 v215, v14, v15
    v_mov_b32 v250, v252
    v_mov_b32 v251, v253
    s_barrier
    s_waitcnt lgkmcnt(7)
    v_mfma_f32_16x16x32_bf16 v[0:3], v[224:227], v[208:211], 0
    v_exp_f32 v192, v192
    ds_read_b64_tr_b16 v[242:243], v249 offset:640
    s_mov_b32 s65, -101376
    v_mfma_f32_16x16x32_bf16 v[4:7], v[224:227], v[212:215], 0
    v_exp_f32 v200, v200
    ds_read_b64_tr_b16 v[244:245], v249 offset:160
    s_waitcnt lgkmcnt(7)
    v_mfma_f32_16x16x32_bf16 v[8:11], v[228:231], v[208:211], 0
    v_exp_f32 v193, v193
    ds_read_b64_tr_b16 v[246:247], v249 offset:672
    s_cmp_gt_u32 s64, 101376
    v_mfma_f32_16x16x32_bf16 v[12:15], v[228:231], v[212:215], 0
    v_exp_f32 v201, v201
    ds_read_b64_tr_b16 v[224:225], v249 offset:192
    s_waitcnt lgkmcnt(7)
    v_mfma_f32_16x16x32_bf16 v[16:19], v[232:235], v[208:211], 0
    v_exp_f32 v194, v194
    ds_read_b64_tr_b16 v[226:227], v249 offset:704
    s_cselect_b32 s66, s68, s67
    v_mfma_f32_16x16x32_bf16 v[20:23], v[232:235], v[212:215], 0
    v_exp_f32 v202, v202
    ds_read_b64_tr_b16 v[228:229], v249 offset:224
    s_waitcnt lgkmcnt(7)
    v_mfma_f32_16x16x32_bf16 v[24:27], v[236:239], v[208:211], 0
    v_add_f32 v252, v192, v193
    v_add_f32 v253, v200, v201
    ds_read_b64_tr_b16 v[230:231], v249 offset:736
    s_add_u32 s64, s64, s66
    v_mfma_f32_16x16x32_bf16 v[28:31], v[236:239], v[212:215], 0
    v_exp_f32 v195, v195
    ds_read_b64_tr_b16 v[232:233], v249 offset:256
    s_waitcnt lgkmcnt(7)
    v_mfma_f32_16x16x32_bf16 v[32:35], v[240:243], v[208:211], 0
    v_exp_f32 v203, v203
    ds_read_b64_tr_b16 v[234:235], v249 offset:768
    s_mov_b64 s[86:87], 0
    v_mfma_f32_16x16x32_bf16 v[36:39], v[240:243], v[212:215], 0
    v_add_f32 v252, v252, v194
    v_add_f32 v253, v253, v202
    ds_read_b64_tr_b16 v[236:237], v249 offset:288
    s_waitcnt lgkmcnt(7)
    v_mfma_f32_16x16x32_bf16 v[40:43], v[244:247], v[208:211], 0
    v_exp_f32 v196, v196
    ds_read_b64_tr_b16 v[238:239], v249 offset:800
    v_mfma_f32_16x16x32_bf16 v[44:47], v[244:247], v[212:215], 0
    v_exp_f32 v204, v204
    ds_read_b64_tr_b16 v[240:241], v249 offset:320
    s_waitcnt lgkmcnt(7)
    v_mfma_f32_16x16x32_bf16 v[48:51], v[224:227], v[208:211], 0
    v_add_f32 v252, v252, v195
    v_add_f32 v253, v253, v203
    ds_read_b64_tr_b16 v[242:243], v249 offset:832
    v_mfma_f32_16x16x32_bf16 v[52:55], v[224:227], v[212:215], 0
    v_exp_f32 v197, v197
    ds_read_b64_tr_b16 v[224:225], v249 offset:352
    s_waitcnt lgkmcnt(7)
    v_mfma_f32_16x16x32_bf16 v[56:59], v[228:231], v[208:211], 0
    v_exp_f32 v205, v205
    ds_read_b64_tr_b16 v[226:227], v249 offset:864
    v_mfma_f32_16x16x32_bf16 v[60:63], v[228:231], v[212:215], 0
    v_add_f32 v252, v252, v196
    v_add_f32 v253, v253, v204
    ds_read_b64_tr_b16 v[228:229], v249 offset:384
    s_waitcnt lgkmcnt(7)
    v_mfma_f32_16x16x32_bf16 v[64:67], v[232:235], v[208:211], 0
    v_exp_f32 v198, v198
    ds_read_b64_tr_b16 v[230:231], v249 offset:896
    v_mfma_f32_16x16x32_bf16 v[68:71], v[232:235], v[212:215], 0
    v_exp_f32 v206, v206
    ds_read_b64_tr_b16 v[232:233], v249 offset:416
    s_waitcnt lgkmcnt(7)
    v_mfma_f32_16x16x32_bf16 v[72:75], v[236:239], v[208:211], 0
    v_add_f32 v252, v252, v197
    v_add_f32 v253, v253, v205
    ds_read_b64_tr_b16 v[234:235], v249 offset:928
    v_mfma_f32_16x16x32_bf16 v[76:79], v[236:239], v[212:215], 0
    v_exp_f32 v199, v199
    ds_read_b64_tr_b16 v[236:237], v249 offset:448
    s_waitcnt lgkmcnt(7)
    v_mfma_f32_16x16x32_bf16 v[80:83], v[240:243], v[208:211], 0
    v_exp_f32 v207, v207
    ds_read_b64_tr_b16 v[238:239], v249 offset:960
    v_mfma_f32_16x16x32_bf16 v[84:87], v[240:243], v[212:215], 0
    v_add_f32 v252, v252, v198
    v_add_f32 v253, v253, v206
    ds_read_b64_tr_b16 v[240:241], v249 offset:480
    s_waitcnt lgkmcnt(7)
    v_mfma_f32_16x16x32_bf16 v[88:91], v[224:227], v[208:211], 0
    v_add_f32 v252, v252, v199
    v_add_f32 v253, v253, v207
    ds_read_b64_tr_b16 v[242:243], v249 offset:992
    v_mfma_f32_16x16x32_bf16 v[92:95], v[224:227], v[212:215], 0
    v_max_f32 v254, v252, v253
    v_cmp_nge_f32 vcc, s62, v254
    v_add_u32 v248, s65, v248
    s_waitcnt lgkmcnt(6)
    v_mfma_f32_16x16x32_bf16 v[96:99], v[228:231], v[208:211], 0
    ds_read_b128 v[224:227], v248 offset:0
    v_mfma_f32_16x16x32_bf16 v[100:103], v[228:231], v[212:215], 0
    s_waitcnt lgkmcnt(5)
    v_mfma_f32_16x16x32_bf16 v[104:107], v[232:235], v[208:211], 0
    ds_read_b128 v[228:231], v248 offset:512
    v_mfma_f32_16x16x32_bf16 v[108:111], v[232:235], v[212:215], 0
    s_waitcnt lgkmcnt(4)
    v_mfma_f32_16x16x32_bf16 v[112:115], v[236:239], v[208:211], 0
    ds_read_b128 v[232:235], v248 offset:64
    v_mfma_f32_16x16x32_bf16 v[116:119], v[236:239], v[212:215], 0
    s_waitcnt lgkmcnt(3)
    v_mfma_f32_16x16x32_bf16 v[120:123], v[240:243], v[208:211], 0
    ds_read_b128 v[236:239], v248 offset:576
    v_mfma_f32_16x16x32_bf16 v[124:127], v[240:243], v[212:215], 0
    s_cbranch_vccnz L_rare
.p2align 6
L_loop:
    v_cvt_pk_bf16_f32 v208, v192, v193
    v_cvt_pk_bf16_f32 v209, v194, v195
    s_waitcnt lgkmcnt(3)
    v_mfma_f32_16x16x32_bf16 v[192:195], v[224:227], v[128:131], v[216:219]
    v_cvt_pk_bf16_f32 v212, v200, v201
    v_cvt_pk_bf16_f32 v213, v202, v203
    ds_read_b128 v[240:243], v248 offset:128
    v_mfma_f32_16x16x32_bf16 v[200:203], v[224:227], v[160:163], v[220:223]
    v_cvt_pk_bf16_f32 v210, v196, v197
    v_cvt_pk_bf16_f32 v211, v198, v199
    s_waitcnt lgkmcnt(3)
    v_mfma_f32_16x16x32_bf16 v[196:199], v[228:231], v[128:131], v[216:219]
    v_cvt_pk_bf16_f32 v214, v204, v205
    v_cvt_pk_bf16_f32 v215, v206, v207
    ds_read_b128 v[244:247], v248 offset:640
    v_mfma_f32_16x16x32_bf16 v[204:207], v[228:231], v[160:163], v[220:223]
    v_add_f32 v250, v250, v252
    v_add_f32 v251, v251, v253
    s_waitcnt lgkmcnt(3)
    v_mfma_f32_16x16x32_bf16 v[192:195], v[232:235], v[132:135], v[192:195]
    ds_read_b128 v[224:227], v248 offset:192
    s_add_u32 s61, s61, 16384
    v_mfma_f32_16x16x32_bf16 v[200:203], v[232:235], v[164:167], v[200:203]
    s_waitcnt lgkmcnt(3)
    v_mfma_f32_16x16x32_bf16 v[196:199], v[236:239], v[132:135], v[196:199]
    ds_read_b128 v[228:231], v248 offset:704
    v_mfma_f32_16x16x32_bf16 v[204:207], v[236:239], v[164:167], v[204:207]
    s_waitcnt lgkmcnt(3)
    v_mfma_f32_16x16x32_bf16 v[192:195], v[240:243], v[136:139], v[192:195]
    ds_read_b128 v[232:235], v248 offset:256
    v_mfma_f32_16x16x32_bf16 v[200:203], v[240:243], v[168:171], v[200:203]
    s_waitcnt lgkmcnt(3)
    v_mfma_f32_16x16x32_bf16 v[196:199], v[244:247], v[136:139], v[196:199]
    ds_read_b128 v[236:239], v248 offset:768
    v_mfma_f32_16x16x32_bf16 v[204:207], v[244:247], v[168:171], v[204:207]
    s_waitcnt lgkmcnt(3)
    v_mfma_f32_16x16x32_bf16 v[192:195], v[224:227], v[140:143], v[192:195]
    ds_read_b128 v[240:243], v248 offset:320
    v_mfma_f32_16x16x32_bf16 v[200:203], v[224:227], v[172:175], v[200:203]
    s_waitcnt lgkmcnt(3)
    v_mfma_f32_16x16x32_bf16 v[196:199], v[228:231], v[140:143], v[196:199]
    ds_read_b128 v[224:227], v248 offset:832
    v_mfma_f32_16x16x32_bf16 v[204:207], v[228:231], v[172:175], v[204:207]
    s_waitcnt lgkmcnt(3)
    v_mfma_f32_16x16x32_bf16 v[192:195], v[232:235], v[144:147], v[192:195]
    ds_read_b128 v[228:231], v248 offset:384
    v_mfma_f32_16x16x32_bf16 v[200:203], v[232:235], v[176:179], v[200:203]
    s_waitcnt lgkmcnt(3)
    v_mfma_f32_16x16x32_bf16 v[196:199], v[236:239], v[144:147], v[196:199]
    ds_read_b128 v[232:235], v248 offset:896
    v_mfma_f32_16x16x32_bf16 v[204:207], v[236:239], v[176:179], v[204:207]
    s_waitcnt lgkmcnt(3)
    v_mfma_f32_16x16x32_bf16 v[192:195], v[240:243], v[148:151], v[192:195]
    ds_read_b128 v[236:239], v248 offset:448
    v_mfma_f32_16x16x32_bf16 v[200:203], v[240:243], v[180:183], v[200:203]
    s_waitcnt lgkmcnt(3)
    v_mfma_f32_16x16x32_bf16 v[196:199], v[224:227], v[148:151], v[196:199]
    ds_read_b128 v[240:243], v248 offset:960
    v_mfma_f32_16x16x32_bf16 v[204:207], v[224:227], v[180:183], v[204:207]
    v_add_u32 v249, s66, v249
    ds_read_b64_tr_b16 v[224:225], v249 offset:0
    s_waitcnt lgkmcnt(4)
    v_mfma_f32_16x16x32_bf16 v[192:195], v[228:231], v[152:155], v[192:195]
    ds_read_b64_tr_b16 v[226:227], v249 offset:512
    v_mfma_f32_16x16x32_bf16 v[200:203], v[228:231], v[184:187], v[200:203]
    ds_read_b64_tr_b16 v[228:229], v249 offset:32
    s_waitcnt lgkmcnt(5)
    v_mfma_f32_16x16x32_bf16 v[196:199], v[232:235], v[152:155], v[196:199]
    ds_read_b64_tr_b16 v[230:231], v249 offset:544
    v_mfma_f32_16x16x32_bf16 v[204:207], v[232:235], v[184:187], v[204:207]
    ds_read_b64_tr_b16 v[232:233], v249 offset:64
    s_waitcnt lgkmcnt(6)
    v_mfma_f32_16x16x32_bf16 v[192:195], v[236:239], v[156:159], v[192:195]
    ds_read_b64_tr_b16 v[234:235], v249 offset:576
    v_mfma_f32_16x16x32_bf16 v[200:203], v[236:239], v[188:191], v[200:203]
    ds_read_b64_tr_b16 v[236:237], v249 offset:96
    s_waitcnt lgkmcnt(7)
    v_mfma_f32_16x16x32_bf16 v[196:199], v[240:243], v[156:159], v[196:199]
    ds_read_b64_tr_b16 v[238:239], v249 offset:608
    v_mfma_f32_16x16x32_bf16 v[204:207], v[240:243], v[188:191], v[204:207]
    ds_read_b64_tr_b16 v[240:241], v249 offset:128
    s_barrier
    s_waitcnt lgkmcnt(7)
    v_mfma_f32_16x16x32_bf16 v[0:3], v[224:227], v[208:211], v[0:3]
    v_exp_f32 v192, v192
    ds_read_b64_tr_b16 v[242:243], v249 offset:640
    s_cmp_gt_u32 s63, 101376
    v_mfma_f32_16x16x32_bf16 v[4:7], v[224:227], v[212:215], v[4:7]
    v_exp_f32 v200, v200
    ds_read_b64_tr_b16 v[244:245], v249 offset:160
    s_waitcnt lgkmcnt(7)
    v_mfma_f32_16x16x32_bf16 v[8:11], v[228:231], v[208:211], v[8:11]
    v_exp_f32 v193, v193
    ds_read_b64_tr_b16 v[246:247], v249 offset:672
    s_cselect_b32 s65, s68, s67
    v_mfma_f32_16x16x32_bf16 v[12:15], v[228:231], v[212:215], v[12:15]
    v_exp_f32 v201, v201
    ds_read_b64_tr_b16 v[224:225], v249 offset:192
    s_waitcnt lgkmcnt(7)
    v_mfma_f32_16x16x32_bf16 v[16:19], v[232:235], v[208:211], v[16:19]
    v_exp_f32 v194, v194
    ds_read_b64_tr_b16 v[226:227], v249 offset:704
    s_add_u32 s63, s63, s65
    v_mfma_f32_16x16x32_bf16 v[20:23], v[232:235], v[212:215], v[20:23]
    v_exp_f32 v202, v202
    ds_read_b64_tr_b16 v[228:229], v249 offset:224
    s_waitcnt lgkmcnt(7)
    v_mfma_f32_16x16x32_bf16 v[24:27], v[236:239], v[208:211], v[24:27]
    v_add_f32 v252, v192, v193
    v_add_f32 v253, v200, v201
    ds_read_b64_tr_b16 v[230:231], v249 offset:736
    s_cmp_gt_u32 s64, 101376
    v_mfma_f32_16x16x32_bf16 v[28:31], v[236:239], v[212:215], v[28:31]
    v_exp_f32 v195, v195
    ds_read_b64_tr_b16 v[232:233], v249 offset:256
    s_waitcnt lgkmcnt(7)
    v_mfma_f32_16x16x32_bf16 v[32:35], v[240:243], v[208:211], v[32:35]
    v_exp_f32 v203, v203
    ds_read_b64_tr_b16 v[234:235], v249 offset:768
    s_cselect_b32 s66, s68, s67
    v_mfma_f32_16x16x32_bf16 v[36:39], v[240:243], v[212:215], v[36:39]
    v_add_f32 v252, v252, v194
    v_add_f32 v253, v253, v202
    ds_read_b64_tr_b16 v[236:237], v249 offset:288
    s_waitcnt lgkmcnt(7)
    v_mfma_f32_16x16x32_bf16 v[40:43], v[244:247], v[208:211], v[40:43]
    v_exp_f32 v196, v196
    ds_read_b64_tr_b16 v[238:239], v249 offset:800
    s_add_u32 s64, s64, s66
    v_mfma_f32_16x16x32_bf16 v[44:47], v[244:247], v[212:215], v[44:47]
    v_exp_f32 v204, v204
    ds_read_b64_tr_b16 v[240:241], v249 offset:320
    s_waitcnt lgkmcnt(7)
    v_mfma_f32_16x16x32_bf16 v[48:51], v[224:227], v[208:211], v[48:51]
    v_add_f32 v252, v252, v195
    v_add_f32 v253, v253, v203
    ds_read_b64_tr_b16 v[242:243], v249 offset:832
    s_sub_u32 s69, s69, 1
    v_mfma_f32_16x16x32_bf16 v[52:55], v[224:227], v[212:215], v[52:55]
    v_exp_f32 v197, v197
    ds_read_b64_tr_b16 v[224:225], v249 offset:352
    s_waitcnt lgkmcnt(7)
    v_mfma_f32_16x16x32_bf16 v[56:59], v[228:231], v[208:211], v[56:59]
    v_exp_f32 v205, v205
    ds_read_b64_tr_b16 v[226:227], v249 offset:864
    s_cmp_eq_u32 s69, 0
    v_mfma_f32_16x16x32_bf16 v[60:63], v[228:231], v[212:215], v[60:63]
    v_add_f32 v252, v252, v196
    v_add_f32 v253, v253, v204
    ds_read_b64_tr_b16 v[228:229], v249 offset:384
    s_waitcnt lgkmcnt(7)
    v_mfma_f32_16x16x32_bf16 v[64:67], v[232:235], v[208:211], v[64:67]
    v_exp_f32 v198, v198
    ds_read_b64_tr_b16 v[230:231], v249 offset:896
    s_cselect_b32 s86, 1, 0
    v_mfma_f32_16x16x32_bf16 v[68:71], v[232:235], v[212:215], v[68:71]
    v_exp_f32 v206, v206
    ds_read_b64_tr_b16 v[232:233], v249 offset:416
    s_waitcnt lgkmcnt(7)
    v_mfma_f32_16x16x32_bf16 v[72:75], v[236:239], v[208:211], v[72:75]
    v_add_f32 v252, v252, v197
    v_add_f32 v253, v253, v205
    ds_read_b64_tr_b16 v[234:235], v249 offset:928
    s_mov_b32 s70, s86
    v_mfma_f32_16x16x32_bf16 v[76:79], v[236:239], v[212:215], v[76:79]
    v_exp_f32 v199, v199
    ds_read_b64_tr_b16 v[236:237], v249 offset:448
    s_waitcnt lgkmcnt(7)
    v_mfma_f32_16x16x32_bf16 v[80:83], v[240:243], v[208:211], v[80:83]
    v_exp_f32 v207, v207
    ds_read_b64_tr_b16 v[238:239], v249 offset:960
    v_mfma_f32_16x16x32_bf16 v[84:87], v[240:243], v[212:215], v[84:87]
    v_add_f32 v252, v252, v198
    v_add_f32 v253, v253, v206
    ds_read_b64_tr_b16 v[240:241], v249 offset:480
    s_waitcnt lgkmcnt(7)
    v_mfma_f32_16x16x32_bf16 v[88:91], v[224:227], v[208:211], v[88:91]
    v_add_f32 v252, v252, v199
    v_add_f32 v253, v253, v207
    ds_read_b64_tr_b16 v[242:243], v249 offset:992
    v_mfma_f32_16x16x32_bf16 v[92:95], v[224:227], v[212:215], v[92:95]
    v_max_f32 v254, v252, v253
    v_cmp_nge_f32 vcc, s62, v254
    v_add_u32 v248, s65, v248
    s_waitcnt lgkmcnt(6)
    v_mfma_f32_16x16x32_bf16 v[96:99], v[228:231], v[208:211], v[96:99]
    ds_read_b128 v[224:227], v248 offset:0
    v_mfma_f32_16x16x32_bf16 v[100:103], v[228:231], v[212:215], v[100:103]
    s_waitcnt lgkmcnt(5)
    v_mfma_f32_16x16x32_bf16 v[104:107], v[232:235], v[208:211], v[104:107]
    ds_read_b128 v[228:231], v248 offset:512
    v_mfma_f32_16x16x32_bf16 v[108:111], v[232:235], v[212:215], v[108:111]
    s_waitcnt lgkmcnt(4)
    v_mfma_f32_16x16x32_bf16 v[112:115], v[236:239], v[208:211], v[112:115]
    ds_read_b128 v[232:235], v248 offset:64
    v_mfma_f32_16x16x32_bf16 v[116:119], v[236:239], v[212:215], v[116:119]
    s_waitcnt lgkmcnt(3)
    v_mfma_f32_16x16x32_bf16 v[120:123], v[240:243], v[208:211], v[120:123]
    ds_read_b128 v[236:239], v248 offset:576
    v_mfma_f32_16x16x32_bf16 v[124:127], v[240:243], v[212:215], v[124:127]
    s_or_b64 s[88:89], vcc, s[86:87]
    s_cbranch_scc0 L_loop
L_post:
    s_cbranch_vccnz L_rare
L_ret1:
    v_cvt_pk_bf16_f32 v208, v192, v193
    v_cvt_pk_bf16_f32 v209, v194, v195
    s_waitcnt lgkmcnt(3)
    v_mfma_f32_16x16x32_bf16 v[192:195], v[224:227], v[128:131], v[216:219]
    v_cvt_pk_bf16_f32 v212, v200, v201
    v_cvt_pk_bf16_f32 v213, v202, v203
    ds_read_b128 v[240:243], v248 offset:128
    v_mfma_f32_16x16x32_bf16 v[200:203], v[224:227], v[160:163], v[220:223]
    v_cvt_pk_bf16_f32 v210, v196, v197
    v_cvt_pk_bf16_f32 v211, v198, v199
    s_waitcnt lgkmcnt(3)
    v_mfma_f32_16x16x32_bf16 v[196:199], v[228:231], v[128:131], v[216:219]
    v_cvt_pk_bf16_f32 v214, v204, v205
    v_cvt_pk_bf16_f32 v215, v206, v207
    ds_read_b128 v[244:247], v248 offset:640
    v_mfma_f32_16x16x32_bf16 v[204:207], v[228:231], v[160:163], v[220:223]
    v_add_f32 v250, v250, v252
    v_add_f32 v251, v251, v253
    s_waitcnt lgkmcnt(3)
    v_mfma_f32_16x16x32_bf16 v[192:195], v[232:235], v[132:135], v[192:195]
    ds_read_b128 v[224:227], v248 offset:192
    s_add_u32 s61, s61, 16384
    v_mfma_f32_16x16x32_bf16 v[200:203], v[232:235], v[164:167], v[200:203]
    s_waitcnt lgkmcnt(3)
    v_mfma_f32_16x16x32_bf16 v[196:199], v[236:239], v[132:135], v[196:199]
    ds_read_b128 v[228:231], v248 offset:704
    s_mov_b32 s70, 2
    v_mfma_f32_16x16x32_bf16 v[204:207], v[236:239], v[164:167], v[204:207]
    s_waitcnt lgkmcnt(3)
    v_mfma_f32_16x16x32_bf16 v[192:195], v[240:243], v[136:139], v[192:195]
    ds_read_b128 v[232:235], v248 offset:256
    v_mfma_f32_16x16x32_bf16 v[200:203], v[240:243], v[168:171], v[200:203]
    s_waitcnt lgkmcnt(3)
    v_mfma_f32_16x16x32_bf16 v[196:199], v[244:247], v[136:139], v[196:199]
    ds_read_b128 v[236:239], v248 offset:768
    v_mfma_f32_16x16x32_bf16 v[204:207], v[244:247], v[168:171], v[204:207]
    s_waitcnt lgkmcnt(3)
    v_mfma_f32_16x16x32_bf16 v[192:195], v[224:227], v[140:143], v[192:195]
    ds_read_b128 v[240:243], v248 offset:320
    v_mfma_f32_16x16x32_bf16 v[200:203], v[224:227], v[172:175], v[200:203]
    s_waitcnt lgkmcnt(3)
    v_mfma_f32_16x16x32_bf16 v[196:199], v[228:231], v[140:143], v[196:199]
    ds_read_b128 v[224:227], v248 offset:832
    v_mfma_f32_16x16x32_bf16 v[204:207], v[228:231], v[172:175], v[204:207]
    s_waitcnt lgkmcnt(3)
    v_mfma_f32_16x16x32_bf16 v[192:195], v[232:235], v[144:147], v[192:195]
    ds_read_b128 v[228:231], v248 offset:384
    v_mfma_f32_16x16x32_bf16 v[200:203], v[232:235], v[176:179], v[200:203]
    s_waitcnt lgkmcnt(3)
    v_mfma_f32_16x16x32_bf16 v[196:199], v[236:239], v[144:147], v[196:199]
    ds_read_b128 v[232:235], v248 offset:896
    v_mfma_f32_16x16x32_bf16 v[204:207], v[236:239], v[176:179], v[204:207]
    s_waitcnt lgkmcnt(3)
    v_mfma_f32_16x16x32_bf16 v[192:195], v[240:243], v[148:151], v[192:195]
    ds_read_b128 v[236:239], v248 offset:448
    v_mfma_f32_16x16x32_bf16 v[200:203], v[240:243], v[180:183], v[200:203]
    s_waitcnt lgkmcnt(3)
    v_mfma_f32_16x16x32_bf16 v[196:199], v[224:227], v[148:151], v[196:199]
    ds_read_b128 v[240:243], v248 offset:960
    v_mfma_f32_16x16x32_bf16 v[204:207], v[224:227], v[180:183], v[204:207]
    v_add_u32 v249, s66, v249
    ds_read_b64_tr_b16 v[224:225], v249 offset:0
    s_waitcnt lgkmcnt(4)
    v_mfma_f32_16x16x32_bf16 v[192:195], v[228:231], v[152:155], v[192:195]
    ds_read_b64_tr_b16 v[226:227], v249 offset:512
    v_mfma_f32_16x16x32_bf16 v[200:203], v[228:231], v[184:187], v[200:203]
    ds_read_b64_tr_b16 v[228:229], v249 offset:32
    s_waitcnt lgkmcnt(5)
    v_mfma_f32_16x16x32_bf16 v[196:199], v[232:235], v[152:155], v[196:199]
    ds_read_b64_tr_b16 v[230:231], v249 offset:544
    v_mfma_f32_16x16x32_bf16 v[204:207], v[232:235], v[184:187], v[204:207]
    ds_read_b64_tr_b16 v[232:233], v249 offset:64
    s_waitcnt lgkmcnt(6)
    v_mfma_f32_16x16x32_bf16 v[192:195], v[236:239], v[156:159], v[192:195]
    ds_read_b64_tr_b16 v[234:235], v249 offset:576
    v_mfma_f32_16x16x32_bf16 v[200:203], v[236:239], v[188:191], v[200:203]
    ds_read_b64_tr_b16 v[236:237], v249 offset:96
    s_waitcnt lgkmcnt(7)
    v_mfma_f32_16x16x32_bf16 v[196:199], v[240:243], v[156:159], v[196:199]
    ds_read_b64_tr_b16 v[238:239], v249 offset:608
    v_mfma_f32_16x16x32_bf16 v[204:207], v[240:243], v[188:191], v[204:207]
    ds_read_b64_tr_b16 v[240:241], v249 offset:128
    s_barrier
    s_waitcnt lgkmcnt(7)
    v_mfma_f32_16x16x32_bf16 v[0:3], v[224:227], v[208:211], v[0:3]
    v_exp_f32 v192, v192
    ds_read_b64_tr_b16 v[242:243], v249 offset:640
    v_mfma_f32_16x16x32_bf16 v[4:7], v[224:227], v[212:215], v[4:7]
    v_exp_f32 v200, v200
    ds_read_b64_tr_b16 v[244:245], v249 offset:160
    s_waitcnt lgkmcnt(7)
    v_mfma_f32_16x16x32_bf16 v[8:11], v[228:231], v[208:211], v[8:11]
    v_exp_f32 v193, v193
    ds_read_b64_tr_b16 v[246:247], v249 offset:672
    v_mfma_f32_16x16x32_bf16 v[12:15], v[228:231], v[212:215], v[12:15]
    v_exp_f32 v201, v201
    ds_read_b64_tr_b16 v[224:225], v249 offset:192
    s_waitcnt lgkmcnt(7)
    v_mfma_f32_16x16x32_bf16 v[16:19], v[232:235], v[208:211], v[16:19]
    v_exp_f32 v194, v194
    ds_read_b64_tr_b16 v[226:227], v249 offset:704
    v_mfma_f32_16x16x32_bf16 v[20:23], v[232:235], v[212:215], v[20:23]
    v_exp_f32 v202, v202
    ds_read_b64_tr_b16 v[228:229], v249 offset:224
    s_waitcnt lgkmcnt(7)
    v_mfma_f32_16x16x32_bf16 v[24:27], v[236:239], v[208:211], v[24:27]
    v_add_f32 v252, v192, v193
    v_add_f32 v253, v200, v201
    ds_read_b64_tr_b16 v[230:231], v249 offset:736
    v_mfma_f32_16x16x32_bf16 v[28:31], v[236:239], v[212:215], v[28:31]
    v_exp_f32 v195, v195
    ds_read_b64_tr_b16 v[232:233], v249 offset:256
    s_waitcnt lgkmcnt(7)
    v_mfma_f32_16x16x32_bf16 v[32:35], v[240:243], v[208:211], v[32:35]
    v_exp_f32 v203, v203
    ds_read_b64_tr_b16 v[234:235], v249 offset:768
    v_mfma_f32_16x16x32_bf16 v[36:39], v[240:243], v[212:215], v[36:39]
    v_add_f32 v252, v252, v194
    v_add_f32 v253, v253, v202
    ds_read_b64_tr_b16 v[236:237], v249 offset:288
    s_waitcnt lgkmcnt(7)
    v_mfma_f32_16x16x32_bf16 v[40:43], v[244:247], v[208:211], v[40:43]
    v_exp_f32 v196, v196
    ds_read_b64_tr_b16 v[238:239], v249 offset:800
    v_mfma_f32_16x16x32_bf16 v[44:47], v[244:247], v[212:215], v[44:47]
    v_exp_f32 v204, v204
    ds_read_b64_tr_b16 v[240:241], v249 offset:320
    s_waitcnt lgkmcnt(7)
    v_mfma_f32_16x16x32_bf16 v[48:51], v[224:227], v[208:211], v[48:51]
    v_add_f32 v252, v252, v195
    v_add_f32 v253, v253, v203
    ds_read_b64_tr_b16 v[242:243], v249 offset:832
    v_mfma_f32_16x16x32_bf16 v[52:55], v[224:227], v[212:215], v[52:55]
    v_exp_f32 v197, v197
    ds_read_b64_tr_b16 v[224:225], v249 offset:352
    s_waitcnt lgkmcnt(7)
    v_mfma_f32_16x16x32_bf16 v[56:59], v[228:231], v[208:211], v[56:59]
    v_exp_f32 v205, v205
    ds_read_b64_tr_b16 v[226:227], v249 offset:864
    v_mfma_f32_16x16x32_bf16 v[60:63], v[228:231], v[212:215], v[60:63]
    v_add_f32 v252, v252, v196
    v_add_f32 v253, v253, v204
    ds_read_b64_tr_b16 v[228:229], v249 offset:384
    s_waitcnt lgkmcnt(7)
    v_mfma_f32_16x16x32_bf16 v[64:67], v[232:235], v[208:211], v[64:67]
    v_exp_f32 v198, v198
    ds_read_b64_tr_b16 v[230:231], v249 offset:896
    v_mfma_f32_16x16x32_bf16 v[68:71], v[232:235], v[212:215], v[68:71]
    v_exp_f32 v206, v206
    ds_read_b64_tr_b16 v[232:233], v249 offset:416
    s_waitcnt lgkmcnt(7)
    v_mfma_f32_16x16x32_bf16 v[72:75], v[236:239], v[208:211], v[72:75]
    v_add_f32 v252, v252, v197
    v_add_f32 v253, v253, v205
    ds_read_b64_tr_b16 v[234:235], v249 offset:928
    v_mfma_f32_16x16x32_bf16 v[76:79], v[236:239], v[212:215], v[76:79]
    v_exp_f32 v199, v199
    ds_read_b64_tr_b16 v[236:237], v249 offset:448
    s_waitcnt lgkmcnt(7)
    v_mfma_f32_16x16x32_bf16 v[80:83], v[240:243], v[208:211], v[80:83]
    v_exp_f32 v207, v207
    ds_read_b64_tr_b16 v[238:239], v249 offset:960
    v_mfma_f32_16x16x32_bf16 v[84:87], v[240:243], v[212:215], v[84:87]
    v_add_f32 v252, v252, v198
    v_add_f32 v253, v253, v206
    ds_read_b64_tr_b16 v[240:241], v249 offset:480
    s_waitcnt lgkmcnt(7)
    v_mfma_f32_16x16x32_bf16 v[88:91], v[224:227], v[208:211], v[88:91]
    v_add_f32 v252, v252, v199
    v_add_f32 v253, v253, v207
    ds_read_b64_tr_b16 v[242:243], v249 offset:992
    v_mfma_f32_16x16x32_bf16 v[92:95], v[224:227], v[212:215], v[92:95]
    v_max_f32 v254, v252, v253
    v_cmp_nge_f32 vcc, s62, v254
    v_add_u32 v249, 0x4200, v249
    ds_read_b64_tr_b16 v[224:225], v249 offset:0
    s_waitcnt lgkmcnt(7)
    v_mfma_f32_16x16x32_bf16 v[96:99], v[228:231], v[208:211], v[96:99]
    ds_read_b64_tr_b16 v[226:227], v249 offset:512
    v_mfma_f32_16x16x32_bf16 v[100:103], v[228:231], v[212:215], v[100:103]
    ds_read_b64_tr_b16 v[228:229], v249 offset:32
    s_waitcnt lgkmcnt(7)
    v_mfma_f32_16x16x32_bf16 v[104:107], v[232:235], v[208:211], v[104:107]
    ds_read_b64_tr_b16 v[230:231], v249 offset:544
    v_mfma_f32_16x16x32_bf16 v[108:111], v[232:235], v[212:215], v[108:111]
    ds_read_b64_tr_b16 v[232:233], v249 offset:64
    s_waitcnt lgkmcnt(7)
    v_mfma_f32_16x16x32_bf16 v[112:115], v[236:239], v[208:211], v[112:115]
    ds_read_b64_tr_b16 v[234:235], v249 offset:576
    v_mfma_f32_16x16x32_bf16 v[116:119], v[236:239], v[212:215], v[116:119]
    ds_read_b64_tr_b16 v[236:237], v249 offset:96
    s_waitcnt lgkmcnt(7)
    v_mfma_f32_16x16x32_bf16 v[120:123], v[240:243], v[208:211], v[120:123]
    ds_read_b64_tr_b16 v[238:239], v249 offset:608
    v_mfma_f32_16x16x32_bf16 v[124:127], v[240:243], v[212:215], v[124:127]
    ds_read_b64_tr_b16 v[240:241], v249 offset:128
    s_cbranch_vccnz L_rare
L_ret2:
    v_cvt_pk_bf16_f32 v208, v192, v193
    v_cvt_pk_bf16_f32 v209, v194, v195
    v_cvt_pk_bf16_f32 v210, v196, v197
    v_cvt_pk_bf16_f32 v211, v198, v199
    v_cvt_pk_bf16_f32 v212, v200, v201
    v_cvt_pk_bf16_f32 v213, v202, v203
    v_cvt_pk_bf16_f32 v214, v204, v205
    v_cvt_pk_bf16_f32 v215, v206, v207
    s_waitcnt lgkmcnt(7)
    v_mfma_f32_16x16x32_bf16 v[0:3], v[224:227], v[208:211], v[0:3]
    v_add_f32 v250, v250, v252
    v_add_f32 v251, v251, v253
    ds_read_b64_tr_b16 v[242:243], v249 offset:640
    v_mfma_f32_16x16x32_bf16 v[4:7], v[224:227], v[212:215], v[4:7]
    v_mov_b32 v254, v250
    v_mov_b32 v255, v251
    ds_read_b64_tr_b16 v[244:245], v249 offset:160
    s_waitcnt lgkmcnt(7)
    v_mfma_f32_16x16x32_bf16 v[8:11], v[228:231], v[208:211], v[8:11]
    v_permlane16_swap_b32 v250, v254
    ds_read_b64_tr_b16 v[246:247], v249 offset:672
    v_mfma_f32_16x16x32_bf16 v[12:15], v[228:231], v[212:215], v[12:15]
    v_permlane16_swap_b32 v251, v255
    ds_read_b64_tr_b16 v[224:225], v249 offset:192
    s_waitcnt lgkmcnt(7)
    v_mfma_f32_16x16x32_bf16 v[16:19], v[232:235], v[208:211], v[16:19]
    v_add_f32 v250, v250, v254
    v_add_f32 v251, v251, v255
    ds_read_b64_tr_b16 v[226:227], v249 offset:704
    v_mfma_f32_16x16x32_bf16 v[20:23], v[232:235], v[212:215], v[20:23]
    v_mov_b32 v254, v250
    v_mov_b32 v255, v251
    ds_read_b64_tr_b16 v[228:229], v249 offset:224
    s_waitcnt lgkmcnt(7)
    v_mfma_f32_16x16x32_bf16 v[24:27], v[236:239], v[208:211], v[24:27]
    v_permlane32_swap_b32 v250, v254
    ds_read_b64_tr_b16 v[230:231], v249 offset:736
    v_mfma_f32_16x16x32_bf16 v[28:31], v[236:239], v[212:215], v[28:31]
    v_permlane32_swap_b32 v251, v255
    ds_read_b64_tr_b16 v[232:233], v249 offset:256
    s_waitcnt lgkmcnt(7)
    v_mfma_f32_16x16x32_bf16 v[32:35], v[240:243], v[208:211], v[32:35]
    v_add_f32 v250, v250, v254
    v_add_f32 v251, v251, v255
    ds_read_b64_tr_b16 v[234:235], v249 offset:768
    v_mfma_f32_16x16x32_bf16 v[36:39], v[240:243], v[212:215], v[36:39]
    v_cvt_pk_bf16_f32 v128, v0, v1
    v_cvt_pk_bf16_f32 v129, v2, v3
    ds_read_b64_tr_b16 v[236:237], v249 offset:288
    s_waitcnt lgkmcnt(7)
    v_mfma_f32_16x16x32_bf16 v[40:43], v[244:247], v[208:211], v[40:43]
    v_cvt_pk_bf16_f32 v130, v8, v9
    v_cvt_pk_bf16_f32 v131, v10, v11
    ds_read_b64_tr_b16 v[238:239], v249 offset:800
    v_mfma_f32_16x16x32_bf16 v[44:47], v[244:247], v[212:215], v[44:47]
    v_cvt_pk_bf16_f32 v160, v4, v5
    v_cvt_pk_bf16_f32 v161, v6, v7
    ds_read_b64_tr_b16 v[240:241], v249 offset:320
    s_waitcnt lgkmcnt(7)
    v_mfma_f32_16x16x32_bf16 v[48:51], v[224:227], v[208:211], v[48:51]
    v_cvt_pk_bf16_f32 v162, v12, v13
    v_cvt_pk_bf16_f32 v163, v14, v15
    ds_read_b64_tr_b16 v[242:243], v249 offset:832
    v_mfma_f32_16x16x32_bf16 v[52:55], v[224:227], v[212:215], v[52:55]
    v_cvt_pk_bf16_f32 v132, v16, v17
    v_cvt_pk_bf16_f32 v133, v18, v19
    ds_read_b64_tr_b16 v[224:225], v249 offset:352
    s_waitcnt lgkmcnt(7)
    v_mfma_f32_16x16x32_bf16 v[56:59], v[228:231], v[208:211], v[56:59]
    v_cvt_pk_bf16_f32 v134, v24, v25
    v_cvt_pk_bf16_f32 v135, v26, v27
    ds_read_b64_tr_b16 v[226:227], v249 offset:864
    v_mfma_f32_16x16x32_bf16 v[60:63], v[228:231], v[212:215], v[60:63]
    v_cvt_pk_bf16_f32 v164, v20, v21
    v_cvt_pk_bf16_f32 v165, v22, v23
    ds_read_b64_tr_b16 v[228:229], v249 offset:384
    s_waitcnt lgkmcnt(7)
    v_mfma_f32_16x16x32_bf16 v[64:67], v[232:235], v[208:211], v[64:67]
    v_cvt_pk_bf16_f32 v166, v28, v29
    v_cvt_pk_bf16_f32 v167, v30, v31
    ds_read_b64_tr_b16 v[230:231], v249 offset:896
    v_mfma_f32_16x16x32_bf16 v[68:71], v[232:235], v[212:215], v[68:71]
    v_cvt_pk_bf16_f32 v136, v32, v33
    v_cvt_pk_bf16_f32 v137, v34, v35
    ds_read_b64_tr_b16 v[232:233], v249 offset:416
    s_waitcnt lgkmcnt(7)
    v_mfma_f32_16x16x32_bf16 v[72:75], v[236:239], v[208:211], v[72:75]
    v_cvt_pk_bf16_f32 v138, v40, v41
    v_cvt_pk_bf16_f32 v139, v42, v43
    ds_read_b64_tr_b16 v[234:235], v249 offset:928
    v_mfma_f32_16x16x32_bf16 v[76:79], v[236:239], v[212:215], v[76:79]
    v_cvt_pk_bf16_f32 v168, v36, v37
    v_cvt_pk_bf16_f32 v169, v38, v39
    ds_read_b64_tr_b16 v[236:237], v249 offset:448
    s_waitcnt lgkmcnt(7)
    v_mfma_f32_16x16x32_bf16 v[80:83], v[240:243], v[208:211], v[80:83]
    v_cvt_pk_bf16_f32 v170, v44, v45
    v_cvt_pk_bf16_f32 v171, v46, v47
    ds_read_b64_tr_b16 v[238:239], v249 offset:960
    v_mfma_f32_16x16x32_bf16 v[84:87], v[240:243], v[212:215], v[84:87]
    v_cvt_pk_bf16_f32 v140, v48, v49
    v_cvt_pk_bf16_f32 v141, v50, v51
    ds_read_b64_tr_b16 v[240:241], v249 offset:480
    s_waitcnt lgkmcnt(7)
    v_mfma_f32_16x16x32_bf16 v[88:91], v[224:227], v[208:211], v[88:91]
    v_cvt_pk_bf16_f32 v142, v56, v57
    v_cvt_pk_bf16_f32 v143, v58, v59
    ds_read_b64_tr_b16 v[242:243], v249 offset:992
    v_mfma_f32_16x16x32_bf16 v[92:95], v[224:227], v[212:215], v[92:95]
    v_cvt_pk_bf16_f32 v172, v52, v53
    v_cvt_pk_bf16_f32 v173, v54, v55
    v_add_u32 v249, 0x4200, v249
    ds_read_b64_tr_b16 v[224:225], v249 offset:0
    s_waitcnt lgkmcnt(7)
    v_mfma_f32_16x16x32_bf16 v[96:99], v[228:231], v[208:211], v[96:99]
    v_cvt_pk_bf16_f32 v174, v60, v61
    v_cvt_pk_bf16_f32 v175, v62, v63
    ds_read_b64_tr_b16 v[226:227], v249 offset:128
    v_mfma_f32_16x16x32_bf16 v[100:103], v[228:231], v[212:215], v[100:103]
    ds_read_b64_tr_b16 v[228:229], v249 offset:32
    s_waitcnt lgkmcnt(7)
    v_mfma_f32_16x16x32_bf16 v[104:107], v[232:235], v[208:211], v[104:107]
    ds_read_b64_tr_b16 v[230:231], v249 offset:160
    v_mfma_f32_16x16x32_bf16 v[108:111], v[232:235], v[212:215], v[108:111]
    ds_read_b64_tr_b16 v[232:233], v249 offset:64
    s_waitcnt lgkmcnt(7)
    v_mfma_f32_16x16x32_bf16 v[112:115], v[236:239], v[208:211], v[112:115]
    ds_read_b64_tr_b16 v[234:235], v249 offset:192
    v_mfma_f32_16x16x32_bf16 v[116:119], v[236:239], v[212:215], v[116:119]
    ds_read_b64_tr_b16 v[236:237], v249 offset:96
    s_waitcnt lgkmcnt(7)
    v_mfma_f32_16x16x32_bf16 v[120:123], v[240:243], v[208:211], v[120:123]
    ds_read_b64_tr_b16 v[238:239], v249 offset:224
    v_mfma_f32_16x16x32_bf16 v[124:127], v[240:243], v[212:215], v[124:127]
    ds_read_b64_tr_b16 v[240:241], v249 offset:256
    s_barrier
    s_waitcnt lgkmcnt(7)
    v_mfma_f32_16x16x32_bf16 v[0:3], v[224:227], v[128:131], 0
    v_cvt_pk_bf16_f32 v144, v64, v65
    v_cvt_pk_bf16_f32 v145, v66, v67
    ds_read_b64_tr_b16 v[242:243], v249 offset:384
    v_mfma_f32_16x16x32_bf16 v[4:7], v[224:227], v[160:163], 0
    v_cvt_pk_bf16_f32 v146, v72, v73
    v_cvt_pk_bf16_f32 v147, v74, v75
    ds_read_b64_tr_b16 v[244:245], v249 offset:288
    s_waitcnt lgkmcnt(7)
    v_mfma_f32_16x16x32_bf16 v[8:11], v[228:231], v[128:131], 0
    v_cvt_pk_bf16_f32 v176, v68, v69
    v_cvt_pk_bf16_f32 v177, v70, v71
    ds_read_b64_tr_b16 v[246:247], v249 offset:416
    v_mfma_f32_16x16x32_bf16 v[12:15], v[228:231], v[160:163], 0
    v_cvt_pk_bf16_f32 v178, v76, v77
    v_cvt_pk_bf16_f32 v179, v78, v79
    ds_read_b64_tr_b16 v[224:225], v249 offset:320
    s_waitcnt lgkmcnt(7)
    v_mfma_f32_16x16x32_bf16 v[16:19], v[232:235], v[128:131], 0
    v_cvt_pk_bf16_f32 v148, v80, v81
    v_cvt_pk_bf16_f32 v149, v82, v83
    ds_read_b64_tr_b16 v[226:227], v249 offset:448
    v_mfma_f32_16x16x32_bf16 v[20:23], v[232:235], v[160:163], 0
    v_cvt_pk_bf16_f32 v150, v88, v89
    v_cvt_pk_bf16_f32 v151, v90, v91
    ds_read_b64_tr_b16 v[228:229], v249 offset:352
    s_waitcnt lgkmcnt(7)
    v_mfma_f32_16x16x32_bf16 v[24:27], v[236:239], v[128:131], 0
    v_cvt_pk_bf16_f32 v180, v84, v85
    v_cvt_pk_bf16_f32 v181, v86, v87
    ds_read_b64_tr_b16 v[230:231], v249 offset:480
    v_mfma_f32_16x16x32_bf16 v[28:31], v[236:239], v[160:163], 0
    v_cvt_pk_bf16_f32 v182, v92, v93
    v_cvt_pk_bf16_f32 v183, v94, v95
    ds_read_b64_tr_b16 v[232:233], v249 offset:512
    s_waitcnt lgkmcnt(7)
    v_mfma_f32_16x16x32_bf16 v[0:3], v[240:243], v[132:135], v[0:3]
    v_cvt_pk_bf16_f32 v152, v96, v97
    v_cvt_pk_bf16_f32 v153, v98, v99
    ds_read_b64_tr_b16 v[234:235], v249 offset:640
    v_mfma_f32_16x16x32_bf16 v[4:7], v[240:243], v[164:167], v[4:7]
    v_cvt_pk_bf16_f32 v154, v104, v105
    v_cvt_pk_bf16_f32 v155, v106, v107
    ds_read_b64_tr_b16 v[236:237], v249 offset:544
    s_waitcnt lgkmcnt(7)
    v_mfma_f32_16x16x32_bf16 v[8:11], v[244:247], v[132:135], v[8:11]
    v_cvt_pk_bf16_f32 v184, v100, v101
    v_cvt_pk_bf16_f32 v185, v102, v103
    ds_read_b64_tr_b16 v[238:239], v249 offset:672
    v_mfma_f32_16x16x32_bf16 v[12:15], v[244:247], v[164:167], v[12:15]
    v_cvt_pk_bf16_f32 v186, v108, v109
    v_cvt_pk_bf16_f32 v187, v110, v111
    ds_read_b64_tr_b16 v[240:241], v249 offset:576
    s_waitcnt lgkmcnt(7)
    v_mfma_f32_16x16x32_bf16 v[16:19], v[224:227], v[132:135], v[16:19]
    v_cvt_pk_bf16_f32 v156, v112, v113
    v_cvt_pk_bf16_f32 v157, v114, v115
    ds_read_b64_tr_b16 v[242:243], v249 offset:704
    v_mfma_f32_16x16x32_bf16 v[20:23], v[224:227], v[164:167], v[20:23]
    v_cvt_pk_bf16_f32 v158, v120, v121
    v_cvt_pk_bf16_f32 v159, v122, v123
    ds_read_b64_tr_b16 v[224:225], v249 offset:608
    s_waitcnt lgkmcnt(7)
    v_mfma_f32_16x16x32_bf16 v[24:27], v[228:231], v[132:135], v[24:27]
    v_cvt_pk_bf16_f32 v188, v116, v117
    v_cvt_pk_bf16_f32 v189, v118, v119
    ds_read_b64_tr_b16 v[226:227], v249 offset:736
    v_mfma_f32_16x16x32_bf16 v[28:31], v[228:231], v[164:167], v[28:31]
    v_cvt_pk_bf16_f32 v190, v124, v125
    v_cvt_pk_bf16_f32 v191, v126, v127
    ds_read_b64_tr_b16 v[228:229], v249 offset:768
    s_waitcnt lgkmcnt(7)
    v_mfma_f32_16x16x32_bf16 v[0:3], v[232:235], v[136:139], v[0:3]
    v_rcp_f32 v250, v250
    ds_read_b64_tr_b16 v[230:231], v249 offset:896
    v_mfma_f32_16x16x32_bf16 v[4:7], v[232:235], v[168:171], v[4:7]
    v_rcp_f32 v251, v251
    ds_read_b64_tr_b16 v[232:233], v249 offset:800
    s_waitcnt lgkmcnt(7)
    v_mfma_f32_16x16x32_bf16 v[8:11], v[236:239], v[136:139], v[8:11]
    v_mbcnt_lo_u32_b32 v254, -1, 0
    v_mbcnt_hi_u32_b32 v254, -1, v254
    s_waitcnt vmcnt(0)
    ds_read_b64_tr_b16 v[234:235], v249 offset:928
    v_mfma_f32_16x16x32_bf16 v[12:15], v[236:239], v[168:171], v[12:15]
    v_lshlrev_b32 v248, 4, v254
    s_add_u32 s71, s74, s75
    v_add_u32 v248, s71, v248
    s_lshl_b32 s71, s3, 7
    s_lshl_b32 s72, s26, 2
    s_add_u32 s71, s71, s72
    ds_read_b64_tr_b16 v[236:237], v249 offset:832
    s_waitcnt lgkmcnt(7)
    v_mfma_f32_16x16x32_bf16 v[16:19], v[240:243], v[136:139], v[16:19]
    v_lshlrev_b32 v252, 16, v254
    v_add_u32 v252, s71, v252
    ds_read_b64_tr_b16 v[238:239], v249 offset:960
    v_mfma_f32_16x16x32_bf16 v[20:23], v[240:243], v[168:171], v[20:23]
    ds_read_b64_tr_b16 v[240:241], v249 offset:864
    s_waitcnt lgkmcnt(7)
    v_mfma_f32_16x16x32_bf16 v[24:27], v[224:227], v[136:139], v[24:27]
    ds_read_b64_tr_b16 v[242:243], v249 offset:992
    v_mfma_f32_16x16x32_bf16 v[28:31], v[224:227], v[168:171], v[28:31]
    v_add_u32 v249, 0x4200, v249
    ds_read_b64_tr_b16 v[224:225], v249 offset:0
    v_mov_b32 v223, 160000
    s_waitcnt lgkmcnt(7)
    v_mfma_f32_16x16x32_bf16 v[0:3], v[228:231], v[140:143], v[0:3]
    ds_read_b64_tr_b16 v[226:227], v249 offset:128
    v_mfma_f32_16x16x32_bf16 v[4:7], v[228:231], v[172:175], v[4:7]
    ds_read_b64_tr_b16 v[228:229], v249 offset:32
    s_waitcnt lgkmcnt(7)
    v_mfma_f32_16x16x32_bf16 v[8:11], v[232:235], v[140:143], v[8:11]
    ds_read_b64_tr_b16 v[230:231], v249 offset:160
    ds_read_b32 v223, v223
    v_mfma_f32_16x16x32_bf16 v[12:15], v[232:235], v[172:175], v[12:15]
    ds_read_b64_tr_b16 v[232:233], v249 offset:64
    s_waitcnt lgkmcnt(8)
    v_mfma_f32_16x16x32_bf16 v[16:19], v[236:239], v[140:143], v[16:19]
    ds_read_b64_tr_b16 v[234:235], v249 offset:192
    v_mfma_f32_16x16x32_bf16 v[20:23], v[236:239], v[172:175], v[20:23]
    ds_read_b64_tr_b16 v[236:237], v249 offset:96
    s_waitcnt lgkmcnt(8)
    v_mfma_f32_16x16x32_bf16 v[24:27], v[240:243], v[140:143], v[24:27]
    ds_read_b64_tr_b16 v[238:239], v249 offset:224
    v_mfma_f32_16x16x32_bf16 v[28:31], v[240:243], v[172:175], v[28:31]
    ds_read_b64_tr_b16 v[240:241], v249 offset:256
    s_waitcnt lgkmcnt(8)
    v_mfma_f32_16x16x32_bf16 v[0:3], v[224:227], v[144:147], v[0:3]
    v_mbcnt_lo_u32_b32 v220, -1, 0
    v_mbcnt_hi_u32_b32 v220, -1, v220
    ds_read_b64_tr_b16 v[242:243], v249 offset:384
    v_mfma_f32_16x16x32_bf16 v[4:7], v[224:227], v[176:179], v[4:7]
    v_and_b32 v221, 15, v220
    v_mov_b32 v208, 0
    ds_read_b64_tr_b16 v[244:245], v249 offset:288
    s_waitcnt lgkmcnt(8)
    v_mfma_f32_16x16x32_bf16 v[8:11], v[228:231], v[144:147], v[8:11]
    v_cmp_eq_u32 vcc, 0, v221
    v_mov_b32 v222, 0x3f80
    ds_read_b64_tr_b16 v[246:247], v249 offset:416
    v_mfma_f32_16x16x32_bf16 v[12:15], v[228:231], v[176:179], v[12:15]
    v_cndmask_b32 v208, v208, v222, vcc
    v_cmp_eq_u32 vcc, 1, v221
    ds_read_b64_tr_b16 v[224:225], v249 offset:320
    s_waitcnt lgkmcnt(7)
    v_mfma_f32_16x16x32_bf16 v[16:19], v[232:235], v[144:147], v[16:19]
    v_mov_b32 v222, 0x3f800000
    v_cndmask_b32 v208, v208, v222, vcc
    ds_read_b64_tr_b16 v[226:227], v249 offset:448
    v_mfma_f32_16x16x32_bf16 v[20:23], v[232:235], v[176:179], v[20:23]
    v_mov_b32 v209, 0
    v_cmp_eq_u32 vcc, 2, v221
    ds_read_b64_tr_b16 v[228:229], v249 offset:352
    s_waitcnt lgkmcnt(7)
    v_mfma_f32_16x16x32_bf16 v[24:27], v[236:239], v[144:147], v[24:27]
    v_mov_b32 v222, 0x3f80
    v_cndmask_b32 v209, v209, v222, vcc
    ds_read_b64_tr_b16 v[230:231], v249 offset:480
    v_mfma_f32_16x16x32_bf16 v[28:31], v[236:239], v[176:179], v[28:31]
    v_cmp_eq_u32 vcc, 3, v221
    v_mov_b32 v222, 0x3f800000
    ds_read_b64_tr_b16 v[232:233], v249 offset:512
    s_waitcnt lgkmcnt(7)
    v_mfma_f32_16x16x32_bf16 v[0:3], v[240:243], v[148:151], v[0:3]
    v_cndmask_b32 v209, v209, v222, vcc
    v_mov_b32 v210, 0
    ds_read_b64_tr_b16 v[234:235], v249 offset:640
    v_mfma_f32_16x16x32_bf16 v[4:7], v[240:243], v[180:183], v[4:7]
    v_cmp_eq_u32 vcc, 4, v221
    v_mov_b32 v222, 0x3f80
    ds_read_b64_tr_b16 v[236:237], v249 offset:544
    s_waitcnt lgkmcnt(7)
    v_mfma_f32_16x16x32_bf16 v[8:11], v[244:247], v[148:151], v[8:11]
    v_cndmask_b32 v210, v210, v222, vcc
    v_cmp_eq_u32 vcc, 5, v221
    ds_read_b64_tr_b16 v[238:239], v249 offset:672
    v_mfma_f32_16x16x32_bf16 v[12:15], v[244:247], v[180:183], v[12:15]
    v_mov_b32 v222, 0x3f800000
    v_cndmask_b32 v210, v210, v222, vcc
    ds_read_b64_tr_b16 v[240:241], v249 offset:576
    s_waitcnt lgkmcnt(7)
    v_mfma_f32_16x16x32_bf16 v[16:19], v[224:227], v[148:151], v[16:19]
    v_mov_b32 v211, 0
    v_cmp_eq_u32 vcc, 6, v221
    ds_read_b64_tr_b16 v[242:243], v249 offset:704
    v_mfma_f32_16x16x32_bf16 v[20:23], v[224:227], v[180:183], v[20:23]
    v_mov_b32 v222, 0x3f80
    v_cndmask_b32 v211, v211, v222, vcc
    ds_read_b64_tr_b16 v[224:225], v249 offset:608
    s_waitcnt lgkmcnt(7)
    v_mfma_f32_16x16x32_bf16 v[24:27], v[228:231], v[148:151], v[24:27]
    v_cmp_eq_u32 vcc, 7, v221
    v_mov_b32 v222, 0x3f800000
    ds_read_b64_tr_b16 v[226:227], v249 offset:736
    s_mov_b32 s64, 84480
    v_mfma_f32_16x16x32_bf16 v[28:31], v[228:231], v[180:183], v[28:31]
    v_cndmask_b32 v211, v211, v222, vcc
    v_lshrrev_b32 v222, 4, v220
    ds_read_b64_tr_b16 v[228:229], v249 offset:768
    s_waitcnt lgkmcnt(7)
    v_mfma_f32_16x16x32_bf16 v[0:3], v[232:235], v[152:155], v[0:3]
    v_mul_u32_u24 v216, 0x31000, v222
    v_lshl_add_u32 v216, v221, 4, v216
    ds_read_b64_tr_b16 v[230:231], v249 offset:896
    s_mov_b32 s67, 16896
    v_mfma_f32_16x16x32_bf16 v[4:7], v[232:235], v[184:187], v[4:7]
    v_mul_u32_u24 v217, 1792, v221
    v_and_b32 v221, 1, v222
    ds_read_b64_tr_b16 v[232:233], v249 offset:800
    s_waitcnt lgkmcnt(7)
    v_mfma_f32_16x16x32_bf16 v[8:11], v[236:239], v[152:155], v[8:11]
    v_lshl_add_u32 v217, v221, 5, v217
    v_lshrrev_b32 v221, 1, v222
    ds_read_b64_tr_b16 v[234:235], v249 offset:928
    s_mov_b32 s68, -135168
    v_mfma_f32_16x16x32_bf16 v[12:15], v[236:239], v[184:187], v[12:15]
    v_lshl_add_u32 v217, v221, 7, v217
    s_mul_i32 s29, s26, 7
    s_add_u32 s29, s29, s3
    s_lshr_b32 s71, s29, 4
    s_lshl_b32 s71, s71, 7
    v_and_b32 v218, 15, v220
    ds_read_b64_tr_b16 v[236:237], v249 offset:832
    s_waitcnt lgkmcnt(7)
    v_mfma_f32_16x16x32_bf16 v[16:19], v[240:243], v[152:155], v[16:19]
    v_lshlrev_b32 v218, 2, v218
    v_add_u32 v218, s71, v218
    s_lshr_b32 s30, s29, 3
    s_mul_i32 s30, s30, 28672
    s_and_b32 s71, s29, 3
    s_lshl_b32 s71, s71, 3
    s_add_u32 s30, s30, s71
    s_and_b32 s71, s29, 4
    s_lshl_b32 s71, s71, 4
    s_add_u32 s30, s30, s71
    s_lshl_b32 s29, s29, 8
    ds_read_b64_tr_b16 v[238:239], v249 offset:960
    s_mov_b32 s73, 0
    v_mfma_f32_16x16x32_bf16 v[20:23], v[240:243], v[184:187], v[20:23]
    v_mov_b32 v253, s90
    ds_read_b64_tr_b16 v[240:241], v249 offset:864
    s_waitcnt lgkmcnt(7)
    v_mfma_f32_16x16x32_bf16 v[24:27], v[224:227], v[152:155], v[24:27]
    ds_read_b64_tr_b16 v[242:243], v249 offset:992
    s_mov_b32 s69, 3
    v_mfma_f32_16x16x32_bf16 v[28:31], v[224:227], v[184:187], v[28:31]
    v_add_u32 v249, 0x4200, v249
    ds_read_b64_tr_b16 v[224:225], v249 offset:0
    s_waitcnt lgkmcnt(7)
    v_mfma_f32_16x16x32_bf16 v[0:3], v[228:231], v[156:159], v[0:3]
    ds_read_b64_tr_b16 v[226:227], v249 offset:128
    v_readfirstlane_b32 s91, v223
    v_mfma_f32_16x16x32_bf16 v[4:7], v[228:231], v[188:191], v[4:7]
    ds_read_b64_tr_b16 v[228:229], v249 offset:32
    s_waitcnt lgkmcnt(7)
    v_mfma_f32_16x16x32_bf16 v[8:11], v[232:235], v[156:159], v[8:11]
    ds_read_b64_tr_b16 v[230:231], v249 offset:160
    v_mfma_f32_16x16x32_bf16 v[12:15], v[232:235], v[188:191], v[12:15]
    ds_read_b64_tr_b16 v[232:233], v249 offset:64
    s_waitcnt lgkmcnt(7)
    v_mfma_f32_16x16x32_bf16 v[16:19], v[236:239], v[156:159], v[16:19]
    ds_read_b64_tr_b16 v[234:235], v249 offset:192
    v_mfma_f32_16x16x32_bf16 v[20:23], v[236:239], v[188:191], v[20:23]
    ds_read_b64_tr_b16 v[236:237], v249 offset:96
    s_waitcnt lgkmcnt(7)
    v_mfma_f32_16x16x32_bf16 v[24:27], v[240:243], v[156:159], v[24:27]
    ds_read_b64_tr_b16 v[238:239], v249 offset:224
    s_cmp_eq_u32 s91, 1
    v_mfma_f32_16x16x32_bf16 v[28:31], v[240:243], v[188:191], v[28:31]
    ds_read_b64_tr_b16 v[240:241], v249 offset:256
    s_cbranch_scc0 L_oloopR
.p2align 6
L_oloopL:
    s_barrier
    s_waitcnt lgkmcnt(7)
    v_mfma_f32_16x16x32_bf16 v[32:35], v[224:227], v[128:131], 0
    ds_read_b64_tr_b16 v[242:243], v249 offset:384
    s_cmp_eq_u32 s64, 135168
    v_mfma_f32_16x16x32_bf16 v[36:39], v[224:227], v[160:163], 0
    v_mul_f32 v0, v0, v250
    v_mul_f32 v1, v1, v250
    ds_read_b64_tr_b16 v[244:245], v249 offset:288
    s_waitcnt lgkmcnt(7)
    v_mfma_f32_16x16x32_bf16 v[40:43], v[228:231], v[128:131], 0
    v_mul_f32 v2, v2, v250
    v_mul_f32 v3, v3, v250
    ds_read_b64_tr_b16 v[246:247], v249 offset:416
    s_cselect_b32 s66, s68, s67
    v_mfma_f32_16x16x32_bf16 v[44:47], v[228:231], v[160:163], 0
    v_cvt_pk_bf16_f32 v192, v0, v1
    v_cvt_pk_bf16_f32 v193, v2, v3
    ds_read_b64_tr_b16 v[224:225], v249 offset:320
    s_waitcnt lgkmcnt(7)
    v_mfma_f32_16x16x32_bf16 v[48:51], v[232:235], v[128:131], 0
    v_mul_f32 v8, v8, v250
    v_mul_f32 v9, v9, v250
    ds_read_b64_tr_b16 v[226:227], v249 offset:448
    s_add_u32 s64, s64, s66
    v_mfma_f32_16x16x32_bf16 v[52:55], v[232:235], v[160:163], 0
    v_mul_f32 v10, v10, v250
    v_mul_f32 v11, v11, v250
    ds_read_b64_tr_b16 v[228:229], v249 offset:352
    s_waitcnt lgkmcnt(7)
    v_mfma_f32_16x16x32_bf16 v[56:59], v[236:239], v[128:131], 0
    v_cvt_pk_bf16_f32 v194, v8, v9
    v_cvt_pk_bf16_f32 v195, v10, v11
    ds_read_b64_tr_b16 v[230:231], v249 offset:480
    v_mfma_f32_16x16x32_bf16 v[60:63], v[236:239], v[160:163], 0
    buffer_store_dwordx4 v[192:195], v248, s[56:59], s73 offen offset:0
    ds_read_b64_tr_b16 v[232:233], v249 offset:512
    s_waitcnt lgkmcnt(7)
    v_mfma_f32_16x16x32_bf16 v[32:35], v[240:243], v[132:135], v[32:35]
    v_mul_f32 v16, v16, v250
    v_mul_f32 v17, v17, v250
    ds_read_b64_tr_b16 v[234:235], v249 offset:640
    v_mfma_f32_16x16x32_bf16 v[36:39], v[240:243], v[164:167], v[36:39]
    v_mul_f32 v18, v18, v250
    v_mul_f32 v19, v19, v250
    ds_read_b64_tr_b16 v[236:237], v249 offset:544
    s_waitcnt lgkmcnt(7)
    v_mfma_f32_16x16x32_bf16 v[40:43], v[244:247], v[132:135], v[40:43]
    v_cvt_pk_bf16_f32 v196, v16, v17
    v_cvt_pk_bf16_f32 v197, v18, v19
    ds_read_b64_tr_b16 v[238:239], v249 offset:672
    v_mfma_f32_16x16x32_bf16 v[44:47], v[244:247], v[164:167], v[44:47]
    v_mul_f32 v24, v24, v250
    v_mul_f32 v25, v25, v250
    ds_read_b64_tr_b16 v[240:241], v249 offset:576
    s_waitcnt lgkmcnt(7)
    v_mfma_f32_16x16x32_bf16 v[48:51], v[224:227], v[132:135], v[48:51]
    v_mul_f32 v26, v26, v250
    v_mul_f32 v27, v27, v250
    ds_read_b64_tr_b16 v[242:243], v249 offset:704
    v_mfma_f32_16x16x32_bf16 v[52:55], v[224:227], v[164:167], v[52:55]
    v_cvt_pk_bf16_f32 v198, v24, v25
    v_cvt_pk_bf16_f32 v199, v26, v27
    ds_read_b64_tr_b16 v[224:225], v249 offset:608
    s_waitcnt lgkmcnt(7)
    v_mfma_f32_16x16x32_bf16 v[56:59], v[228:231], v[132:135], v[56:59]
    buffer_store_dwordx4 v[196:199], v248, s[56:59], s73 offen offset:1024
    ds_read_b64_tr_b16 v[226:227], v249 offset:736
    v_mfma_f32_16x16x32_bf16 v[60:63], v[228:231], v[164:167], v[60:63]
    v_mul_f32 v4, v4, v251
    v_mul_f32 v5, v5, v251
    ds_read_b64_tr_b16 v[228:229], v249 offset:768
    s_waitcnt lgkmcnt(7)
    v_mfma_f32_16x16x32_bf16 v[32:35], v[232:235], v[136:139], v[32:35]
    v_mul_f32 v6, v6, v251
    v_mul_f32 v7, v7, v251
    ds_read_b64_tr_b16 v[230:231], v249 offset:896
    v_mfma_f32_16x16x32_bf16 v[36:39], v[232:235], v[168:171], v[36:39]
    v_cvt_pk_bf16_f32 v200, v4, v5
    v_cvt_pk_bf16_f32 v201, v6, v7
    ds_read_b64_tr_b16 v[232:233], v249 offset:800
    s_waitcnt lgkmcnt(7)
    v_mfma_f32_16x16x32_bf16 v[40:43], v[236:239], v[136:139], v[40:43]
    v_mul_f32 v12, v12, v251
    v_mul_f32 v13, v13, v251
    ds_read_b64_tr_b16 v[234:235], v249 offset:928
    v_mfma_f32_16x16x32_bf16 v[44:47], v[236:239], v[168:171], v[44:47]
    v_mul_f32 v14, v14, v251
    v_mul_f32 v15, v15, v251
    ds_read_b64_tr_b16 v[236:237], v249 offset:832
    s_waitcnt lgkmcnt(7)
    v_mfma_f32_16x16x32_bf16 v[48:51], v[240:243], v[136:139], v[48:51]
    v_cvt_pk_bf16_f32 v202, v12, v13
    v_cvt_pk_bf16_f32 v203, v14, v15
    ds_read_b64_tr_b16 v[238:239], v249 offset:960
    v_mfma_f32_16x16x32_bf16 v[52:55], v[240:243], v[168:171], v[52:55]
    buffer_store_dwordx4 v[200:203], v248, s[56:59], s73 offen offset:2048
    ds_read_b64_tr_b16 v[240:241], v249 offset:864
    s_waitcnt lgkmcnt(7)
    v_mfma_f32_16x16x32_bf16 v[56:59], v[224:227], v[136:139], v[56:59]
    v_mul_f32 v20, v20, v251
    v_mul_f32 v21, v21, v251
    ds_read_b64_tr_b16 v[242:243], v249 offset:992
    v_mfma_f32_16x16x32_bf16 v[60:63], v[224:227], v[168:171], v[60:63]
    v_mul_f32 v22, v22, v251
    v_mul_f32 v23, v23, v251
    v_add_u32 v249, s66, v249
    ds_read_b64_tr_b16 v[224:225], v249 offset:0
    s_waitcnt lgkmcnt(7)
    v_mfma_f32_16x16x32_bf16 v[32:35], v[228:231], v[140:143], v[32:35]
    v_cvt_pk_bf16_f32 v204, v20, v21
    v_cvt_pk_bf16_f32 v205, v22, v23
    ds_read_b64_tr_b16 v[226:227], v249 offset:128
    v_mfma_f32_16x16x32_bf16 v[36:39], v[228:231], v[172:175], v[36:39]
    v_mul_f32 v28, v28, v251
    v_mul_f32 v29, v29, v251
    ds_read_b64_tr_b16 v[228:229], v249 offset:32
    s_waitcnt lgkmcnt(7)
    v_mfma_f32_16x16x32_bf16 v[40:43], v[232:235], v[140:143], v[40:43]
    v_mul_f32 v30, v30, v251
    v_mul_f32 v31, v31, v251
    ds_read_b64_tr_b16 v[230:231], v249 offset:160
    v_mfma_f32_16x16x32_bf16 v[44:47], v[232:235], v[172:175], v[44:47]
    v_cvt_pk_bf16_f32 v206, v28, v29
    v_cvt_pk_bf16_f32 v207, v30, v31
    ds_read_b64_tr_b16 v[232:233], v249 offset:64
    s_waitcnt lgkmcnt(7)
    v_mfma_f32_16x16x32_bf16 v[48:51], v[236:239], v[140:143], v[48:51]
    buffer_store_dwordx4 v[204:207], v248, s[56:59], s73 offen offset:3072
    ds_read_b64_tr_b16 v[234:235], v249 offset:192
    v_mfma_f32_16x16x32_bf16 v[52:55], v[236:239], v[172:175], v[52:55]
    ds_read_b64_tr_b16 v[236:237], v249 offset:96
    s_waitcnt lgkmcnt(7)
    v_mfma_f32_16x16x32_bf16 v[56:59], v[240:243], v[140:143], v[56:59]
    ds_read_b64_tr_b16 v[238:239], v249 offset:224
    v_mfma_f32_16x16x32_bf16 v[60:63], v[240:243], v[172:175], v[60:63]
    ds_read_b64_tr_b16 v[240:241], v249 offset:256
    s_waitcnt lgkmcnt(7)
    v_mfma_f32_16x16x32_bf16 v[32:35], v[224:227], v[144:147], v[32:35]
    ds_read_b64_tr_b16 v[242:243], v249 offset:384
    s_cmp_eq_u32 s64, 135168
    v_mfma_f32_16x16x32_bf16 v[36:39], v[224:227], v[176:179], v[36:39]
    ds_read_b64_tr_b16 v[244:245], v249 offset:288
    s_waitcnt lgkmcnt(7)
    v_mfma_f32_16x16x32_bf16 v[40:43], v[228:231], v[144:147], v[40:43]
    ds_read_b64_tr_b16 v[246:247], v249 offset:416
    s_cselect_b32 s66, s68, s67
    v_mfma_f32_16x16x32_bf16 v[44:47], v[228:231], v[176:179], v[44:47]
    ds_read_b64_tr_b16 v[224:225], v249 offset:320
    s_waitcnt lgkmcnt(7)
    v_mfma_f32_16x16x32_bf16 v[48:51], v[232:235], v[144:147], v[48:51]
    ds_read_b64_tr_b16 v[226:227], v249 offset:448
    s_add_u32 s64, s64, s66
    v_mfma_f32_16x16x32_bf16 v[52:55], v[232:235], v[176:179], v[52:55]
    ds_read_b64_tr_b16 v[228:229], v249 offset:352
    s_waitcnt lgkmcnt(7)
    v_mfma_f32_16x16x32_bf16 v[56:59], v[236:239], v[144:147], v[56:59]
    ds_read_b64_tr_b16 v[230:231], v249 offset:480
    s_xor_b32 s73, s73, 28672
    v_add_u32 v253, 1, v253
    v_mfma_f32_16x16x32_bf16 v[60:63], v[236:239], v[176:179], v[60:63]
    ds_read_b64_tr_b16 v[232:233], v249 offset:512
    s_waitcnt lgkmcnt(7)
    v_mfma_f32_16x16x32_bf16 v[32:35], v[240:243], v[148:151], v[32:35]
    ds_read_b64_tr_b16 v[234:235], v249 offset:640
    v_mfma_f32_16x16x32_bf16 v[36:39], v[240:243], v[180:183], v[36:39]
    ds_read_b64_tr_b16 v[236:237], v249 offset:544
    s_waitcnt lgkmcnt(7)
    v_mfma_f32_16x16x32_bf16 v[40:43], v[244:247], v[148:151], v[40:43]
    ds_read_b64_tr_b16 v[238:239], v249 offset:672
    v_mfma_f32_16x16x32_bf16 v[44:47], v[244:247], v[180:183], v[44:47]
    ds_read_b64_tr_b16 v[240:241], v249 offset:576
    s_waitcnt lgkmcnt(7)
    v_mfma_f32_16x16x32_bf16 v[48:51], v[224:227], v[148:151], v[48:51]
    ds_read_b64_tr_b16 v[242:243], v249 offset:704
    v_mfma_f32_16x16x32_bf16 v[52:55], v[224:227], v[180:183], v[52:55]
    ds_read_b64_tr_b16 v[224:225], v249 offset:608
    s_waitcnt lgkmcnt(7)
    v_mfma_f32_16x16x32_bf16 v[56:59], v[228:231], v[148:151], v[56:59]
    ds_read_b64_tr_b16 v[226:227], v249 offset:736
    v_mfma_f32_16x16x32_bf16 v[60:63], v[228:231], v[180:183], v[60:63]
    ds_read_b64_tr_b16 v[228:229], v249 offset:768
    s_waitcnt lgkmcnt(7)
    v_mfma_f32_16x16x32_bf16 v[32:35], v[232:235], v[152:155], v[32:35]
    ds_read_b64_tr_b16 v[230:231], v249 offset:896
    v_mfma_f32_16x16x32_bf16 v[36:39], v[232:235], v[184:187], v[36:39]
    ds_read_b64_tr_b16 v[232:233], v249 offset:800
    s_waitcnt lgkmcnt(7)
    v_mfma_f32_16x16x32_bf16 v[40:43], v[236:239], v[152:155], v[40:43]
    ds_read_b64_tr_b16 v[234:235], v249 offset:928
    v_mfma_f32_16x16x32_bf16 v[44:47], v[236:239], v[184:187], v[44:47]
    ds_read_b64_tr_b16 v[236:237], v249 offset:832
    s_waitcnt lgkmcnt(7)
    v_mfma_f32_16x16x32_bf16 v[48:51], v[240:243], v[152:155], v[48:51]
    ds_read_b64_tr_b16 v[238:239], v249 offset:960
    v_mfma_f32_16x16x32_bf16 v[52:55], v[240:243], v[184:187], v[52:55]
    ds_read_b64_tr_b16 v[240:241], v249 offset:864
    s_waitcnt lgkmcnt(7)
    v_mfma_f32_16x16x32_bf16 v[56:59], v[224:227], v[152:155], v[56:59]
    ds_read_b64_tr_b16 v[242:243], v249 offset:992
    s_waitcnt vmcnt(0)
    buffer_store_dword v253, v252, s[92:95], 0 offen
    v_mfma_f32_16x16x32_bf16 v[60:63], v[224:227], v[184:187], v[60:63]
    v_add_u32 v249, s66, v249
    ds_read_b64_tr_b16 v[224:225], v249 offset:0
    s_waitcnt lgkmcnt(7)
    v_mfma_f32_16x16x32_bf16 v[32:35], v[228:231], v[156:159], v[32:35]
    ds_read_b64_tr_b16 v[226:227], v249 offset:128
    v_mfma_f32_16x16x32_bf16 v[36:39], v[228:231], v[188:191], v[36:39]
    ds_read_b64_tr_b16 v[228:229], v249 offset:32
    s_waitcnt lgkmcnt(7)
    v_mfma_f32_16x16x32_bf16 v[40:43], v[232:235], v[156:159], v[40:43]
    ds_read_b64_tr_b16 v[230:231], v249 offset:160
    v_mfma_f32_16x16x32_bf16 v[44:47], v[232:235], v[188:191], v[44:47]
    ds_read_b64_tr_b16 v[232:233], v249 offset:64
    s_waitcnt lgkmcnt(7)
    v_mfma_f32_16x16x32_bf16 v[48:51], v[236:239], v[156:159], v[48:51]
    ds_read_b64_tr_b16 v[234:235], v249 offset:192
    v_mfma_f32_16x16x32_bf16 v[52:55], v[236:239], v[188:191], v[52:55]
    ds_read_b64_tr_b16 v[236:237], v249 offset:96
    s_waitcnt lgkmcnt(7)
    v_mfma_f32_16x16x32_bf16 v[56:59], v[240:243], v[156:159], v[56:59]
    ds_read_b64_tr_b16 v[238:239], v249 offset:224
    v_mfma_f32_16x16x32_bf16 v[60:63], v[240:243], v[188:191], v[60:63]
    ds_read_b64_tr_b16 v[240:241], v249 offset:256
    s_barrier
    s_waitcnt lgkmcnt(7)
    v_mfma_f32_16x16x32_bf16 v[0:3], v[224:227], v[128:131], 0
    ds_read_b64_tr_b16 v[242:243], v249 offset:384
    s_cmp_eq_u32 s64, 135168
    v_mfma_f32_16x16x32_bf16 v[4:7], v[224:227], v[160:163], 0
    v_mul_f32 v32, v32, v250
    v_mul_f32 v33, v33, v250
    ds_read_b64_tr_b16 v[244:245], v249 offset:288
    s_waitcnt lgkmcnt(7)
    v_mfma_f32_16x16x32_bf16 v[8:11], v[228:231], v[128:131], 0
    v_mul_f32 v34, v34, v250
    v_mul_f32 v35, v35, v250
    ds_read_b64_tr_b16 v[246:247], v249 offset:416
    s_cselect_b32 s66, s68, s67
    v_mfma_f32_16x16x32_bf16 v[12:15], v[228:231], v[160:163], 0
    v_cvt_pk_bf16_f32 v192, v32, v33
    v_cvt_pk_bf16_f32 v193, v34, v35
    ds_read_b64_tr_b16 v[224:225], v249 offset:320
    s_waitcnt lgkmcnt(7)
    v_mfma_f32_16x16x32_bf16 v[16:19], v[232:235], v[128:131], 0
    v_mul_f32 v40, v40, v250
    v_mul_f32 v41, v41, v250
    ds_read_b64_tr_b16 v[226:227], v249 offset:448
    s_add_u32 s64, s64, s66
    v_mfma_f32_16x16x32_bf16 v[20:23], v[232:235], v[160:163], 0
    v_mul_f32 v42, v42, v250
    v_mul_f32 v43, v43, v250
    ds_read_b64_tr_b16 v[228:229], v249 offset:352
    s_waitcnt lgkmcnt(7)
    v_mfma_f32_16x16x32_bf16 v[24:27], v[236:239], v[128:131], 0
    v_cvt_pk_bf16_f32 v194, v40, v41
    v_cvt_pk_bf16_f32 v195, v42, v43
    ds_read_b64_tr_b16 v[230:231], v249 offset:480
    v_mfma_f32_16x16x32_bf16 v[28:31], v[236:239], v[160:163], 0
    buffer_store_dwordx4 v[192:195], v248, s[56:59], s73 offen offset:0
    ds_read_b64_tr_b16 v[232:233], v249 offset:512
    s_waitcnt lgkmcnt(7)
    v_mfma_f32_16x16x32_bf16 v[0:3], v[240:243], v[132:135], v[0:3]
    v_mul_f32 v48, v48, v250
    v_mul_f32 v49, v49, v250
    ds_read_b64_tr_b16 v[234:235], v249 offset:640
    v_mfma_f32_16x16x32_bf16 v[4:7], v[240:243], v[164:167], v[4:7]
    v_mul_f32 v50, v50, v250
    v_mul_f32 v51, v51, v250
    ds_read_b64_tr_b16 v[236:237], v249 offset:544
    s_waitcnt lgkmcnt(7)
    v_mfma_f32_16x16x32_bf16 v[8:11], v[244:247], v[132:135], v[8:11]
    v_cvt_pk_bf16_f32 v196, v48, v49
    v_cvt_pk_bf16_f32 v197, v50, v51
    ds_read_b64_tr_b16 v[238:239], v249 offset:672
    v_mfma_f32_16x16x32_bf16 v[12:15], v[244:247], v[164:167], v[12:15]
    v_mul_f32 v56, v56, v250
    v_mul_f32 v57, v57, v250
    ds_read_b64_tr_b16 v[240:241], v249 offset:576
    s_waitcnt lgkmcnt(7)
    v_mfma_f32_16x16x32_bf16 v[16:19], v[224:227], v[132:135], v[16:19]
    v_mul_f32 v58, v58, v250
    v_mul_f32 v59, v59, v250
    ds_read_b64_tr_b16 v[242:243], v249 offset:704
    v_mfma_f32_16x16x32_bf16 v[20:23], v[224:227], v[164:167], v[20:23]
    v_cvt_pk_bf16_f32 v198, v56, v57
    v_cvt_pk_bf16_f32 v199, v58, v59
    ds_read_b64_tr_b16 v[224:225], v249 offset:608
    s_waitcnt lgkmcnt(7)
    v_mfma_f32_16x16x32_bf16 v[24:27], v[228:231], v[132:135], v[24:27]
    buffer_store_dwordx4 v[196:199], v248, s[56:59], s73 offen offset:1024
    ds_read_b64_tr_b16 v[226:227], v249 offset:736
    v_mfma_f32_16x16x32_bf16 v[28:31], v[228:231], v[164:167], v[28:31]
    v_mul_f32 v36, v36, v251
    v_mul_f32 v37, v37, v251
    ds_read_b64_tr_b16 v[228:229], v249 offset:768
    s_waitcnt lgkmcnt(7)
    v_mfma_f32_16x16x32_bf16 v[0:3], v[232:235], v[136:139], v[0:3]
    v_mul_f32 v38, v38, v251
    v_mul_f32 v39, v39, v251
    ds_read_b64_tr_b16 v[230:231], v249 offset:896
    v_mfma_f32_16x16x32_bf16 v[4:7], v[232:235], v[168:171], v[4:7]
    v_cvt_pk_bf16_f32 v200, v36, v37
    v_cvt_pk_bf16_f32 v201, v38, v39
    ds_read_b64_tr_b16 v[232:233], v249 offset:800
    s_waitcnt lgkmcnt(7)
    v_mfma_f32_16x16x32_bf16 v[8:11], v[236:239], v[136:139], v[8:11]
    v_mul_f32 v44, v44, v251
    v_mul_f32 v45, v45, v251
    ds_read_b64_tr_b16 v[234:235], v249 offset:928
    v_mfma_f32_16x16x32_bf16 v[12:15], v[236:239], v[168:171], v[12:15]
    v_mul_f32 v46, v46, v251
    v_mul_f32 v47, v47, v251
    ds_read_b64_tr_b16 v[236:237], v249 offset:832
    s_waitcnt lgkmcnt(7)
    v_mfma_f32_16x16x32_bf16 v[16:19], v[240:243], v[136:139], v[16:19]
    v_cvt_pk_bf16_f32 v202, v44, v45
    v_cvt_pk_bf16_f32 v203, v46, v47
    ds_read_b64_tr_b16 v[238:239], v249 offset:960
    v_mfma_f32_16x16x32_bf16 v[20:23], v[240:243], v[168:171], v[20:23]
    buffer_store_dwordx4 v[200:203], v248, s[56:59], s73 offen offset:2048
    ds_read_b64_tr_b16 v[240:241], v249 offset:864
    s_waitcnt lgkmcnt(7)
    v_mfma_f32_16x16x32_bf16 v[24:27], v[224:227], v[136:139], v[24:27]
    v_mul_f32 v52, v52, v251
    v_mul_f32 v53, v53, v251
    ds_read_b64_tr_b16 v[242:243], v249 offset:992
    v_mfma_f32_16x16x32_bf16 v[28:31], v[224:227], v[168:171], v[28:31]
    v_mul_f32 v54, v54, v251
    v_mul_f32 v55, v55, v251
    v_add_u32 v249, s66, v249
    ds_read_b64_tr_b16 v[224:225], v249 offset:0
    s_waitcnt lgkmcnt(7)
    v_mfma_f32_16x16x32_bf16 v[0:3], v[228:231], v[140:143], v[0:3]
    v_cvt_pk_bf16_f32 v204, v52, v53
    v_cvt_pk_bf16_f32 v205, v54, v55
    ds_read_b64_tr_b16 v[226:227], v249 offset:128
    v_mfma_f32_16x16x32_bf16 v[4:7], v[228:231], v[172:175], v[4:7]
    v_mul_f32 v60, v60, v251
    v_mul_f32 v61, v61, v251
    ds_read_b64_tr_b16 v[228:229], v249 offset:32
    s_waitcnt lgkmcnt(7)
    v_mfma_f32_16x16x32_bf16 v[8:11], v[232:235], v[140:143], v[8:11]
    v_mul_f32 v62, v62, v251
    v_mul_f32 v63, v63, v251
    ds_read_b64_tr_b16 v[230:231], v249 offset:160
    v_mfma_f32_16x16x32_bf16 v[12:15], v[232:235], v[172:175], v[12:15]
    v_cvt_pk_bf16_f32 v206, v60, v61
    v_cvt_pk_bf16_f32 v207, v62, v63
    ds_read_b64_tr_b16 v[232:233], v249 offset:64
    s_waitcnt lgkmcnt(7)
    v_mfma_f32_16x16x32_bf16 v[16:19], v[236:239], v[140:143], v[16:19]
    buffer_store_dwordx4 v[204:207], v248, s[56:59], s73 offen offset:3072
    ds_read_b64_tr_b16 v[234:235], v249 offset:192
    v_mfma_f32_16x16x32_bf16 v[20:23], v[236:239], v[172:175], v[20:23]
    ds_read_b64_tr_b16 v[236:237], v249 offset:96
    s_waitcnt lgkmcnt(7)
    v_mfma_f32_16x16x32_bf16 v[24:27], v[240:243], v[140:143], v[24:27]
    ds_read_b64_tr_b16 v[238:239], v249 offset:224
    v_mfma_f32_16x16x32_bf16 v[28:31], v[240:243], v[172:175], v[28:31]
    ds_read_b64_tr_b16 v[240:241], v249 offset:256
    s_waitcnt lgkmcnt(7)
    v_mfma_f32_16x16x32_bf16 v[0:3], v[224:227], v[144:147], v[0:3]
    ds_read_b64_tr_b16 v[242:243], v249 offset:384
    s_cmp_eq_u32 s64, 135168
    v_mfma_f32_16x16x32_bf16 v[4:7], v[224:227], v[176:179], v[4:7]
    ds_read_b64_tr_b16 v[244:245], v249 offset:288
    s_waitcnt lgkmcnt(7)
    v_mfma_f32_16x16x32_bf16 v[8:11], v[228:231], v[144:147], v[8:11]
    ds_read_b64_tr_b16 v[246:247], v249 offset:416
    s_cselect_b32 s66, s68, s67
    v_mfma_f32_16x16x32_bf16 v[12:15], v[228:231], v[176:179], v[12:15]
    ds_read_b64_tr_b16 v[224:225], v249 offset:320
    s_waitcnt lgkmcnt(7)
    v_mfma_f32_16x16x32_bf16 v[16:19], v[232:235], v[144:147], v[16:19]
    ds_read_b64_tr_b16 v[226:227], v249 offset:448
    s_add_u32 s64, s64, s66
    v_mfma_f32_16x16x32_bf16 v[20:23], v[232:235], v[176:179], v[20:23]
    ds_read_b64_tr_b16 v[228:229], v249 offset:352
    s_waitcnt lgkmcnt(7)
    v_mfma_f32_16x16x32_bf16 v[24:27], v[236:239], v[144:147], v[24:27]
    ds_read_b64_tr_b16 v[230:231], v249 offset:480
    s_xor_b32 s73, s73, 28672
    v_add_u32 v253, 1, v253
    v_mfma_f32_16x16x32_bf16 v[28:31], v[236:239], v[176:179], v[28:31]
    ds_read_b64_tr_b16 v[232:233], v249 offset:512
    s_waitcnt lgkmcnt(7)
    v_mfma_f32_16x16x32_bf16 v[0:3], v[240:243], v[148:151], v[0:3]
    ds_read_b64_tr_b16 v[234:235], v249 offset:640
    s_sub_u32 s69, s69, 1
    v_mfma_f32_16x16x32_bf16 v[4:7], v[240:243], v[180:183], v[4:7]
    ds_read_b64_tr_b16 v[236:237], v249 offset:544
    s_waitcnt lgkmcnt(7)
    v_mfma_f32_16x16x32_bf16 v[8:11], v[244:247], v[148:151], v[8:11]
    ds_read_b64_tr_b16 v[238:239], v249 offset:672
    s_cmp_lg_u32 s69, 0
    v_mfma_f32_16x16x32_bf16 v[12:15], v[244:247], v[180:183], v[12:15]
    ds_read_b64_tr_b16 v[240:241], v249 offset:576
    s_waitcnt lgkmcnt(7)
    v_mfma_f32_16x16x32_bf16 v[16:19], v[224:227], v[148:151], v[16:19]
    ds_read_b64_tr_b16 v[242:243], v249 offset:704
    v_mfma_f32_16x16x32_bf16 v[20:23], v[224:227], v[180:183], v[20:23]
    ds_read_b64_tr_b16 v[224:225], v249 offset:608
    s_waitcnt lgkmcnt(7)
    v_mfma_f32_16x16x32_bf16 v[24:27], v[228:231], v[148:151], v[24:27]
    ds_read_b64_tr_b16 v[226:227], v249 offset:736
    v_mfma_f32_16x16x32_bf16 v[28:31], v[228:231], v[180:183], v[28:31]
    ds_read_b64_tr_b16 v[228:229], v249 offset:768
    s_waitcnt lgkmcnt(7)
    v_mfma_f32_16x16x32_bf16 v[0:3], v[232:235], v[152:155], v[0:3]
    ds_read_b64_tr_b16 v[230:231], v249 offset:896
    v_mfma_f32_16x16x32_bf16 v[4:7], v[232:235], v[184:187], v[4:7]
    ds_read_b64_tr_b16 v[232:233], v249 offset:800
    s_waitcnt lgkmcnt(7)
    v_mfma_f32_16x16x32_bf16 v[8:11], v[236:239], v[152:155], v[8:11]
    ds_read_b64_tr_b16 v[234:235], v249 offset:928
    v_mfma_f32_16x16x32_bf16 v[12:15], v[236:239], v[184:187], v[12:15]
    ds_read_b64_tr_b16 v[236:237], v249 offset:832
    s_waitcnt lgkmcnt(7)
    v_mfma_f32_16x16x32_bf16 v[16:19], v[240:243], v[152:155], v[16:19]
    ds_read_b64_tr_b16 v[238:239], v249 offset:960
    v_mfma_f32_16x16x32_bf16 v[20:23], v[240:243], v[184:187], v[20:23]
    ds_read_b64_tr_b16 v[240:241], v249 offset:864
    s_waitcnt lgkmcnt(7)
    v_mfma_f32_16x16x32_bf16 v[24:27], v[224:227], v[152:155], v[24:27]
    ds_read_b64_tr_b16 v[242:243], v249 offset:992
    s_waitcnt vmcnt(0)
    buffer_store_dword v253, v252, s[92:95], 0 offen
    v_mfma_f32_16x16x32_bf16 v[28:31], v[224:227], v[184:187], v[28:31]
    v_add_u32 v249, s66, v249
    ds_read_b64_tr_b16 v[224:225], v249 offset:0
    s_waitcnt lgkmcnt(7)
    v_mfma_f32_16x16x32_bf16 v[0:3], v[228:231], v[156:159], v[0:3]
    ds_read_b64_tr_b16 v[226:227], v249 offset:128
    v_mfma_f32_16x16x32_bf16 v[4:7], v[228:231], v[188:191], v[4:7]
    ds_read_b64_tr_b16 v[228:229], v249 offset:32
    s_waitcnt lgkmcnt(7)
    v_mfma_f32_16x16x32_bf16 v[8:11], v[232:235], v[156:159], v[8:11]
    ds_read_b64_tr_b16 v[230:231], v249 offset:160
    v_mfma_f32_16x16x32_bf16 v[12:15], v[232:235], v[188:191], v[12:15]
    ds_read_b64_tr_b16 v[232:233], v249 offset:64
    s_waitcnt lgkmcnt(7)
    v_mfma_f32_16x16x32_bf16 v[16:19], v[236:239], v[156:159], v[16:19]
    ds_read_b64_tr_b16 v[234:235], v249 offset:192
    v_mfma_f32_16x16x32_bf16 v[20:23], v[236:239], v[188:191], v[20:23]
    ds_read_b64_tr_b16 v[236:237], v249 offset:96
    s_waitcnt lgkmcnt(7)
    v_mfma_f32_16x16x32_bf16 v[24:27], v[240:243], v[156:159], v[24:27]
    ds_read_b64_tr_b16 v[238:239], v249 offset:224
    v_mfma_f32_16x16x32_bf16 v[28:31], v[240:243], v[188:191], v[28:31]
    ds_read_b64_tr_b16 v[240:241], v249 offset:256
    s_cbranch_scc1 L_oloopL
    v_add_u32 v253, 1, v253
    v_mul_f32 v0, v0, v250
    v_mul_f32 v1, v1, v250
    v_mul_f32 v2, v2, v250
    v_mul_f32 v3, v3, v250
    v_cvt_pk_bf16_f32 v192, v0, v1
    v_cvt_pk_bf16_f32 v193, v2, v3
    v_mul_f32 v8, v8, v250
    v_mul_f32 v9, v9, v250
    v_mul_f32 v10, v10, v250
    v_mul_f32 v11, v11, v250
    v_cvt_pk_bf16_f32 v194, v8, v9
    v_cvt_pk_bf16_f32 v195, v10, v11
    v_mul_f32 v16, v16, v250
    v_mul_f32 v17, v17, v250
    v_mul_f32 v18, v18, v250
    v_mul_f32 v19, v19, v250
    v_cvt_pk_bf16_f32 v196, v16, v17
    v_cvt_pk_bf16_f32 v197, v18, v19
    v_mul_f32 v24, v24, v250
    v_mul_f32 v25, v25, v250
    v_mul_f32 v26, v26, v250
    v_mul_f32 v27, v27, v250
    v_cvt_pk_bf16_f32 v198, v24, v25
    v_cvt_pk_bf16_f32 v199, v26, v27
    v_mul_f32 v4, v4, v251
    v_mul_f32 v5, v5, v251
    v_mul_f32 v6, v6, v251
    v_mul_f32 v7, v7, v251
    v_cvt_pk_bf16_f32 v200, v4, v5
    v_cvt_pk_bf16_f32 v201, v6, v7
    v_mul_f32 v12, v12, v251
    v_mul_f32 v13, v13, v251
    v_mul_f32 v14, v14, v251
    v_mul_f32 v15, v15, v251
    v_cvt_pk_bf16_f32 v202, v12, v13
    v_cvt_pk_bf16_f32 v203, v14, v15
    v_mul_f32 v20, v20, v251
    v_mul_f32 v21, v21, v251
    v_mul_f32 v22, v22, v251
    v_mul_f32 v23, v23, v251
    v_cvt_pk_bf16_f32 v204, v20, v21
    v_cvt_pk_bf16_f32 v205, v22, v23
    v_mul_f32 v28, v28, v251
    v_mul_f32 v29, v29, v251
    v_mul_f32 v30, v30, v251
    v_mul_f32 v31, v31, v251
    v_cvt_pk_bf16_f32 v206, v28, v29
    v_cvt_pk_bf16_f32 v207, v30, v31
    s_barrier
    buffer_store_dwordx4 v[192:195], v248, s[56:59], s73 offen offset:0
    buffer_store_dwordx4 v[196:199], v248, s[56:59], s73 offen offset:1024
    buffer_store_dwordx4 v[200:203], v248, s[56:59], s73 offen offset:2048
    buffer_store_dwordx4 v[204:207], v248, s[56:59], s73 offen offset:3072
    s_waitcnt vmcnt(0)
    buffer_store_dword v253, v252, s[92:95], 0 offen
L_fin:
    s_mov_b32 s69, 400000
L_poll1:
    buffer_load_dword v219, v218, s[92:95], 0 offen sc1
    s_sub_u32 s69, s69, 1
    s_cbranch_scc1 L_exit1
    s_add_u32 s72, s90, 7
    s_waitcnt vmcnt(0)
L_poll1c:
    v_subrev_u32 v219, s72, v219
    v_cmp_lt_u32 vcc, 0, v219
    s_nop 0
    s_cbranch_vccnz L_poll1
    s_add_u32 s73, s29, 0
    buffer_load_dwordx4 v[0:3], v216, s[56:59], s73 offen sc1
    s_add_u32 s73, s29, 802816
    buffer_load_dwordx4 v[4:7], v216, s[56:59], s73 offen sc1
    s_add_u32 s73, s29, 1605632
    buffer_load_dwordx4 v[8:11], v216, s[56:59], s73 offen sc1
    s_add_u32 s73, s29, 2408448
    buffer_load_dwordx4 v[12:15], v216, s[56:59], s73 offen sc1
    v_mov_b32 v221, s90
    s_lshl_b32 s71, s29, 7
    buffer_store_dword v221, off, s[92:95], s71 offset:896
    s_waitcnt vmcnt(4)
    v_mfma_f32_16x16x32_bf16 v[144:147], v[208:211], v[0:3], 0
    s_waitcnt vmcnt(3)
    v_mfma_f32_16x16x32_bf16 v[144:147], v[208:211], v[4:7], v[144:147]
    s_waitcnt vmcnt(2)
    v_mfma_f32_16x16x32_bf16 v[144:147], v[208:211], v[8:11], v[144:147]
    s_waitcnt vmcnt(1)
    v_mfma_f32_16x16x32_bf16 v[144:147], v[208:211], v[12:15], v[144:147]
    s_nop 7
    v_cvt_pk_bf16_f32 v148, v144, v145
    v_cvt_pk_bf16_f32 v149, v146, v147
    s_mov_b32 exec_hi, 0
    buffer_store_dwordx2 v[148:149], v217, s[96:99], s30 offen offset:768
    s_endpgm
L_oloopR:
    s_barrier
    s_waitcnt lgkmcnt(7)
    v_mfma_f32_16x16x32_bf16 v[32:35], v[224:227], v[128:131], 0
    ds_read_b64_tr_b16 v[242:243], v249 offset:384
    s_cmp_eq_u32 s64, 135168
    v_mfma_f32_16x16x32_bf16 v[36:39], v[224:227], v[160:163], 0
    v_mul_f32 v0, v0, v250
    v_mul_f32 v1, v1, v250
    ds_read_b64_tr_b16 v[244:245], v249 offset:288
    s_waitcnt lgkmcnt(7)
    v_mfma_f32_16x16x32_bf16 v[40:43], v[228:231], v[128:131], 0
    v_mul_f32 v2, v2, v250
    v_mul_f32 v3, v3, v250
    ds_read_b64_tr_b16 v[246:247], v249 offset:416
    s_cselect_b32 s66, s68, s67
    v_mfma_f32_16x16x32_bf16 v[44:47], v[228:231], v[160:163], 0
    v_cvt_pk_bf16_f32 v192, v0, v1
    v_cvt_pk_bf16_f32 v193, v2, v3
    ds_read_b64_tr_b16 v[224:225], v249 offset:320
    s_waitcnt lgkmcnt(7)
    v_mfma_f32_16x16x32_bf16 v[48:51], v[232:235], v[128:131], 0
    v_mul_f32 v8, v8, v250
    v_mul_f32 v9, v9, v250
    ds_read_b64_tr_b16 v[226:227], v249 offset:448
    s_add_u32 s64, s64, s66
    v_mfma_f32_16x16x32_bf16 v[52:55], v[232:235], v[160:163], 0
    v_mul_f32 v10, v10, v250
    v_mul_f32 v11, v11, v250
    ds_read_b64_tr_b16 v[228:229], v249 offset:352
    s_waitcnt lgkmcnt(7)
    v_mfma_f32_16x16x32_bf16 v[56:59], v[236:239], v[128:131], 0
    v_cvt_pk_bf16_f32 v194, v8, v9
    v_cvt_pk_bf16_f32 v195, v10, v11
    ds_read_b64_tr_b16 v[230:231], v249 offset:480
    v_mfma_f32_16x16x32_bf16 v[60:63], v[236:239], v[160:163], 0
    buffer_store_dwordx4 v[192:195], v248, s[56:59], s73 offen offset:0 sc1
    ds_read_b64_tr_b16 v[232:233], v249 offset:512
    s_waitcnt lgkmcnt(7)
    v_mfma_f32_16x16x32_bf16 v[32:35], v[240:243], v[132:135], v[32:35]
    v_mul_f32 v16, v16, v250
    v_mul_f32 v17, v17, v250
    ds_read_b64_tr_b16 v[234:235], v249 offset:640
    v_mfma_f32_16x16x32_bf16 v[36:39], v[240:243], v[164:167], v[36:39]
    v_mul_f32 v18, v18, v250
    v_mul_f32 v19, v19, v250
    ds_read_b64_tr_b16 v[236:237], v249 offset:544
    s_waitcnt lgkmcnt(7)
    v_mfma_f32_16x16x32_bf16 v[40:43], v[244:247], v[132:135], v[40:43]
    v_cvt_pk_bf16_f32 v196, v16, v17
    v_cvt_pk_bf16_f32 v197, v18, v19
    ds_read_b64_tr_b16 v[238:239], v249 offset:672
    v_mfma_f32_16x16x32_bf16 v[44:47], v[244:247], v[164:167], v[44:47]
    v_mul_f32 v24, v24, v250
    v_mul_f32 v25, v25, v250
    ds_read_b64_tr_b16 v[240:241], v249 offset:576
    s_waitcnt lgkmcnt(7)
    v_mfma_f32_16x16x32_bf16 v[48:51], v[224:227], v[132:135], v[48:51]
    v_mul_f32 v26, v26, v250
    v_mul_f32 v27, v27, v250
    ds_read_b64_tr_b16 v[242:243], v249 offset:704
    v_mfma_f32_16x16x32_bf16 v[52:55], v[224:227], v[164:167], v[52:55]
    v_cvt_pk_bf16_f32 v198, v24, v25
    v_cvt_pk_bf16_f32 v199, v26, v27
    ds_read_b64_tr_b16 v[224:225], v249 offset:608
    s_waitcnt lgkmcnt(7)
    v_mfma_f32_16x16x32_bf16 v[56:59], v[228:231], v[132:135], v[56:59]
    buffer_store_dwordx4 v[196:199], v248, s[56:59], s73 offen offset:1024 sc1
    ds_read_b64_tr_b16 v[226:227], v249 offset:736
    v_mfma_f32_16x16x32_bf16 v[60:63], v[228:231], v[164:167], v[60:63]
    v_mul_f32 v4, v4, v251
    v_mul_f32 v5, v5, v251
    ds_read_b64_tr_b16 v[228:229], v249 offset:768
    s_waitcnt lgkmcnt(7)
    v_mfma_f32_16x16x32_bf16 v[32:35], v[232:235], v[136:139], v[32:35]
    v_mul_f32 v6, v6, v251
    v_mul_f32 v7, v7, v251
    ds_read_b64_tr_b16 v[230:231], v249 offset:896
    v_mfma_f32_16x16x32_bf16 v[36:39], v[232:235], v[168:171], v[36:39]
    v_cvt_pk_bf16_f32 v200, v4, v5
    v_cvt_pk_bf16_f32 v201, v6, v7
    ds_read_b64_tr_b16 v[232:233], v249 offset:800
    s_waitcnt lgkmcnt(7)
    v_mfma_f32_16x16x32_bf16 v[40:43], v[236:239], v[136:139], v[40:43]
    v_mul_f32 v12, v12, v251
    v_mul_f32 v13, v13, v251
    ds_read_b64_tr_b16 v[234:235], v249 offset:928
    v_mfma_f32_16x16x32_bf16 v[44:47], v[236:239], v[168:171], v[44:47]
    v_mul_f32 v14, v14, v251
    v_mul_f32 v15, v15, v251
    ds_read_b64_tr_b16 v[236:237], v249 offset:832
    s_waitcnt lgkmcnt(7)
    v_mfma_f32_16x16x32_bf16 v[48:51], v[240:243], v[136:139], v[48:51]
    v_cvt_pk_bf16_f32 v202, v12, v13
    v_cvt_pk_bf16_f32 v203, v14, v15
    ds_read_b64_tr_b16 v[238:239], v249 offset:960
    v_mfma_f32_16x16x32_bf16 v[52:55], v[240:243], v[168:171], v[52:55]
    buffer_store_dwordx4 v[200:203], v248, s[56:59], s73 offen offset:2048 sc1
    ds_read_b64_tr_b16 v[240:241], v249 offset:864
    s_waitcnt lgkmcnt(7)
    v_mfma_f32_16x16x32_bf16 v[56:59], v[224:227], v[136:139], v[56:59]
    v_mul_f32 v20, v20, v251
    v_mul_f32 v21, v21, v251
    ds_read_b64_tr_b16 v[242:243], v249 offset:992
    v_mfma_f32_16x16x32_bf16 v[60:63], v[224:227], v[168:171], v[60:63]
    v_mul_f32 v22, v22, v251
    v_mul_f32 v23, v23, v251
    v_add_u32 v249, s66, v249
    ds_read_b64_tr_b16 v[224:225], v249 offset:0
    s_waitcnt lgkmcnt(7)
    v_mfma_f32_16x16x32_bf16 v[32:35], v[228:231], v[140:143], v[32:35]
    v_cvt_pk_bf16_f32 v204, v20, v21
    v_cvt_pk_bf16_f32 v205, v22, v23
    ds_read_b64_tr_b16 v[226:227], v249 offset:128
    v_mfma_f32_16x16x32_bf16 v[36:39], v[228:231], v[172:175], v[36:39]
    v_mul_f32 v28, v28, v251
    v_mul_f32 v29, v29, v251
    ds_read_b64_tr_b16 v[228:229], v249 offset:32
    s_waitcnt lgkmcnt(7)
    v_mfma_f32_16x16x32_bf16 v[40:43], v[232:235], v[140:143], v[40:43]
    v_mul_f32 v30, v30, v251
    v_mul_f32 v31, v31, v251
    ds_read_b64_tr_b16 v[230:231], v249 offset:160
    v_mfma_f32_16x16x32_bf16 v[44:47], v[232:235], v[172:175], v[44:47]
    v_cvt_pk_bf16_f32 v206, v28, v29
    v_cvt_pk_bf16_f32 v207, v30, v31
    ds_read_b64_tr_b16 v[232:233], v249 offset:64
    s_waitcnt lgkmcnt(7)
    v_mfma_f32_16x16x32_bf16 v[48:51], v[236:239], v[140:143], v[48:51]
    buffer_store_dwordx4 v[204:207], v248, s[56:59], s73 offen offset:3072 sc1
    ds_read_b64_tr_b16 v[234:235], v249 offset:192
    v_mfma_f32_16x16x32_bf16 v[52:55], v[236:239], v[172:175], v[52:55]
    ds_read_b64_tr_b16 v[236:237], v249 offset:96
    s_waitcnt lgkmcnt(7)
    v_mfma_f32_16x16x32_bf16 v[56:59], v[240:243], v[140:143], v[56:59]
    ds_read_b64_tr_b16 v[238:239], v249 offset:224
    v_mfma_f32_16x16x32_bf16 v[60:63], v[240:243], v[172:175], v[60:63]
    ds_read_b64_tr_b16 v[240:241], v249 offset:256
    s_waitcnt lgkmcnt(7)
    v_mfma_f32_16x16x32_bf16 v[32:35], v[224:227], v[144:147], v[32:35]
    ds_read_b64_tr_b16 v[242:243], v249 offset:384
    s_cmp_eq_u32 s64, 135168
    v_mfma_f32_16x16x32_bf16 v[36:39], v[224:227], v[176:179], v[36:39]
    ds_read_b64_tr_b16 v[244:245], v249 offset:288
    s_waitcnt lgkmcnt(7)
    v_mfma_f32_16x16x32_bf16 v[40:43], v[228:231], v[144:147], v[40:43]
    ds_read_b64_tr_b16 v[246:247], v249 offset:416
    s_cselect_b32 s66, s68, s67
    v_mfma_f32_16x16x32_bf16 v[44:47], v[228:231], v[176:179], v[44:47]
    ds_read_b64_tr_b16 v[224:225], v249 offset:320
    s_waitcnt lgkmcnt(7)
    v_mfma_f32_16x16x32_bf16 v[48:51], v[232:235], v[144:147], v[48:51]
    ds_read_b64_tr_b16 v[226:227], v249 offset:448
    s_add_u32 s64, s64, s66
    v_mfma_f32_16x16x32_bf16 v[52:55], v[232:235], v[176:179], v[52:55]
    ds_read_b64_tr_b16 v[228:229], v249 offset:352
    s_waitcnt lgkmcnt(7)
    v_mfma_f32_16x16x32_bf16 v[56:59], v[236:239], v[144:147], v[56:59]
    ds_read_b64_tr_b16 v[230:231], v249 offset:480
    s_xor_b32 s73, s73, 28672
    v_add_u32 v253, 1, v253
    v_mfma_f32_16x16x32_bf16 v[60:63], v[236:239], v[176:179], v[60:63]
    ds_read_b64_tr_b16 v[232:233], v249 offset:512
    s_waitcnt lgkmcnt(7)
    v_mfma_f32_16x16x32_bf16 v[32:35], v[240:243], v[148:151], v[32:35]
    ds_read_b64_tr_b16 v[234:235], v249 offset:640
    v_mfma_f32_16x16x32_bf16 v[36:39], v[240:243], v[180:183], v[36:39]
    ds_read_b64_tr_b16 v[236:237], v249 offset:544
    s_waitcnt lgkmcnt(7)
    v_mfma_f32_16x16x32_bf16 v[40:43], v[244:247], v[148:151], v[40:43]
    ds_read_b64_tr_b16 v[238:239], v249 offset:672
    v_mfma_f32_16x16x32_bf16 v[44:47], v[244:247], v[180:183], v[44:47]
    ds_read_b64_tr_b16 v[240:241], v249 offset:576
    s_waitcnt lgkmcnt(7)
    v_mfma_f32_16x16x32_bf16 v[48:51], v[224:227], v[148:151], v[48:51]
    ds_read_b64_tr_b16 v[242:243], v249 offset:704
    v_mfma_f32_16x16x32_bf16 v[52:55], v[224:227], v[180:183], v[52:55]
    ds_read_b64_tr_b16 v[224:225], v249 offset:608
    s_waitcnt lgkmcnt(7)
    v_mfma_f32_16x16x32_bf16 v[56:59], v[228:231], v[148:151], v[56:59]
    ds_read_b64_tr_b16 v[226:227], v249 offset:736
    v_mfma_f32_16x16x32_bf16 v[60:63], v[228:231], v[180:183], v[60:63]
    ds_read_b64_tr_b16 v[228:229], v249 offset:768
    s_waitcnt lgkmcnt(7)
    v_mfma_f32_16x16x32_bf16 v[32:35], v[232:235], v[152:155], v[32:35]
    ds_read_b64_tr_b16 v[230:231], v249 offset:896
    v_mfma_f32_16x16x32_bf16 v[36:39], v[232:235], v[184:187], v[36:39]
    ds_read_b64_tr_b16 v[232:233], v249 offset:800
    s_waitcnt lgkmcnt(7)
    v_mfma_f32_16x16x32_bf16 v[40:43], v[236:239], v[152:155], v[40:43]
    ds_read_b64_tr_b16 v[234:235], v249 offset:928
    v_mfma_f32_16x16x32_bf16 v[44:47], v[236:239], v[184:187], v[44:47]
    ds_read_b64_tr_b16 v[236:237], v249 offset:832
    s_waitcnt lgkmcnt(7)
    v_mfma_f32_16x16x32_bf16 v[48:51], v[240:243], v[152:155], v[48:51]
    ds_read_b64_tr_b16 v[238:239], v249 offset:960
    v_mfma_f32_16x16x32_bf16 v[52:55], v[240:243], v[184:187], v[52:55]
    ds_read_b64_tr_b16 v[240:241], v249 offset:864
    s_waitcnt lgkmcnt(7)
    v_mfma_f32_16x16x32_bf16 v[56:59], v[224:227], v[152:155], v[56:59]
    ds_read_b64_tr_b16 v[242:243], v249 offset:992
    s_waitcnt vmcnt(0)
    buffer_store_dword v253, v252, s[92:95], 0 offen sc1
    v_mfma_f32_16x16x32_bf16 v[60:63], v[224:227], v[184:187], v[60:63]
    v_add_u32 v249, s66, v249
    ds_read_b64_tr_b16 v[224:225], v249 offset:0
    s_waitcnt lgkmcnt(7)
    v_mfma_f32_16x16x32_bf16 v[32:35], v[228:231], v[156:159], v[32:35]
    ds_read_b64_tr_b16 v[226:227], v249 offset:128
    v_mfma_f32_16x16x32_bf16 v[36:39], v[228:231], v[188:191], v[36:39]
    ds_read_b64_tr_b16 v[228:229], v249 offset:32
    s_waitcnt lgkmcnt(7)
    v_mfma_f32_16x16x32_bf16 v[40:43], v[232:235], v[156:159], v[40:43]
    ds_read_b64_tr_b16 v[230:231], v249 offset:160
    v_mfma_f32_16x16x32_bf16 v[44:47], v[232:235], v[188:191], v[44:47]
    ds_read_b64_tr_b16 v[232:233], v249 offset:64
    s_waitcnt lgkmcnt(7)
    v_mfma_f32_16x16x32_bf16 v[48:51], v[236:239], v[156:159], v[48:51]
    ds_read_b64_tr_b16 v[234:235], v249 offset:192
    v_mfma_f32_16x16x32_bf16 v[52:55], v[236:239], v[188:191], v[52:55]
    ds_read_b64_tr_b16 v[236:237], v249 offset:96
    s_waitcnt lgkmcnt(7)
    v_mfma_f32_16x16x32_bf16 v[56:59], v[240:243], v[156:159], v[56:59]
    ds_read_b64_tr_b16 v[238:239], v249 offset:224
    v_mfma_f32_16x16x32_bf16 v[60:63], v[240:243], v[188:191], v[60:63]
    ds_read_b64_tr_b16 v[240:241], v249 offset:256
    s_barrier
    s_waitcnt lgkmcnt(7)
    v_mfma_f32_16x16x32_bf16 v[0:3], v[224:227], v[128:131], 0
    ds_read_b64_tr_b16 v[242:243], v249 offset:384
    s_cmp_eq_u32 s64, 135168
    v_mfma_f32_16x16x32_bf16 v[4:7], v[224:227], v[160:163], 0
    v_mul_f32 v32, v32, v250
    v_mul_f32 v33, v33, v250
    ds_read_b64_tr_b16 v[244:245], v249 offset:288
    s_waitcnt lgkmcnt(7)
    v_mfma_f32_16x16x32_bf16 v[8:11], v[228:231], v[128:131], 0
    v_mul_f32 v34, v34, v250
    v_mul_f32 v35, v35, v250
    ds_read_b64_tr_b16 v[246:247], v249 offset:416
    s_cselect_b32 s66, s68, s67
    v_mfma_f32_16x16x32_bf16 v[12:15], v[228:231], v[160:163], 0
    v_cvt_pk_bf16_f32 v192, v32, v33
    v_cvt_pk_bf16_f32 v193, v34, v35
    ds_read_b64_tr_b16 v[224:225], v249 offset:320
    s_waitcnt lgkmcnt(7)
    v_mfma_f32_16x16x32_bf16 v[16:19], v[232:235], v[128:131], 0
    v_mul_f32 v40, v40, v250
    v_mul_f32 v41, v41, v250
    ds_read_b64_tr_b16 v[226:227], v249 offset:448
    s_add_u32 s64, s64, s66
    v_mfma_f32_16x16x32_bf16 v[20:23], v[232:235], v[160:163], 0
    v_mul_f32 v42, v42, v250
    v_mul_f32 v43, v43, v250
    ds_read_b64_tr_b16 v[228:229], v249 offset:352
    s_waitcnt lgkmcnt(7)
    v_mfma_f32_16x16x32_bf16 v[24:27], v[236:239], v[128:131], 0
    v_cvt_pk_bf16_f32 v194, v40, v41
    v_cvt_pk_bf16_f32 v195, v42, v43
    ds_read_b64_tr_b16 v[230:231], v249 offset:480
    v_mfma_f32_16x16x32_bf16 v[28:31], v[236:239], v[160:163], 0
    buffer_store_dwordx4 v[192:195], v248, s[56:59], s73 offen offset:0 sc1
    ds_read_b64_tr_b16 v[232:233], v249 offset:512
    s_waitcnt lgkmcnt(7)
    v_mfma_f32_16x16x32_bf16 v[0:3], v[240:243], v[132:135], v[0:3]
    v_mul_f32 v48, v48, v250
    v_mul_f32 v49, v49, v250
    ds_read_b64_tr_b16 v[234:235], v249 offset:640
    v_mfma_f32_16x16x32_bf16 v[4:7], v[240:243], v[164:167], v[4:7]
    v_mul_f32 v50, v50, v250
    v_mul_f32 v51, v51, v250
    ds_read_b64_tr_b16 v[236:237], v249 offset:544
    s_waitcnt lgkmcnt(7)
    v_mfma_f32_16x16x32_bf16 v[8:11], v[244:247], v[132:135], v[8:11]
    v_cvt_pk_bf16_f32 v196, v48, v49
    v_cvt_pk_bf16_f32 v197, v50, v51
    ds_read_b64_tr_b16 v[238:239], v249 offset:672
    v_mfma_f32_16x16x32_bf16 v[12:15], v[244:247], v[164:167], v[12:15]
    v_mul_f32 v56, v56, v250
    v_mul_f32 v57, v57, v250
    ds_read_b64_tr_b16 v[240:241], v249 offset:576
    s_waitcnt lgkmcnt(7)
    v_mfma_f32_16x16x32_bf16 v[16:19], v[224:227], v[132:135], v[16:19]
    v_mul_f32 v58, v58, v250
    v_mul_f32 v59, v59, v250
    ds_read_b64_tr_b16 v[242:243], v249 offset:704
    v_mfma_f32_16x16x32_bf16 v[20:23], v[224:227], v[164:167], v[20:23]
    v_cvt_pk_bf16_f32 v198, v56, v57
    v_cvt_pk_bf16_f32 v199, v58, v59
    ds_read_b64_tr_b16 v[224:225], v249 offset:608
    s_waitcnt lgkmcnt(7)
    v_mfma_f32_16x16x32_bf16 v[24:27], v[228:231], v[132:135], v[24:27]
    buffer_store_dwordx4 v[196:199], v248, s[56:59], s73 offen offset:1024 sc1
    ds_read_b64_tr_b16 v[226:227], v249 offset:736
    v_mfma_f32_16x16x32_bf16 v[28:31], v[228:231], v[164:167], v[28:31]
    v_mul_f32 v36, v36, v251
    v_mul_f32 v37, v37, v251
    ds_read_b64_tr_b16 v[228:229], v249 offset:768
    s_waitcnt lgkmcnt(7)
    v_mfma_f32_16x16x32_bf16 v[0:3], v[232:235], v[136:139], v[0:3]
    v_mul_f32 v38, v38, v251
    v_mul_f32 v39, v39, v251
    ds_read_b64_tr_b16 v[230:231], v249 offset:896
    v_mfma_f32_16x16x32_bf16 v[4:7], v[232:235], v[168:171], v[4:7]
    v_cvt_pk_bf16_f32 v200, v36, v37
    v_cvt_pk_bf16_f32 v201, v38, v39
    ds_read_b64_tr_b16 v[232:233], v249 offset:800
    s_waitcnt lgkmcnt(7)
    v_mfma_f32_16x16x32_bf16 v[8:11], v[236:239], v[136:139], v[8:11]
    v_mul_f32 v44, v44, v251
    v_mul_f32 v45, v45, v251
    ds_read_b64_tr_b16 v[234:235], v249 offset:928
    v_mfma_f32_16x16x32_bf16 v[12:15], v[236:239], v[168:171], v[12:15]
    v_mul_f32 v46, v46, v251
    v_mul_f32 v47, v47, v251
    ds_read_b64_tr_b16 v[236:237], v249 offset:832
    s_waitcnt lgkmcnt(7)
    v_mfma_f32_16x16x32_bf16 v[16:19], v[240:243], v[136:139], v[16:19]
    v_cvt_pk_bf16_f32 v202, v44, v45
    v_cvt_pk_bf16_f32 v203, v46, v47
    ds_read_b64_tr_b16 v[238:239], v249 offset:960
    v_mfma_f32_16x16x32_bf16 v[20:23], v[240:243], v[168:171], v[20:23]
    buffer_store_dwordx4 v[200:203], v248, s[56:59], s73 offen offset:2048 sc1
    ds_read_b64_tr_b16 v[240:241], v249 offset:864
    s_waitcnt lgkmcnt(7)
    v_mfma_f32_16x16x32_bf16 v[24:27], v[224:227], v[136:139], v[24:27]
    v_mul_f32 v52, v52, v251
    v_mul_f32 v53, v53, v251
    ds_read_b64_tr_b16 v[242:243], v249 offset:992
    v_mfma_f32_16x16x32_bf16 v[28:31], v[224:227], v[168:171], v[28:31]
    v_mul_f32 v54, v54, v251
    v_mul_f32 v55, v55, v251
    v_add_u32 v249, s66, v249
    ds_read_b64_tr_b16 v[224:225], v249 offset:0
    s_waitcnt lgkmcnt(7)
    v_mfma_f32_16x16x32_bf16 v[0:3], v[228:231], v[140:143], v[0:3]
    v_cvt_pk_bf16_f32 v204, v52, v53
    v_cvt_pk_bf16_f32 v205, v54, v55
    ds_read_b64_tr_b16 v[226:227], v249 offset:128
    v_mfma_f32_16x16x32_bf16 v[4:7], v[228:231], v[172:175], v[4:7]
    v_mul_f32 v60, v60, v251
    v_mul_f32 v61, v61, v251
    ds_read_b64_tr_b16 v[228:229], v249 offset:32
    s_waitcnt lgkmcnt(7)
    v_mfma_f32_16x16x32_bf16 v[8:11], v[232:235], v[140:143], v[8:11]
    v_mul_f32 v62, v62, v251
    v_mul_f32 v63, v63, v251
    ds_read_b64_tr_b16 v[230:231], v249 offset:160
    v_mfma_f32_16x16x32_bf16 v[12:15], v[232:235], v[172:175], v[12:15]
    v_cvt_pk_bf16_f32 v206, v60, v61
    v_cvt_pk_bf16_f32 v207, v62, v63
    ds_read_b64_tr_b16 v[232:233], v249 offset:64
    s_waitcnt lgkmcnt(7)
    v_mfma_f32_16x16x32_bf16 v[16:19], v[236:239], v[140:143], v[16:19]
    buffer_store_dwordx4 v[204:207], v248, s[56:59], s73 offen offset:3072 sc1
    ds_read_b64_tr_b16 v[234:235], v249 offset:192
    v_mfma_f32_16x16x32_bf16 v[20:23], v[236:239], v[172:175], v[20:23]
    ds_read_b64_tr_b16 v[236:237], v249 offset:96
    s_waitcnt lgkmcnt(7)
    v_mfma_f32_16x16x32_bf16 v[24:27], v[240:243], v[140:143], v[24:27]
    ds_read_b64_tr_b16 v[238:239], v249 offset:224
    v_mfma_f32_16x16x32_bf16 v[28:31], v[240:243], v[172:175], v[28:31]
    ds_read_b64_tr_b16 v[240:241], v249 offset:256
    s_waitcnt lgkmcnt(7)
    v_mfma_f32_16x16x32_bf16 v[0:3], v[224:227], v[144:147], v[0:3]
    ds_read_b64_tr_b16 v[242:243], v249 offset:384
    s_cmp_eq_u32 s64, 135168
    v_mfma_f32_16x16x32_bf16 v[4:7], v[224:227], v[176:179], v[4:7]
    ds_read_b64_tr_b16 v[244:245], v249 offset:288
    s_waitcnt lgkmcnt(7)
    v_mfma_f32_16x16x32_bf16 v[8:11], v[228:231], v[144:147], v[8:11]
    ds_read_b64_tr_b16 v[246:247], v249 offset:416
    s_cselect_b32 s66, s68, s67
    v_mfma_f32_16x16x32_bf16 v[12:15], v[228:231], v[176:179], v[12:15]
    ds_read_b64_tr_b16 v[224:225], v249 offset:320
    s_waitcnt lgkmcnt(7)
    v_mfma_f32_16x16x32_bf16 v[16:19], v[232:235], v[144:147], v[16:19]
    ds_read_b64_tr_b16 v[226:227], v249 offset:448
    s_add_u32 s64, s64, s66
    v_mfma_f32_16x16x32_bf16 v[20:23], v[232:235], v[176:179], v[20:23]
    ds_read_b64_tr_b16 v[228:229], v249 offset:352
    s_waitcnt lgkmcnt(7)
    v_mfma_f32_16x16x32_bf16 v[24:27], v[236:239], v[144:147], v[24:27]
    ds_read_b64_tr_b16 v[230:231], v249 offset:480
    s_xor_b32 s73, s73, 28672
    v_add_u32 v253, 1, v253
    v_mfma_f32_16x16x32_bf16 v[28:31], v[236:239], v[176:179], v[28:31]
    ds_read_b64_tr_b16 v[232:233], v249 offset:512
    s_waitcnt lgkmcnt(7)
    v_mfma_f32_16x16x32_bf16 v[0:3], v[240:243], v[148:151], v[0:3]
    ds_read_b64_tr_b16 v[234:235], v249 offset:640
    s_sub_u32 s69, s69, 1
    v_mfma_f32_16x16x32_bf16 v[4:7], v[240:243], v[180:183], v[4:7]
    ds_read_b64_tr_b16 v[236:237], v249 offset:544
    s_waitcnt lgkmcnt(7)
    v_mfma_f32_16x16x32_bf16 v[8:11], v[244:247], v[148:151], v[8:11]
    ds_read_b64_tr_b16 v[238:239], v249 offset:672
    s_cmp_lg_u32 s69, 0
    v_mfma_f32_16x16x32_bf16 v[12:15], v[244:247], v[180:183], v[12:15]
    ds_read_b64_tr_b16 v[240:241], v249 offset:576
    s_waitcnt lgkmcnt(7)
    v_mfma_f32_16x16x32_bf16 v[16:19], v[224:227], v[148:151], v[16:19]
    ds_read_b64_tr_b16 v[242:243], v249 offset:704
    v_mfma_f32_16x16x32_bf16 v[20:23], v[224:227], v[180:183], v[20:23]
    ds_read_b64_tr_b16 v[224:225], v249 offset:608
    s_waitcnt lgkmcnt(7)
    v_mfma_f32_16x16x32_bf16 v[24:27], v[228:231], v[148:151], v[24:27]
    ds_read_b64_tr_b16 v[226:227], v249 offset:736
    v_mfma_f32_16x16x32_bf16 v[28:31], v[228:231], v[180:183], v[28:31]
    ds_read_b64_tr_b16 v[228:229], v249 offset:768
    s_waitcnt lgkmcnt(7)
    v_mfma_f32_16x16x32_bf16 v[0:3], v[232:235], v[152:155], v[0:3]
    ds_read_b64_tr_b16 v[230:231], v249 offset:896
    v_mfma_f32_16x16x32_bf16 v[4:7], v[232:235], v[184:187], v[4:7]
    ds_read_b64_tr_b16 v[232:233], v249 offset:800
    s_waitcnt lgkmcnt(7)
    v_mfma_f32_16x16x32_bf16 v[8:11], v[236:239], v[152:155], v[8:11]
    ds_read_b64_tr_b16 v[234:235], v249 offset:928
    v_mfma_f32_16x16x32_bf16 v[12:15], v[236:239], v[184:187], v[12:15]
    ds_read_b64_tr_b16 v[236:237], v249 offset:832
    s_waitcnt lgkmcnt(7)
    v_mfma_f32_16x16x32_bf16 v[16:19], v[240:243], v[152:155], v[16:19]
    ds_read_b64_tr_b16 v[238:239], v249 offset:960
    v_mfma_f32_16x16x32_bf16 v[20:23], v[240:243], v[184:187], v[20:23]
    ds_read_b64_tr_b16 v[240:241], v249 offset:864
    s_waitcnt lgkmcnt(7)
    v_mfma_f32_16x16x32_bf16 v[24:27], v[224:227], v[152:155], v[24:27]
    ds_read_b64_tr_b16 v[242:243], v249 offset:992
    s_waitcnt vmcnt(0)
    buffer_store_dword v253, v252, s[92:95], 0 offen sc1
    v_mfma_f32_16x16x32_bf16 v[28:31], v[224:227], v[184:187], v[28:31]
    v_add_u32 v249, s66, v249
    ds_read_b64_tr_b16 v[224:225], v249 offset:0
    s_waitcnt lgkmcnt(7)
    v_mfma_f32_16x16x32_bf16 v[0:3], v[228:231], v[156:159], v[0:3]
    ds_read_b64_tr_b16 v[226:227], v249 offset:128
    v_mfma_f32_16x16x32_bf16 v[4:7], v[228:231], v[188:191], v[4:7]
    ds_read_b64_tr_b16 v[228:229], v249 offset:32
    s_waitcnt lgkmcnt(7)
    v_mfma_f32_16x16x32_bf16 v[8:11], v[232:235], v[156:159], v[8:11]
    ds_read_b64_tr_b16 v[230:231], v249 offset:160
    v_mfma_f32_16x16x32_bf16 v[12:15], v[232:235], v[188:191], v[12:15]
    ds_read_b64_tr_b16 v[232:233], v249 offset:64
    s_waitcnt lgkmcnt(7)
    v_mfma_f32_16x16x32_bf16 v[16:19], v[236:239], v[156:159], v[16:19]
    ds_read_b64_tr_b16 v[234:235], v249 offset:192
    v_mfma_f32_16x16x32_bf16 v[20:23], v[236:239], v[188:191], v[20:23]
    ds_read_b64_tr_b16 v[236:237], v249 offset:96
    s_waitcnt lgkmcnt(7)
    v_mfma_f32_16x16x32_bf16 v[24:27], v[240:243], v[156:159], v[24:27]
    ds_read_b64_tr_b16 v[238:239], v249 offset:224
    v_mfma_f32_16x16x32_bf16 v[28:31], v[240:243], v[188:191], v[28:31]
    ds_read_b64_tr_b16 v[240:241], v249 offset:256
    s_cbranch_scc1 L_oloopR
    v_add_u32 v253, 1, v253
    v_mul_f32 v0, v0, v250
    v_mul_f32 v1, v1, v250
    v_mul_f32 v2, v2, v250
    v_mul_f32 v3, v3, v250
    v_cvt_pk_bf16_f32 v192, v0, v1
    v_cvt_pk_bf16_f32 v193, v2, v3
    v_mul_f32 v8, v8, v250
    v_mul_f32 v9, v9, v250
    v_mul_f32 v10, v10, v250
    v_mul_f32 v11, v11, v250
    v_cvt_pk_bf16_f32 v194, v8, v9
    v_cvt_pk_bf16_f32 v195, v10, v11
    v_mul_f32 v16, v16, v250
    v_mul_f32 v17, v17, v250
    v_mul_f32 v18, v18, v250
    v_mul_f32 v19, v19, v250
    v_cvt_pk_bf16_f32 v196, v16, v17
    v_cvt_pk_bf16_f32 v197, v18, v19
    v_mul_f32 v24, v24, v250
    v_mul_f32 v25, v25, v250
    v_mul_f32 v26, v26, v250
    v_mul_f32 v27, v27, v250
    v_cvt_pk_bf16_f32 v198, v24, v25
    v_cvt_pk_bf16_f32 v199, v26, v27
    v_mul_f32 v4, v4, v251
    v_mul_f32 v5, v5, v251
    v_mul_f32 v6, v6, v251
    v_mul_f32 v7, v7, v251
    v_cvt_pk_bf16_f32 v200, v4, v5
    v_cvt_pk_bf16_f32 v201, v6, v7
    v_mul_f32 v12, v12, v251
    v_mul_f32 v13, v13, v251
    v_mul_f32 v14, v14, v251
    v_mul_f32 v15, v15, v251
    v_cvt_pk_bf16_f32 v202, v12, v13
    v_cvt_pk_bf16_f32 v203, v14, v15
    v_mul_f32 v20, v20, v251
    v_mul_f32 v21, v21, v251
    v_mul_f32 v22, v22, v251
    v_mul_f32 v23, v23, v251
    v_cvt_pk_bf16_f32 v204, v20, v21
    v_cvt_pk_bf16_f32 v205, v22, v23
    v_mul_f32 v28, v28, v251
    v_mul_f32 v29, v29, v251
    v_mul_f32 v30, v30, v251
    v_mul_f32 v31, v31, v251
    v_cvt_pk_bf16_f32 v206, v28, v29
    v_cvt_pk_bf16_f32 v207, v30, v31
    s_barrier
    buffer_store_dwordx4 v[192:195], v248, s[56:59], s73 offen offset:0 sc1
    buffer_store_dwordx4 v[196:199], v248, s[56:59], s73 offen offset:1024 sc1
    buffer_store_dwordx4 v[200:203], v248, s[56:59], s73 offen offset:2048 sc1
    buffer_store_dwordx4 v[204:207], v248, s[56:59], s73 offen offset:3072 sc1
    s_waitcnt vmcnt(0)
    buffer_store_dword v253, v252, s[92:95], 0 offen sc1
    s_branch L_fin
L_postend:
L_rare:
    s_nop 15
    v_mbcnt_lo_u32_b32 v254, -1, 0
    v_mbcnt_hi_u32_b32 v254, -1, v254
    v_lshrrev_b32 v255, 4, v254
    v_lshlrev_b32 v255, 1, v255
    v_mov_b32 v252, 0x9c
    v_lshrrev_b32 v255, v255, v252
    v_and_b32 v255, 3, v255
    v_lshlrev_b32 v255, 4, v255
    v_and_b32 v254, 15, v254
    v_lshl_add_u32 v254, v254, 9, v255
    s_add_u32 s71, s61, 8192
    buffer_load_dwordx4 v[208:211], v254, s[44:47], s61 offen offset:0
    buffer_load_dwordx4 v[212:215], v254, s[44:47], s71 offen offset:0
    s_waitcnt vmcnt(0)
    v_mfma_f32_16x16x32_bf16 v[192:195], v[208:211], v[128:131], v[216:219]
    v_mfma_f32_16x16x32_bf16 v[200:203], v[208:211], v[160:163], v[220:223]
    v_mfma_f32_16x16x32_bf16 v[196:199], v[212:215], v[128:131], v[216:219]
    v_mfma_f32_16x16x32_bf16 v[204:207], v[212:215], v[160:163], v[220:223]
    s_nop 7
    buffer_load_dwordx4 v[208:211], v254, s[44:47], s61 offen offset:64
    buffer_load_dwordx4 v[212:215], v254, s[44:47], s71 offen offset:64
    s_waitcnt vmcnt(0)
    v_mfma_f32_16x16x32_bf16 v[192:195], v[208:211], v[132:135], v[192:195]
    v_mfma_f32_16x16x32_bf16 v[200:203], v[208:211], v[164:167], v[200:203]
    v_mfma_f32_16x16x32_bf16 v[196:199], v[212:215], v[132:135], v[196:199]
    v_mfma_f32_16x16x32_bf16 v[204:207], v[212:215], v[164:167], v[204:207]
    s_nop 7
    buffer_load_dwordx4 v[208:211], v254, s[44:47], s61 offen offset:128
    buffer_load_dwordx4 v[212:215], v254, s[44:47], s71 offen offset:128
    s_waitcnt vmcnt(0)
    v_mfma_f32_16x16x32_bf16 v[192:195], v[208:211], v[136:139], v[192:195]
    v_mfma_f32_16x16x32_bf16 v[200:203], v[208:211], v[168:171], v[200:203]
    v_mfma_f32_16x16x32_bf16 v[196:199], v[212:215], v[136:139], v[196:199]
    v_mfma_f32_16x16x32_bf16 v[204:207], v[212:215], v[168:171], v[204:207]
    s_nop 7
    buffer_load_dwordx4 v[208:211], v254, s[44:47], s61 offen offset:192
    buffer_load_dwordx4 v[212:215], v254, s[44:47], s71 offen offset:192
    s_waitcnt vmcnt(0)
    v_mfma_f32_16x16x32_bf16 v[192:195], v[208:211], v[140:143], v[192:195]
    v_mfma_f32_16x16x32_bf16 v[200:203], v[208:211], v[172:175], v[200:203]
    v_mfma_f32_16x16x32_bf16 v[196:199], v[212:215], v[140:143], v[196:199]
    v_mfma_f32_16x16x32_bf16 v[204:207], v[212:215], v[172:175], v[204:207]
    s_nop 7
    buffer_load_dwordx4 v[208:211], v254, s[44:47], s61 offen offset:256
    buffer_load_dwordx4 v[212:215], v254, s[44:47], s71 offen offset:256
    s_waitcnt vmcnt(0)
    v_mfma_f32_16x16x32_bf16 v[192:195], v[208:211], v[144:147], v[192:195]
    v_mfma_f32_16x16x32_bf16 v[200:203], v[208:211], v[176:179], v[200:203]
    v_mfma_f32_16x16x32_bf16 v[196:199], v[212:215], v[144:147], v[196:199]
    v_mfma_f32_16x16x32_bf16 v[204:207], v[212:215], v[176:179], v[204:207]
    s_nop 7
    buffer_load_dwordx4 v[208:211], v254, s[44:47], s61 offen offset:320
    buffer_load_dwordx4 v[212:215], v254, s[44:47], s71 offen offset:320
    s_waitcnt vmcnt(0)
    v_mfma_f32_16x16x32_bf16 v[192:195], v[208:211], v[148:151], v[192:195]
    v_mfma_f32_16x16x32_bf16 v[200:203], v[208:211], v[180:183], v[200:203]
    v_mfma_f32_16x16x32_bf16 v[196:199], v[212:215], v[148:151], v[196:199]
    v_mfma_f32_16x16x32_bf16 v[204:207], v[212:215], v[180:183], v[204:207]
    s_nop 7
    buffer_load_dwordx4 v[208:211], v254, s[44:47], s61 offen offset:384
    buffer_load_dwordx4 v[212:215], v254, s[44:47], s71 offen offset:384
    s_waitcnt vmcnt(0)
    v_mfma_f32_16x16x32_bf16 v[192:195], v[208:211], v[152:155], v[192:195]
    v_mfma_f32_16x16x32_bf16 v[200:203], v[208:211], v[184:187], v[200:203]
    v_mfma_f32_16x16x32_bf16 v[196:199], v[212:215], v[152:155], v[196:199]
    v_mfma_f32_16x16x32_bf16 v[204:207], v[212:215], v[184:187], v[204:207]
    s_nop 7
    buffer_load_dwordx4 v[208:211], v254, s[44:47], s61 offen offset:448
    buffer_load_dwordx4 v[212:215], v254, s[44:47], s71 offen offset:448
    s_waitcnt vmcnt(0)
    v_mfma_f32_16x16x32_bf16 v[192:195], v[208:211], v[156:159], v[192:195]
    v_mfma_f32_16x16x32_bf16 v[200:203], v[208:211], v[188:191], v[200:203]
    v_mfma_f32_16x16x32_bf16 v[196:199], v[212:215], v[156:159], v[196:199]
    v_mfma_f32_16x16x32_bf16 v[204:207], v[212:215], v[188:191], v[204:207]
    s_nop 7
    s_nop 15
    v_max3_f32 v252, v192, v193, v194
    v_max3_f32 v252, v252, v195, v196
    v_max3_f32 v252, v252, v197, v198
    v_max_f32 v252, v252, v199
    v_mov_b32 v254, v252
    s_nop 1
    v_permlane16_swap_b32 v252, v254
    v_max_f32 v252, v252, v254
    v_mov_b32 v254, v252
    s_nop 1
    v_permlane32_swap_b32 v252, v254
    v_max_f32 v252, v252, v254
    v_max_f32 v252, 0, v252
    v_sub_f32 v192, v192, v252
    v_sub_f32 v193, v193, v252
    v_sub_f32 v194, v194, v252
    v_sub_f32 v195, v195, v252
    v_sub_f32 v196, v196, v252
    v_sub_f32 v197, v197, v252
    v_sub_f32 v198, v198, v252
    v_sub_f32 v199, v199, v252
    v_sub_f32 v216, v216, v252
    v_sub_f32 v217, v217, v252
    v_sub_f32 v218, v218, v252
    v_sub_f32 v219, v219, v252
    v_exp_f32 v255, -v252
    s_nop 0
    v_mul_f32 v250, v250, v255
    v_mul_f32 v0, v0, v255
    v_mul_f32 v1, v1, v255
    v_mul_f32 v2, v2, v255
    v_mul_f32 v3, v3, v255
    v_mul_f32 v8, v8, v255
    v_mul_f32 v9, v9, v255
    v_mul_f32 v10, v10, v255
    v_mul_f32 v11, v11, v255
    v_mul_f32 v16, v16, v255
    v_mul_f32 v17, v17, v255
    v_mul_f32 v18, v18, v255
    v_mul_f32 v19, v19, v255
    v_mul_f32 v24, v24, v255
    v_mul_f32 v25, v25, v255
    v_mul_f32 v26, v26, v255
    v_mul_f32 v27, v27, v255
    v_mul_f32 v32, v32, v255
    v_mul_f32 v33, v33, v255
    v_mul_f32 v34, v34, v255
    v_mul_f32 v35, v35, v255
    v_mul_f32 v40, v40, v255
    v_mul_f32 v41, v41, v255
    v_mul_f32 v42, v42, v255
    v_mul_f32 v43, v43, v255
    v_mul_f32 v48, v48, v255
    v_mul_f32 v49, v49, v255
    v_mul_f32 v50, v50, v255
    v_mul_f32 v51, v51, v255
    v_mul_f32 v56, v56, v255
    v_mul_f32 v57, v57, v255
    v_mul_f32 v58, v58, v255
    v_mul_f32 v59, v59, v255
    v_mul_f32 v64, v64, v255
    v_mul_f32 v65, v65, v255
    v_mul_f32 v66, v66, v255
    v_mul_f32 v67, v67, v255
    v_mul_f32 v72, v72, v255
    v_mul_f32 v73, v73, v255
    v_mul_f32 v74, v74, v255
    v_mul_f32 v75, v75, v255
    v_mul_f32 v80, v80, v255
    v_mul_f32 v81, v81, v255
    v_mul_f32 v82, v82, v255
    v_mul_f32 v83, v83, v255
    v_mul_f32 v88, v88, v255
    v_mul_f32 v89, v89, v255
    v_mul_f32 v90, v90, v255
    v_mul_f32 v91, v91, v255
    v_mul_f32 v96, v96, v255
    v_mul_f32 v97, v97, v255
    v_mul_f32 v98, v98, v255
    v_mul_f32 v99, v99, v255
    v_mul_f32 v104, v104, v255
    v_mul_f32 v105, v105, v255
    v_mul_f32 v106, v106, v255
    v_mul_f32 v107, v107, v255
    v_mul_f32 v112, v112, v255
    v_mul_f32 v113, v113, v255
    v_mul_f32 v114, v114, v255
    v_mul_f32 v115, v115, v255
    v_mul_f32 v120, v120, v255
    v_mul_f32 v121, v121, v255
    v_mul_f32 v122, v122, v255
    v_mul_f32 v123, v123, v255
    v_max3_f32 v253, v200, v201, v202
    v_max3_f32 v253, v253, v203, v204
    v_max3_f32 v253, v253, v205, v206
    v_max_f32 v253, v253, v207
    v_mov_b32 v254, v253
    s_nop 1
    v_permlane16_swap_b32 v253, v254
    v_max_f32 v253, v253, v254
    v_mov_b32 v254, v253
    s_nop 1
    v_permlane32_swap_b32 v253, v254
    v_max_f32 v253, v253, v254
    v_max_f32 v253, 0, v253
    v_sub_f32 v200, v200, v253
    v_sub_f32 v201, v201, v253
    v_sub_f32 v202, v202, v253
    v_sub_f32 v203, v203, v253
    v_sub_f32 v204, v204, v253
    v_sub_f32 v205, v205, v253
    v_sub_f32 v206, v206, v253
    v_sub_f32 v207, v207, v253
    v_sub_f32 v220, v220, v253
    v_sub_f32 v221, v221, v253
    v_sub_f32 v222, v222, v253
    v_sub_f32 v223, v223, v253
    v_exp_f32 v255, -v253
    s_nop 0
    v_mul_f32 v251, v251, v255
    v_mul_f32 v4, v4, v255
    v_mul_f32 v5, v5, v255
    v_mul_f32 v6, v6, v255
    v_mul_f32 v7, v7, v255
    v_mul_f32 v12, v12, v255
    v_mul_f32 v13, v13, v255
    v_mul_f32 v14, v14, v255
    v_mul_f32 v15, v15, v255
    v_mul_f32 v20, v20, v255
    v_mul_f32 v21, v21, v255
    v_mul_f32 v22, v22, v255
    v_mul_f32 v23, v23, v255
    v_mul_f32 v28, v28, v255
    v_mul_f32 v29, v29, v255
    v_mul_f32 v30, v30, v255
    v_mul_f32 v31, v31, v255
    v_mul_f32 v36, v36, v255
    v_mul_f32 v37, v37, v255
    v_mul_f32 v38, v38, v255
    v_mul_f32 v39, v39, v255
    v_mul_f32 v44, v44, v255
    v_mul_f32 v45, v45, v255
    v_mul_f32 v46, v46, v255
    v_mul_f32 v47, v47, v255
    v_mul_f32 v52, v52, v255
    v_mul_f32 v53, v53, v255
    v_mul_f32 v54, v54, v255
    v_mul_f32 v55, v55, v255
    v_mul_f32 v60, v60, v255
    v_mul_f32 v61, v61, v255
    v_mul_f32 v62, v62, v255
    v_mul_f32 v63, v63, v255
    v_mul_f32 v68, v68, v255
    v_mul_f32 v69, v69, v255
    v_mul_f32 v70, v70, v255
    v_mul_f32 v71, v71, v255
    v_mul_f32 v76, v76, v255
    v_mul_f32 v77, v77, v255
    v_mul_f32 v78, v78, v255
    v_mul_f32 v79, v79, v255
    v_mul_f32 v84, v84, v255
    v_mul_f32 v85, v85, v255
    v_mul_f32 v86, v86, v255
    v_mul_f32 v87, v87, v255
    v_mul_f32 v92, v92, v255
    v_mul_f32 v93, v93, v255
    v_mul_f32 v94, v94, v255
    v_mul_f32 v95, v95, v255
    v_mul_f32 v100, v100, v255
    v_mul_f32 v101, v101, v255
    v_mul_f32 v102, v102, v255
    v_mul_f32 v103, v103, v255
    v_mul_f32 v108, v108, v255
    v_mul_f32 v109, v109, v255
    v_mul_f32 v110, v110, v255
    v_mul_f32 v111, v111, v255
    v_mul_f32 v116, v116, v255
    v_mul_f32 v117, v117, v255
    v_mul_f32 v118, v118, v255
    v_mul_f32 v119, v119, v255
    v_mul_f32 v124, v124, v255
    v_mul_f32 v125, v125, v255
    v_mul_f32 v126, v126, v255
    v_mul_f32 v127, v127, v255
    v_exp_f32 v192, v192
    v_exp_f32 v200, v200
    v_exp_f32 v193, v193
    v_exp_f32 v201, v201
    v_exp_f32 v194, v194
    v_exp_f32 v202, v202
    v_add_f32 v252, v192, v193
    v_add_f32 v253, v200, v201
    v_exp_f32 v195, v195
    v_exp_f32 v203, v203
    v_add_f32 v252, v252, v194
    v_add_f32 v253, v253, v202
    v_exp_f32 v196, v196
    v_exp_f32 v204, v204
    v_add_f32 v252, v252, v195
    v_add_f32 v253, v253, v203
    v_exp_f32 v197, v197
    v_exp_f32 v205, v205
    v_add_f32 v252, v252, v196
    v_add_f32 v253, v253, v204
    v_exp_f32 v198, v198
    v_exp_f32 v206, v206
    v_add_f32 v252, v252, v197
    v_add_f32 v253, v253, v205
    v_exp_f32 v199, v199
    v_exp_f32 v207, v207
    v_add_f32 v252, v252, v198
    v_add_f32 v253, v253, v206
    v_add_f32 v252, v252, v199
    v_add_f32 v253, v253, v207
    s_nop 7
    s_cmp_eq_u32 s70, 0
    s_cbranch_scc1 L_loop
    s_cmp_eq_u32 s70, 1
    s_cbranch_scc1 L_ret1
    s_branch L_ret2
L_loader:
    s_add_u32 m0, s23, 16896
    s_add_u32 s73, s73, 253952
    buffer_load_dwordx4 v242, s[40:43], s73 offen lds
    s_addk_i32 m0, 1056
    s_addk_i32 s73, 8192
    buffer_load_dwordx4 v242, s[40:43], s73 offen lds
    v_mov_b32 v240, v1
    s_mov_b32 m0, 33792
    s_mov_b32 s73, 524288
    buffer_load_dwordx4 v242, s[40:43], s73 offen lds
    s_addk_i32 m0, 1056
    s_addk_i32 s73, 8192
    buffer_load_dwordx4 v242, s[40:43], s73 offen lds
    s_addk_i32 m0, 1056
    s_addk_i32 s73, 8192
    buffer_load_dwordx4 v242, s[40:43], s73 offen lds
    s_addk_i32 m0, 1056
    s_addk_i32 s73, 8192
    buffer_load_dwordx4 v242, s[40:43], s73 offen lds
    s_addk_i32 m0, 1056
    s_add_u32 s73, s73, 40960
    buffer_load_dwordx4 v242, s[40:43], s73 offen lds
    s_addk_i32 m0, 1056
    s_addk_i32 s73, 8192
    buffer_load_dwordx4 v242, s[40:43], s73 offen lds
    s_addk_i32 m0, 1056
    s_addk_i32 s73, 8192
    buffer_load_dwordx4 v242, s[40:43], s73 offen lds
    s_addk_i32 m0, 1056
    s_addk_i32 s73, 8192
    buffer_load_dwordx4 v242, s[40:43], s73 offen lds
    s_addk_i32 m0, 1056
    s_add_u32 s73, s73, 40960
    buffer_load_dwordx4 v242, s[40:43], s73 offen lds
    s_addk_i32 m0, 1056
    s_addk_i32 s73, 8192
    buffer_load_dwordx4 v242, s[40:43], s73 offen lds
    s_addk_i32 m0, 1056
    s_addk_i32 s73, 8192
    buffer_load_dwordx4 v242, s[40:43], s73 offen lds
    s_addk_i32 m0, 1056
    s_addk_i32 s73, 8192
    buffer_load_dwordx4 v242, s[40:43], s73 offen lds
    s_addk_i32 m0, 1056
    s_add_u32 s73, s73, 40960
    buffer_load_dwordx4 v242, s[40:43], s73 offen lds
    s_addk_i32 m0, 1056
    s_addk_i32 s73, 8192
    buffer_load_dwordx4 v242, s[40:43], s73 offen lds
    s_addk_i32 m0, 1056
    s_addk_i32 s73, 8192
    buffer_load_dwordx4 v242, s[40:43], s73 offen lds
    s_addk_i32 m0, 1056
    s_addk_i32 s73, 8192
    buffer_load_dwordx4 v242, s[40:43], s73 offen lds
    s_waitcnt vmcnt(18)
    s_barrier
    s_mov_b32 m0, 50688
    s_mov_b32 s73, 786432
    buffer_load_dwordx4 v242, s[40:43], s73 offen lds
    s_addk_i32 m0, 1056
    s_addk_i32 s73, 8192
    buffer_load_dwordx4 v242, s[40:43], s73 offen lds
    s_addk_i32 m0, 1056
    s_addk_i32 s73, 8192
    buffer_load_dwordx4 v242, s[40:43], s73 offen lds
    s_addk_i32 m0, 1056
    s_addk_i32 s73, 8192
    buffer_load_dwordx4 v242, s[40:43], s73 offen lds
    s_addk_i32 m0, 1056
    s_add_u32 s73, s73, 40960
    buffer_load_dwordx4 v242, s[40:43], s73 offen lds
    s_addk_i32 m0, 1056
    s_addk_i32 s73, 8192
    buffer_load_dwordx4 v242, s[40:43], s73 offen lds
    s_addk_i32 m0, 1056
    s_addk_i32 s73, 8192
    buffer_load_dwordx4 v242, s[40:43], s73 offen lds
    s_addk_i32 m0, 1056
    s_addk_i32 s73, 8192
    buffer_load_dwordx4 v242, s[40:43], s73 offen lds
    s_addk_i32 m0, 1056
    s_add_u32 s73, s73, 40960
    buffer_load_dwordx4 v242, s[40:43], s73 offen lds
    s_addk_i32 m0, 1056
    s_addk_i32 s73, 8192
    buffer_load_dwordx4 v242, s[40:43], s73 offen lds
    s_addk_i32 m0, 1056
    s_addk_i32 s73, 8192
    buffer_load_dwordx4 v242, s[40:43], s73 offen lds
    s_addk_i32 m0, 1056
    s_addk_i32 s73, 8192
    buffer_load_dwordx4 v242, s[40:43], s73 offen lds
    s_addk_i32 m0, 1056
    s_add_u32 s73, s73, 40960
    buffer_load_dwordx4 v242, s[40:43], s73 offen lds
    s_addk_i32 m0, 1056
    s_addk_i32 s73, 8192
    buffer_load_dwordx4 v242, s[40:43], s73 offen lds
    s_addk_i32 m0, 1056
    s_addk_i32 s73, 8192
    buffer_load_dwordx4 v242, s[40:43], s73 offen lds
    s_addk_i32 m0, 1056
    s_addk_i32 s73, 8192
    buffer_load_dwordx4 v242, s[40:43], s73 offen lds
    v_and_b32 v5, 7, v240
    v_lshlrev_b32 v5, 4, v5
    v_lshrrev_b32 v6, 3, v240
    v_mul_u32_u24 v6, 14336, v6
    v_add_u32 v243, v5, v6
    v_lshlrev_b32 v245, 7, v240
    v_and_b32 v5, 15, v240
    v_lshlrev_b32 v5, 4, v5
    v_and_b32 v6, 32, v240
    v_lshl_add_u32 v5, v6, 13, v5
    v_and_b32 v6, 16, v240
    v_lshl_add_u32 v239, v6, 11, v5
    v_mul_u32_u24 v247, 896, v240
    s_lshr_b32 s29, s2, 6
    s_mul_i32 s29, s29, 50176
    s_add_u32 s44, s6, s31
    s_addc_u32 s45, s7, 0
    s_mov_b32 s46, 0x40000
    s_mov_b32 s47, 0x20000
    s_add_u32 s48, s8, s31
    s_addc_u32 s49, s9, 0
    s_mov_b32 s50, 0x40000
    s_mov_b32 s51, 0x20000
    s_add_u32 s52, s12, s33
    s_addc_u32 s53, s13, 0
    s_mov_b32 s54, 0x38000
    s_mov_b32 s55, 0x20000
    s_add_u32 s56, s24, s34
    s_addc_u32 s57, s25, 0
    s_mov_b32 s58, 0x310000
    s_mov_b32 s59, 0x20000
    s_add_u32 s92, s24, s20
    s_addc_u32 s93, s25, 0
    s_mov_b32 s94, 0x8000
    s_mov_b32 s95, 0x20000
    s_add_u32 s96, s64, s21
    s_addc_u32 s97, s65, 0
    s_mov_b32 s98, s22
    s_mov_b32 s99, 0x20000
    s_getpc_b64 s[4:5]
L_pcl:
    s_sub_u32 s4, s4, L_pcl-L_compute
    s_subb_u32 s5, s5, 0
    s_mov_b32 s6, L_exit1-L_compute
    s_mov_b32 s7, 0x20000
    s_lshr_b32 s8, s2, 3
    s_lshl_b32 s8, s8, 7
    v_lshlrev_b32 v248, 12, v240
    buffer_load_dword v246, v248, s[4:7], s8 offen
    s_buffer_load_dword s90, s[92:95], 0x380
    s_waitcnt vmcnt(33)
    s_barrier
    s_mov_b32 m0, 67584
    s_mov_b32 s73, 1048576
    buffer_load_dwordx4 v242, s[40:43], s73 offen lds
    s_addk_i32 m0, 1056
    s_addk_i32 s73, 8192
    buffer_load_dwordx4 v242, s[40:43], s73 offen lds
    s_addk_i32 m0, 1056
    s_addk_i32 s73, 8192
    buffer_load_dwordx4 v242, s[40:43], s73 offen lds
    s_addk_i32 m0, 1056
    s_addk_i32 s73, 8192
    buffer_load_dwordx4 v242, s[40:43], s73 offen lds
    s_addk_i32 m0, 1056
    s_add_u32 s73, s73, 40960
    buffer_load_dwordx4 v242, s[40:43], s73 offen lds
    s_addk_i32 m0, 1056
    s_addk_i32 s73, 8192
    buffer_load_dwordx4 v242, s[40:43], s73 offen lds
    s_addk_i32 m0, 1056
    s_addk_i32 s73, 8192
    buffer_load_dwordx4 v242, s[40:43], s73 offen lds
    s_addk_i32 m0, 1056
    s_addk_i32 s73, 8192
    buffer_load_dwordx4 v242, s[40:43], s73 offen lds
    s_addk_i32 m0, 1056
    s_add_u32 s73, s73, 40960
    buffer_load_dwordx4 v242, s[40:43], s73 offen lds
    s_addk_i32 m0, 1056
    s_addk_i32 s73, 8192
    buffer_load_dwordx4 v242, s[40:43], s73 offen lds
    s_addk_i32 m0, 1056
    s_addk_i32 s73, 8192
    buffer_load_dwordx4 v242, s[40:43], s73 offen lds
    s_addk_i32 m0, 1056
    s_addk_i32 s73, 8192
    buffer_load_dwordx4 v242, s[40:43], s73 offen lds
    s_addk_i32 m0, 1056
    s_add_u32 s73, s73, 40960
    buffer_load_dwordx4 v242, s[40:43], s73 offen lds
    s_addk_i32 m0, 1056
    s_addk_i32 s73, 8192
    buffer_load_dwordx4 v242, s[40:43], s73 offen lds
    s_addk_i32 m0, 1056
    s_addk_i32 s73, 8192
    buffer_load_dwordx4 v242, s[40:43], s73 offen lds
    s_addk_i32 m0, 1056
    s_addk_i32 s73, 8192
    buffer_load_dwordx4 v242, s[40:43], s73 offen lds
    s_waitcnt vmcnt(33)
    s_barrier
    s_mov_b32 m0, 84480
    s_mov_b32 s73, 1310720
    buffer_load_dwordx4 v242, s[40:43], s73 offen lds
    s_addk_i32 m0, 1056
    s_addk_i32 s73, 8192
    buffer_load_dwordx4 v242, s[40:43], s73 offen lds
    s_addk_i32 m0, 1056
    s_addk_i32 s73, 8192
    buffer_load_dwordx4 v242, s[40:43], s73 offen lds
    s_addk_i32 m0, 1056
    s_addk_i32 s73, 8192
    buffer_load_dwordx4 v242, s[40:43], s73 offen lds
    s_addk_i32 m0, 1056
    s_add_u32 s73, s73, 40960
    buffer_load_dwordx4 v242, s[40:43], s73 offen lds
    s_addk_i32 m0, 1056
    s_addk_i32 s73, 8192
    buffer_load_dwordx4 v242, s[40:43], s73 offen lds
    s_addk_i32 m0, 1056
    s_addk_i32 s73, 8192
    buffer_load_dwordx4 v242, s[40:43], s73 offen lds
    s_addk_i32 m0, 1056
    s_addk_i32 s73, 8192
    buffer_load_dwordx4 v242, s[40:43], s73 offen lds
    s_addk_i32 m0, 1056
    s_add_u32 s73, s73, 40960
    buffer_load_dwordx4 v242, s[40:43], s73 offen lds
    s_addk_i32 m0, 1056
    s_addk_i32 s73, 8192
    buffer_load_dwordx4 v242, s[40:43], s73 offen lds
    s_addk_i32 m0, 1056
    s_addk_i32 s73, 8192
    buffer_load_dwordx4 v242, s[40:43], s73 offen lds
    s_addk_i32 m0, 1056
    s_addk_i32 s73, 8192
    buffer_load_dwordx4 v242, s[40:43], s73 offen lds
    s_addk_i32 m0, 1056
    s_add_u32 s73, s73, 40960
    buffer_load_dwordx4 v242, s[40:43], s73 offen lds
    s_addk_i32 m0, 1056
    s_addk_i32 s73, 8192
    buffer_load_dwordx4 v242, s[40:43], s73 offen lds
    s_addk_i32 m0, 1056
    s_addk_i32 s73, 8192
    buffer_load_dwordx4 v242, s[40:43], s73 offen lds
    s_addk_i32 m0, 1056
    s_addk_i32 s73, 8192
    buffer_load_dwordx4 v242, s[40:43], s73 offen lds
    s_waitcnt vmcnt(16)
    s_barrier
    s_mov_b32 m0, 101376
    s_mov_b32 s73, 1572864
    buffer_load_dwordx4 v242, s[40:43], s73 offen lds
    s_addk_i32 m0, 1056
    s_addk_i32 s73, 8192
    buffer_load_dwordx4 v242, s[40:43], s73 offen lds
    s_addk_i32 m0, 1056
    s_addk_i32 s73, 8192
    buffer_load_dwordx4 v242, s[40:43], s73 offen lds
    s_addk_i32 m0, 1056
    s_addk_i32 s73, 8192
    buffer_load_dwordx4 v242, s[40:43], s73 offen lds
    s_addk_i32 m0, 1056
    s_add_u32 s73, s73, 40960
    buffer_load_dwordx4 v242, s[40:43], s73 offen lds
    s_addk_i32 m0, 1056
    s_addk_i32 s73, 8192
    buffer_load_dwordx4 v242, s[40:43], s73 offen lds
    s_addk_i32 m0, 1056
    s_addk_i32 s73, 8192
    buffer_load_dwordx4 v242, s[40:43], s73 offen lds
    s_addk_i32 m0, 1056
    s_addk_i32 s73, 8192
    buffer_load_dwordx4 v242, s[40:43], s73 offen lds
    s_addk_i32 m0, 1056
    s_add_u32 s73, s73, 40960
    buffer_load_dwordx4 v242, s[40:43], s73 offen lds
    s_addk_i32 m0, 1056
    s_addk_i32 s73, 8192
    buffer_load_dwordx4 v242, s[40:43], s73 offen lds
    s_addk_i32 m0, 1056
    s_addk_i32 s73, 8192
    buffer_load_dwordx4 v242, s[40:43], s73 offen lds
    s_addk_i32 m0, 1056
    s_addk_i32 s73, 8192
    buffer_load_dwordx4 v242, s[40:43], s73 offen lds
    s_addk_i32 m0, 1056
    s_add_u32 s73, s73, 40960
    buffer_load_dwordx4 v242, s[40:43], s73 offen lds
    s_addk_i32 m0, 1056
    s_addk_i32 s73, 8192
    buffer_load_dwordx4 v242, s[40:43], s73 offen lds
    s_addk_i32 m0, 1056
    s_addk_i32 s73, 8192
    buffer_load_dwordx4 v242, s[40:43], s73 offen lds
    s_addk_i32 m0, 1056
    s_addk_i32 s73, 8192
    buffer_load_dwordx4 v242, s[40:43], s73 offen lds
    s_mov_b32 m0, 118272
    s_mov_b32 s73, 1835008
    buffer_load_dwordx4 v242, s[40:43], s73 offen lds
    s_addk_i32 m0, 1056
    s_addk_i32 s73, 8192
    buffer_load_dwordx4 v242, s[40:43], s73 offen lds
    s_addk_i32 m0, 1056
    s_addk_i32 s73, 8192
    buffer_load_dwordx4 v242, s[40:43], s73 offen lds
    s_addk_i32 m0, 1056
    s_addk_i32 s73, 8192
    buffer_load_dwordx4 v242, s[40:43], s73 offen lds
    s_addk_i32 m0, 1056
    s_add_u32 s73, s73, 40960
    buffer_load_dwordx4 v242, s[40:43], s73 offen lds
    s_addk_i32 m0, 1056
    s_addk_i32 s73, 8192
    buffer_load_dwordx4 v242, s[40:43], s73 offen lds
    s_addk_i32 m0, 1056
    s_addk_i32 s73, 8192
    buffer_load_dwordx4 v242, s[40:43], s73 offen lds
    s_addk_i32 m0, 1056
    s_addk_i32 s73, 8192
    buffer_load_dwordx4 v242, s[40:43], s73 offen lds
    s_addk_i32 m0, 1056
    s_add_u32 s73, s73, 40960
    buffer_load_dwordx4 v242, s[40:43], s73 offen lds
    s_addk_i32 m0, 1056
    s_addk_i32 s73, 8192
    buffer_load_dwordx4 v242, s[40:43], s73 offen lds
    s_addk_i32 m0, 1056
    s_addk_i32 s73, 8192
    buffer_load_dwordx4 v242, s[40:43], s73 offen lds
    s_addk_i32 m0, 1056
    s_addk_i32 s73, 8192
    buffer_load_dwordx4 v242, s[40:43], s73 offen lds
    s_addk_i32 m0, 1056
    s_add_u32 s73, s73, 40960
    buffer_load_dwordx4 v242, s[40:43], s73 offen lds
    s_addk_i32 m0, 1056
    s_addk_i32 s73, 8192
    buffer_load_dwordx4 v242, s[40:43], s73 offen lds
    s_addk_i32 m0, 1056
    s_addk_i32 s73, 8192
    buffer_load_dwordx4 v242, s[40:43], s73 offen lds
    s_addk_i32 m0, 1056
    s_addk_i32 s73, 8192
    buffer_load_dwordx4 v242, s[40:43], s73 offen lds
    s_mov_b32 m0, 0
    s_mov_b32 s73, 2097152
    buffer_load_dwordx4 v242, s[40:43], s73 offen lds
    s_addk_i32 m0, 1056
    s_addk_i32 s73, 8192
    buffer_load_dwordx4 v242, s[40:43], s73 offen lds
    s_addk_i32 m0, 1056
    s_addk_i32 s73, 8192
    buffer_load_dwordx4 v242, s[40:43], s73 offen lds
    s_addk_i32 m0, 1056
    s_addk_i32 s73, 8192
    buffer_load_dwordx4 v242, s[40:43], s73 offen lds
    s_addk_i32 m0, 1056
    s_add_u32 s73, s73, 40960
    buffer_load_dwordx4 v242, s[40:43], s73 offen lds
    s_addk_i32 m0, 1056
    s_addk_i32 s73, 8192
    buffer_load_dwordx4 v242, s[40:43], s73 offen lds
    s_addk_i32 m0, 1056
    s_addk_i32 s73, 8192
    buffer_load_dwordx4 v242, s[40:43], s73 offen lds
    s_addk_i32 m0, 1056
    s_addk_i32 s73, 8192
    buffer_load_dwordx4 v242, s[40:43], s73 offen lds
    s_addk_i32 m0, 1056
    s_add_u32 s73, s73, 40960
    buffer_load_dwordx4 v242, s[40:43], s73 offen lds
    s_addk_i32 m0, 1056
    s_addk_i32 s73, 8192
    buffer_load_dwordx4 v242, s[40:43], s73 offen lds
    s_addk_i32 m0, 1056
    s_addk_i32 s73, 8192
    buffer_load_dwordx4 v242, s[40:43], s73 offen lds
    s_addk_i32 m0, 1056
    s_addk_i32 s73, 8192
    buffer_load_dwordx4 v242, s[40:43], s73 offen lds
    s_addk_i32 m0, 1056
    s_add_u32 s73, s73, 40960
    buffer_load_dwordx4 v242, s[40:43], s73 offen lds
    s_addk_i32 m0, 1056
    s_addk_i32 s73, 8192
    buffer_load_dwordx4 v242, s[40:43], s73 offen lds
    s_addk_i32 m0, 1056
    s_addk_i32 s73, 8192
    buffer_load_dwordx4 v242, s[40:43], s73 offen lds
    s_waitcnt vmcnt(62)
    s_addk_i32 m0, 1056
    s_addk_i32 s73, 8192
    buffer_load_dwordx4 v242, s[40:43], s73 offen lds
    v_lshlrev_b32 v155, 16, v240
    s_waitcnt vmcnt(62)
    buffer_load_dword v246, v155, s[44:47], 0 offen nt
    s_waitcnt vmcnt(62)
    buffer_load_dword v246, v155, s[48:51], 0 offen nt
    s_waitcnt vmcnt(34)
    s_barrier
    s_setprio 3
    s_mov_b32 m0, 16896
    s_mov_b32 s73, 2359296
    buffer_load_dwordx4 v242, s[40:43], s73 offen lds
    s_addk_i32 m0, 1056
    s_addk_i32 s73, 8192
    buffer_load_dwordx4 v242, s[40:43], s73 offen lds
    s_addk_i32 m0, 1056
    s_addk_i32 s73, 8192
    buffer_load_dwordx4 v242, s[40:43], s73 offen lds
    s_addk_i32 m0, 1056
    s_addk_i32 s73, 8192
    buffer_load_dwordx4 v242, s[40:43], s73 offen lds
    s_addk_i32 m0, 1056
    s_add_u32 s73, s73, 40960
    buffer_load_dwordx4 v242, s[40:43], s73 offen lds
    s_addk_i32 m0, 1056
    s_addk_i32 s73, 8192
    buffer_load_dwordx4 v242, s[40:43], s73 offen lds
    s_addk_i32 m0, 1056
    s_addk_i32 s73, 8192
    buffer_load_dwordx4 v242, s[40:43], s73 offen lds
    s_addk_i32 m0, 1056
    s_addk_i32 s73, 8192
    buffer_load_dwordx4 v242, s[40:43], s73 offen lds
    s_addk_i32 m0, 1056
    s_add_u32 s73, s73, 40960
    buffer_load_dwordx4 v242, s[40:43], s73 offen lds
    s_addk_i32 m0, 1056
    s_addk_i32 s73, 8192
    buffer_load_dwordx4 v242, s[40:43], s73 offen lds
    s_addk_i32 m0, 1056
    s_addk_i32 s73, 8192
    buffer_load_dwordx4 v242, s[40:43], s73 offen lds
    s_addk_i32 m0, 1056
    s_addk_i32 s73, 8192
    buffer_load_dwordx4 v242, s[40:43], s73 offen lds
    s_addk_i32 m0, 1056
    s_add_u32 s73, s73, 40960
    buffer_load_dwordx4 v242, s[40:43], s73 offen lds
    s_addk_i32 m0, 1056
    s_addk_i32 s73, 8192
    buffer_load_dwordx4 v242, s[40:43], s73 offen lds
    s_addk_i32 m0, 1056
    s_addk_i32 s73, 8192
    buffer_load_dwordx4 v242, s[40:43], s73 offen lds
    s_addk_i32 m0, 1056
    s_addk_i32 s73, 8192
    buffer_load_dwordx4 v242, s[40:43], s73 offen lds
    s_mov_b32 m0, 33792
    s_mov_b32 s73, 2621440
    buffer_load_dwordx4 v239, s[40:43], s73 offen lds
    s_addk_i32 m0, 1056
    s_addk_i32 s73, 8192
    buffer_load_dwordx4 v239, s[40:43], s73 offen lds
    s_addk_i32 m0, 1056
    s_addk_i32 s73, 8192
    buffer_load_dwordx4 v239, s[40:43], s73 offen lds
    s_addk_i32 m0, 1056
    s_addk_i32 s73, 8192
    buffer_load_dwordx4 v239, s[40:43], s73 offen lds
    s_addk_i32 m0, 1056
    s_add_u32 s73, s73, 40960
    buffer_load_dwordx4 v239, s[40:43], s73 offen lds
    s_addk_i32 m0, 1056
    s_addk_i32 s73, 8192
    buffer_load_dwordx4 v239, s[40:43], s73 offen lds
    s_addk_i32 m0, 1056
    s_addk_i32 s73, 8192
    buffer_load_dwordx4 v239, s[40:43], s73 offen lds
    s_addk_i32 m0, 1056
    s_addk_i32 s73, 8192
    buffer_load_dwordx4 v239, s[40:43], s73 offen lds
    s_addk_i32 m0, 1056
    s_add_u32 s73, s73, 40960
    buffer_load_dwordx4 v239, s[40:43], s73 offen lds
    s_addk_i32 m0, 1056
    s_addk_i32 s73, 8192
    buffer_load_dwordx4 v239, s[40:43], s73 offen lds
    s_addk_i32 m0, 1056
    s_addk_i32 s73, 8192
    buffer_load_dwordx4 v239, s[40:43], s73 offen lds
    s_addk_i32 m0, 1056
    s_addk_i32 s73, 8192
    buffer_load_dwordx4 v239, s[40:43], s73 offen lds
    s_addk_i32 m0, 1056
    s_add_u32 s73, s73, 40960
    buffer_load_dwordx4 v239, s[40:43], s73 offen lds
    s_waitcnt vmcnt(55)
    s_addk_i32 m0, 1056
    s_addk_i32 s73, 8192
    buffer_load_dwordx4 v239, s[40:43], s73 offen lds
    s_addk_i32 m0, 1056
    s_addk_i32 s73, 8192
    buffer_load_dwordx4 v239, s[40:43], s73 offen lds
    s_addk_i32 m0, 1056
    s_addk_i32 s73, 8192
    buffer_load_dwordx4 v239, s[40:43], s73 offen lds
    s_mov_b32 m0, 50688
    s_mov_b32 s73, 3145728
    buffer_load_dwordx4 v239, s[40:43], s73 offen lds
    s_addk_i32 m0, 1056
    s_addk_i32 s73, 8192
    buffer_load_dwordx4 v239, s[40:43], s73 offen lds
    s_addk_i32 m0, 1056
    s_addk_i32 s73, 8192
    buffer_load_dwordx4 v239, s[40:43], s73 offen lds
    s_addk_i32 m0, 1056
    s_addk_i32 s73, 8192
    buffer_load_dwordx4 v239, s[40:43], s73 offen lds
    s_addk_i32 m0, 1056
    s_add_u32 s73, s73, 40960
    buffer_load_dwordx4 v239, s[40:43], s73 offen lds
    s_waitcnt vmcnt(55)
    s_addk_i32 m0, 1056
    s_addk_i32 s73, 8192
    buffer_load_dwordx4 v239, s[40:43], s73 offen lds
    s_addk_i32 m0, 1056
    s_addk_i32 s73, 8192
    buffer_load_dwordx4 v239, s[40:43], s73 offen lds
    s_addk_i32 m0, 1056
    s_addk_i32 s73, 8192
    buffer_load_dwordx4 v239, s[40:43], s73 offen lds
    s_addk_i32 m0, 1056
    s_add_u32 s73, s73, 40960
    buffer_load_dwordx4 v239, s[40:43], s73 offen lds
    s_addk_i32 m0, 1056
    s_addk_i32 s73, 8192
    buffer_load_dwordx4 v239, s[40:43], s73 offen lds
    s_addk_i32 m0, 1056
    s_addk_i32 s73, 8192
    buffer_load_dwordx4 v239, s[40:43], s73 offen lds
    s_addk_i32 m0, 1056
    s_addk_i32 s73, 8192
    buffer_load_dwordx4 v239, s[40:43], s73 offen lds
    s_addk_i32 m0, 1056
    s_add_u32 s73, s73, 40960
    buffer_load_dwordx4 v239, s[40:43], s73 offen lds
    s_waitcnt vmcnt(60)
    s_addk_i32 m0, 1056
    s_addk_i32 s73, 8192
    buffer_load_dwordx4 v239, s[40:43], s73 offen lds
    s_addk_i32 m0, 1056
    s_addk_i32 s73, 8192
    buffer_load_dwordx4 v239, s[40:43], s73 offen lds
    s_addk_i32 m0, 1056
    s_addk_i32 s73, 8192
    buffer_load_dwordx4 v239, s[40:43], s73 offen lds
    v_lshrrev_b32 v162, 1, v240
    v_mul_u32_u24 v162, 896, v162
    v_and_b32 v163, 1, v240
    v_lshl_add_u32 v162, v163, 7, v162
    s_mul_i32 s71, s27, 28672
    s_add_u32 s71, s71, 640
    s_waitcnt vmcnt(62)
    buffer_load_dword v246, v162, s[52:55], s71 offen
    s_waitcnt vmcnt(51)
    s_barrier
    s_mov_b32 m0, 67584
    s_mov_b32 s73, 2621696
    buffer_load_dwordx4 v239, s[40:43], s73 offen lds
    s_addk_i32 m0, 1056
    s_addk_i32 s73, 8192
    buffer_load_dwordx4 v239, s[40:43], s73 offen lds
    s_addk_i32 m0, 1056
    s_addk_i32 s73, 8192
    buffer_load_dwordx4 v239, s[40:43], s73 offen lds
    s_addk_i32 m0, 1056
    s_addk_i32 s73, 8192
    buffer_load_dwordx4 v239, s[40:43], s73 offen lds
    s_addk_i32 m0, 1056
    s_add_u32 s73, s73, 40960
    buffer_load_dwordx4 v239, s[40:43], s73 offen lds
    s_addk_i32 m0, 1056
    s_addk_i32 s73, 8192
    buffer_load_dwordx4 v239, s[40:43], s73 offen lds
    s_addk_i32 m0, 1056
    s_addk_i32 s73, 8192
    buffer_load_dwordx4 v239, s[40:43], s73 offen lds
    s_addk_i32 m0, 1056
    s_addk_i32 s73, 8192
    buffer_load_dwordx4 v239, s[40:43], s73 offen lds
    s_addk_i32 m0, 1056
    s_add_u32 s73, s73, 40960
    buffer_load_dwordx4 v239, s[40:43], s73 offen lds
    s_addk_i32 m0, 1056
    s_addk_i32 s73, 8192
    buffer_load_dwordx4 v239, s[40:43], s73 offen lds
    s_addk_i32 m0, 1056
    s_addk_i32 s73, 8192
    buffer_load_dwordx4 v239, s[40:43], s73 offen lds
    s_addk_i32 m0, 1056
    s_addk_i32 s73, 8192
    buffer_load_dwordx4 v239, s[40:43], s73 offen lds
    s_waitcnt vmcnt(55)
    s_addk_i32 m0, 1056
    s_add_u32 s73, s73, 40960
    buffer_load_dwordx4 v239, s[40:43], s73 offen lds
    s_addk_i32 m0, 1056
    s_addk_i32 s73, 8192
    buffer_load_dwordx4 v239, s[40:43], s73 offen lds
    s_addk_i32 m0, 1056
    s_addk_i32 s73, 8192
    buffer_load_dwordx4 v239, s[40:43], s73 offen lds
    s_addk_i32 m0, 1056
    s_addk_i32 s73, 8192
    buffer_load_dwordx4 v239, s[40:43], s73 offen lds
    s_mov_b32 m0, 84480
    s_mov_b32 s73, 3145984
    buffer_load_dwordx4 v239, s[40:43], s73 offen lds
    s_addk_i32 m0, 1056
    s_addk_i32 s73, 8192
    buffer_load_dwordx4 v239, s[40:43], s73 offen lds
    s_addk_i32 m0, 1056
    s_addk_i32 s73, 8192
    buffer_load_dwordx4 v239, s[40:43], s73 offen lds
    s_addk_i32 m0, 1056
    s_addk_i32 s73, 8192
    buffer_load_dwordx4 v239, s[40:43], s73 offen lds
    s_waitcnt vmcnt(55)
    s_addk_i32 m0, 1056
    s_add_u32 s73, s73, 40960
    buffer_load_dwordx4 v239, s[40:43], s73 offen lds
    s_addk_i32 m0, 1056
    s_addk_i32 s73, 8192
    buffer_load_dwordx4 v239, s[40:43], s73 offen lds
    s_addk_i32 m0, 1056
    s_addk_i32 s73, 8192
    buffer_load_dwordx4 v239, s[40:43], s73 offen lds
    s_addk_i32 m0, 1056
    s_addk_i32 s73, 8192
    buffer_load_dwordx4 v239, s[40:43], s73 offen lds
    s_addk_i32 m0, 1056
    s_add_u32 s73, s73, 40960
    buffer_load_dwordx4 v239, s[40:43], s73 offen lds
    s_addk_i32 m0, 1056
    s_addk_i32 s73, 8192
    buffer_load_dwordx4 v239, s[40:43], s73 offen lds
    s_addk_i32 m0, 1056
    s_addk_i32 s73, 8192
    buffer_load_dwordx4 v239, s[40:43], s73 offen lds
    s_addk_i32 m0, 1056
    s_addk_i32 s73, 8192
    buffer_load_dwordx4 v239, s[40:43], s73 offen lds
    s_waitcnt vmcnt(59)
    s_addk_i32 m0, 1056
    s_add_u32 s73, s73, 40960
    buffer_load_dwordx4 v239, s[40:43], s73 offen lds
    s_addk_i32 m0, 1056
    s_addk_i32 s73, 8192
    buffer_load_dwordx4 v239, s[40:43], s73 offen lds
    s_addk_i32 m0, 1056
    s_addk_i32 s73, 8192
    buffer_load_dwordx4 v239, s[40:43], s73 offen lds
    s_addk_i32 m0, 1056
    s_addk_i32 s73, 8192
    buffer_load_dwordx4 v239, s[40:43], s73 offen lds
    s_waitcnt lgkmcnt(0)
    s_mul_i32 s90, s90, 0x9e3779b1
    s_add_u32 s90, s90, 0x7f4a7c15
    s_getreg_b32 s91, hwreg(HW_REG_XCC_ID)
    s_and_b32 s91, s91, 15
    s_add_u32 s91, s91, s90
    s_add_u32 s91, s91, 32
    v_mov_b32 v157, s91
    s_lshl_b32 s71, s26, 11
    v_and_b32 v155, 32, v240
    v_lshlrev_b32 v155, 12, v155
    v_lshl_add_u32 v158, v240, 2, v155
    s_waitcnt vmcnt(62)
    buffer_store_dword v157, v158, s[92:95], s71 offen offset:1024 sc1
    v_and_b32 v153, 15, v240
    v_lshlrev_b32 v153, 11, v153
    v_add_u32 v153, 1024, v153
    v_lshrrev_b32 v162, 1, v240
    v_mul_u32_u24 v162, 896, v162
    v_and_b32 v163, 1, v240
    v_lshl_add_u32 v162, v163, 7, v162
    s_mul_i32 s71, s27, 28672
    s_add_u32 s71, s71, 384
    s_waitcnt vmcnt(62)
    buffer_load_dword v246, v162, s[52:55], s71 offen
    s_waitcnt vmcnt(62)
    buffer_load_dword v246, v248, s[4:7], s8 offen
    s_waitcnt vmcnt(36)
    s_barrier
    s_mov_b32 m0, 101376
    s_mov_b32 s73, 0
    buffer_load_dwordx4 v241, s[44:47], s73 offen nt lds
    s_addk_i32 m0, 1056
    s_addk_i32 s73, 512
    buffer_load_dwordx4 v241, s[44:47], s73 offen nt lds
    s_addk_i32 m0, 1056
    s_addk_i32 s73, 512
    buffer_load_dwordx4 v241, s[44:47], s73 offen nt lds
    s_addk_i32 m0, 1056
    s_addk_i32 s73, 512
    buffer_load_dwordx4 v241, s[44:47], s73 offen nt lds
    s_addk_i32 m0, 1056
    s_addk_i32 s73, 512
    buffer_load_dwordx4 v241, s[44:47], s73 offen nt lds
    s_addk_i32 m0, 1056
    s_addk_i32 s73, 512
    buffer_load_dwordx4 v241, s[44:47], s73 offen nt lds
    s_addk_i32 m0, 1056
    s_addk_i32 s73, 512
    buffer_load_dwordx4 v241, s[44:47], s73 offen nt lds
    s_addk_i32 m0, 1056
    s_addk_i32 s73, 512
    buffer_load_dwordx4 v241, s[44:47], s73 offen nt lds
    s_addk_i32 m0, 1056
    s_addk_i32 s73, 512
    buffer_load_dwordx4 v241, s[44:47], s73 offen nt lds
    s_addk_i32 m0, 1056
    s_addk_i32 s73, 512
    buffer_load_dwordx4 v241, s[44:47], s73 offen nt lds
    s_addk_i32 m0, 1056
    s_addk_i32 s73, 512
    buffer_load_dwordx4 v241, s[44:47], s73 offen nt lds
    s_addk_i32 m0, 1056
    s_addk_i32 s73, 512
    buffer_load_dwordx4 v241, s[44:47], s73 offen nt lds
    s_addk_i32 m0, 1056
    s_addk_i32 s73, 512
    buffer_load_dwordx4 v241, s[44:47], s73 offen nt lds
    s_addk_i32 m0, 1056
    s_addk_i32 s73, 512
    buffer_load_dwordx4 v241, s[44:47], s73 offen nt lds
    s_addk_i32 m0, 1056
    s_addk_i32 s73, 512
    buffer_load_dwordx4 v241, s[44:47], s73 offen nt lds
    s_addk_i32 m0, 1056
    s_addk_i32 s73, 512
    buffer_load_dwordx4 v241, s[44:47], s73 offen nt lds
    s_mov_b32 m0, 118272
    s_mov_b32 s73, 16384
    buffer_load_dwordx4 v241, s[44:47], s73 offen nt lds
    s_addk_i32 m0, 1056
    s_addk_i32 s73, 512
    buffer_load_dwordx4 v241, s[44:47], s73 offen nt lds
    s_addk_i32 m0, 1056
    s_addk_i32 s73, 512
    buffer_load_dwordx4 v241, s[44:47], s73 offen nt lds
    s_addk_i32 m0, 1056
    s_addk_i32 s73, 512
    buffer_load_dwordx4 v241, s[44:47], s73 offen nt lds
    s_addk_i32 m0, 1056
    s_addk_i32 s73, 512
    buffer_load_dwordx4 v241, s[44:47], s73 offen nt lds
    s_addk_i32 m0, 1056
    s_addk_i32 s73, 512
    buffer_load_dwordx4 v241, s[44:47], s73 offen nt lds
    s_addk_i32 m0, 1056
    s_addk_i32 s73, 512
    buffer_load_dwordx4 v241, s[44:47], s73 offen nt lds
    s_addk_i32 m0, 1056
    s_addk_i32 s73, 512
    buffer_load_dwordx4 v241, s[44:47], s73 offen nt lds
    s_addk_i32 m0, 1056
    s_addk_i32 s73, 512
    buffer_load_dwordx4 v241, s[44:47], s73 offen nt lds
    s_addk_i32 m0, 1056
    s_addk_i32 s73, 512
    buffer_load_dwordx4 v241, s[44:47], s73 offen nt lds
    s_addk_i32 m0, 1056
    s_addk_i32 s73, 512
    buffer_load_dwordx4 v241, s[44:47], s73 offen nt lds
    s_waitcnt vmcnt(58)
    s_addk_i32 m0, 1056
    s_addk_i32 s73, 512
    buffer_load_dwordx4 v241, s[44:47], s73 offen nt lds
    s_addk_i32 m0, 1056
    s_addk_i32 s73, 512
    buffer_load_dwordx4 v241, s[44:47], s73 offen nt lds
    s_addk_i32 m0, 1056
    s_addk_i32 s73, 512
    buffer_load_dwordx4 v241, s[44:47], s73 offen nt lds
    s_addk_i32 m0, 1056
    s_addk_i32 s73, 512
    buffer_load_dwordx4 v241, s[44:47], s73 offen nt lds
    s_addk_i32 m0, 1056
    s_addk_i32 s73, 512
    buffer_load_dwordx4 v241, s[44:47], s73 offen nt lds
    s_waitcnt vmcnt(35)
    s_barrier
    s_mov_b32 m0, 0
    s_mov_b32 s73, 0
    buffer_load_dwordx4 v241, s[48:51], s73 offen nt lds
    s_addk_i32 m0, 1056
    s_addk_i32 s73, 512
    buffer_load_dwordx4 v241, s[48:51], s73 offen nt lds
    s_addk_i32 m0, 1056
    s_addk_i32 s73, 512
    buffer_load_dwordx4 v241, s[48:51], s73 offen nt lds
    s_addk_i32 m0, 1056
    s_addk_i32 s73, 512
    buffer_load_dwordx4 v241, s[48:51], s73 offen nt lds
    s_addk_i32 m0, 1056
    s_addk_i32 s73, 512
    buffer_load_dwordx4 v241, s[48:51], s73 offen nt lds
    s_addk_i32 m0, 1056
    s_addk_i32 s73, 512
    buffer_load_dwordx4 v241, s[48:51], s73 offen nt lds
    s_addk_i32 m0, 1056
    s_addk_i32 s73, 512
    buffer_load_dwordx4 v241, s[48:51], s73 offen nt lds
    s_addk_i32 m0, 1056
    s_addk_i32 s73, 512
    buffer_load_dwordx4 v241, s[48:51], s73 offen nt lds
    s_addk_i32 m0, 1056
    s_addk_i32 s73, 512
    buffer_load_dwordx4 v241, s[48:51], s73 offen nt lds
    s_addk_i32 m0, 1056
    s_addk_i32 s73, 512
    buffer_load_dwordx4 v241, s[48:51], s73 offen nt lds
    s_addk_i32 m0, 1056
    s_addk_i32 s73, 512
    buffer_load_dwordx4 v241, s[48:51], s73 offen nt lds
    s_addk_i32 m0, 1056
    s_addk_i32 s73, 512
    buffer_load_dwordx4 v241, s[48:51], s73 offen nt lds
    s_addk_i32 m0, 1056
    s_addk_i32 s73, 512
    buffer_load_dwordx4 v241, s[48:51], s73 offen nt lds
    s_addk_i32 m0, 1056
    s_addk_i32 s73, 512
    buffer_load_dwordx4 v241, s[48:51], s73 offen nt lds
    s_addk_i32 m0, 1056
    s_addk_i32 s73, 512
    buffer_load_dwordx4 v241, s[48:51], s73 offen nt lds
    s_addk_i32 m0, 1056
    s_addk_i32 s73, 512
    buffer_load_dwordx4 v241, s[48:51], s73 offen nt lds
    s_mov_b32 m0, 16896
    s_mov_b32 s73, 32768
    buffer_load_dwordx4 v241, s[44:47], s73 offen nt lds
    s_addk_i32 m0, 1056
    s_addk_i32 s73, 512
    buffer_load_dwordx4 v241, s[44:47], s73 offen nt lds
    s_addk_i32 m0, 1056
    s_addk_i32 s73, 512
    buffer_load_dwordx4 v241, s[44:47], s73 offen nt lds
    s_addk_i32 m0, 1056
    s_addk_i32 s73, 512
    buffer_load_dwordx4 v241, s[44:47], s73 offen nt lds
    s_addk_i32 m0, 1056
    s_addk_i32 s73, 512
    buffer_load_dwordx4 v241, s[44:47], s73 offen nt lds
    s_addk_i32 m0, 1056
    s_addk_i32 s73, 512
    buffer_load_dwordx4 v241, s[44:47], s73 offen nt lds
    s_addk_i32 m0, 1056
    s_addk_i32 s73, 512
    buffer_load_dwordx4 v241, s[44:47], s73 offen nt lds
    s_addk_i32 m0, 1056
    s_addk_i32 s73, 512
    buffer_load_dwordx4 v241, s[44:47], s73 offen nt lds
    s_addk_i32 m0, 1056
    s_addk_i32 s73, 512
    buffer_load_dwordx4 v241, s[44:47], s73 offen nt lds
    s_addk_i32 m0, 1056
    s_addk_i32 s73, 512
    buffer_load_dwordx4 v241, s[44:47], s73 offen nt lds
    s_addk_i32 m0, 1056
    s_addk_i32 s73, 512
    buffer_load_dwordx4 v241, s[44:47], s73 offen nt lds
    s_addk_i32 m0, 1056
    s_addk_i32 s73, 512
    buffer_load_dwordx4 v241, s[44:47], s73 offen nt lds
    s_waitcnt vmcnt(59)
    s_addk_i32 m0, 1056
    s_addk_i32 s73, 512
    buffer_load_dwordx4 v241, s[44:47], s73 offen nt lds
    s_addk_i32 m0, 1056
    s_addk_i32 s73, 512
    buffer_load_dwordx4 v241, s[44:47], s73 offen nt lds
    s_addk_i32 m0, 1056
    s_addk_i32 s73, 512
    buffer_load_dwordx4 v241, s[44:47], s73 offen nt lds
    s_addk_i32 m0, 1056
    s_addk_i32 s73, 512
    buffer_load_dwordx4 v241, s[44:47], s73 offen nt lds
    s_waitcnt vmcnt(48)
    s_barrier
    s_mov_b32 m0, 33792
    s_mov_b32 s73, 16384
    buffer_load_dwordx4 v241, s[48:51], s73 offen nt lds
    s_addk_i32 m0, 1056
    s_addk_i32 s73, 512
    buffer_load_dwordx4 v241, s[48:51], s73 offen nt lds
    s_addk_i32 m0, 1056
    s_addk_i32 s73, 512
    buffer_load_dwordx4 v241, s[48:51], s73 offen nt lds
    s_addk_i32 m0, 1056
    s_addk_i32 s73, 512
    buffer_load_dwordx4 v241, s[48:51], s73 offen nt lds
    s_addk_i32 m0, 1056
    s_addk_i32 s73, 512
    buffer_load_dwordx4 v241, s[48:51], s73 offen nt lds
    s_addk_i32 m0, 1056
    s_addk_i32 s73, 512
    buffer_load_dwordx4 v241, s[48:51], s73 offen nt lds
    s_addk_i32 m0, 1056
    s_addk_i32 s73, 512
    buffer_load_dwordx4 v241, s[48:51], s73 offen nt lds
    s_addk_i32 m0, 1056
    s_addk_i32 s73, 512
    buffer_load_dwordx4 v241, s[48:51], s73 offen nt lds
    s_addk_i32 m0, 1056
    s_addk_i32 s73, 512
    buffer_load_dwordx4 v241, s[48:51], s73 offen nt lds
    s_addk_i32 m0, 1056
    s_addk_i32 s73, 512
    buffer_load_dwordx4 v241, s[48:51], s73 offen nt lds
    s_addk_i32 m0, 1056
    s_addk_i32 s73, 512
    buffer_load_dwordx4 v241, s[48:51], s73 offen nt lds
    s_addk_i32 m0, 1056
    s_addk_i32 s73, 512
    buffer_load_dwordx4 v241, s[48:51], s73 offen nt lds
    s_addk_i32 m0, 1056
    s_addk_i32 s73, 512
    buffer_load_dwordx4 v241, s[48:51], s73 offen nt lds
    s_addk_i32 m0, 1056
    s_addk_i32 s73, 512
    buffer_load_dwordx4 v241, s[48:51], s73 offen nt lds
    s_addk_i32 m0, 1056
    s_addk_i32 s73, 512
    buffer_load_dwordx4 v241, s[48:51], s73 offen nt lds
    s_waitcnt vmcnt(55)
    s_addk_i32 m0, 1056
    s_addk_i32 s73, 512
    buffer_load_dwordx4 v241, s[48:51], s73 offen nt lds
    s_mov_b32 m0, 50688
    s_mov_b32 s73, 49152
    buffer_load_dwordx4 v241, s[44:47], s73 offen nt lds
    s_addk_i32 m0, 1056
    s_addk_i32 s73, 512
    buffer_load_dwordx4 v241, s[44:47], s73 offen nt lds
    s_addk_i32 m0, 1056
    s_addk_i32 s73, 512
    buffer_load_dwordx4 v241, s[44:47], s73 offen nt lds
    s_addk_i32 m0, 1056
    s_addk_i32 s73, 512
    buffer_load_dwordx4 v241, s[44:47], s73 offen nt lds
    s_addk_i32 m0, 1056
    s_addk_i32 s73, 512
    buffer_load_dwordx4 v241, s[44:47], s73 offen nt lds
    s_addk_i32 m0, 1056
    s_addk_i32 s73, 512
    buffer_load_dwordx4 v241, s[44:47], s73 offen nt lds
    s_addk_i32 m0, 1056
    s_addk_i32 s73, 512
    buffer_load_dwordx4 v241, s[44:47], s73 offen nt lds
    s_waitcnt vmcnt(55)
    s_addk_i32 m0, 1056
    s_addk_i32 s73, 512
    buffer_load_dwordx4 v241, s[44:47], s73 offen nt lds
    s_addk_i32 m0, 1056
    s_addk_i32 s73, 512
    buffer_load_dwordx4 v241, s[44:47], s73 offen nt lds
    s_addk_i32 m0, 1056
    s_addk_i32 s73, 512
    buffer_load_dwordx4 v241, s[44:47], s73 offen nt lds
    s_addk_i32 m0, 1056
    s_addk_i32 s73, 512
    buffer_load_dwordx4 v241, s[44:47], s73 offen nt lds
    s_addk_i32 m0, 1056
    s_addk_i32 s73, 512
    buffer_load_dwordx4 v241, s[44:47], s73 offen nt lds
    s_addk_i32 m0, 1056
    s_addk_i32 s73, 512
    buffer_load_dwordx4 v241, s[44:47], s73 offen nt lds
    s_addk_i32 m0, 1056
    s_addk_i32 s73, 512
    buffer_load_dwordx4 v241, s[44:47], s73 offen nt lds
    s_addk_i32 m0, 1056
    s_addk_i32 s73, 512
    buffer_load_dwordx4 v241, s[44:47], s73 offen nt lds
    s_waitcnt vmcnt(60)
    s_addk_i32 m0, 1056
    s_addk_i32 s73, 512
    buffer_load_dwordx4 v241, s[44:47], s73 offen nt lds
    s_mov_b32 m0, 135168
    s_mov_b32 s73, 65536
    buffer_load_dwordx4 v241, s[48:51], s73 offen nt lds
    s_addk_i32 m0, 1056
    s_addk_i32 s73, 512
    buffer_load_dwordx4 v241, s[48:51], s73 offen nt lds
    s_waitcnt vmcnt(50)
    s_barrier
    s_mov_b32 m0, 67584
    s_mov_b32 s73, 32768
    buffer_load_dwordx4 v241, s[48:51], s73 offen nt lds
    s_addk_i32 m0, 1056
    s_addk_i32 s73, 512
    buffer_load_dwordx4 v241, s[48:51], s73 offen nt lds
    s_addk_i32 m0, 1056
    s_addk_i32 s73, 512
    buffer_load_dwordx4 v241, s[48:51], s73 offen nt lds
    s_addk_i32 m0, 1056
    s_addk_i32 s73, 512
    buffer_load_dwordx4 v241, s[48:51], s73 offen nt lds
    s_addk_i32 m0, 1056
    s_addk_i32 s73, 512
    buffer_load_dwordx4 v241, s[48:51], s73 offen nt lds
    s_addk_i32 m0, 1056
    s_addk_i32 s73, 512
    buffer_load_dwordx4 v241, s[48:51], s73 offen nt lds
    s_addk_i32 m0, 1056
    s_addk_i32 s73, 512
    buffer_load_dwordx4 v241, s[48:51], s73 offen nt lds
    s_addk_i32 m0, 1056
    s_addk_i32 s73, 512
    buffer_load_dwordx4 v241, s[48:51], s73 offen nt lds
    s_addk_i32 m0, 1056
    s_addk_i32 s73, 512
    buffer_load_dwordx4 v241, s[48:51], s73 offen nt lds
    s_addk_i32 m0, 1056
    s_addk_i32 s73, 512
    buffer_load_dwordx4 v241, s[48:51], s73 offen nt lds
    s_addk_i32 m0, 1056
    s_addk_i32 s73, 512
    buffer_load_dwordx4 v241, s[48:51], s73 offen nt lds
    s_addk_i32 m0, 1056
    s_addk_i32 s73, 512
    buffer_load_dwordx4 v241, s[48:51], s73 offen nt lds
    s_addk_i32 m0, 1056
    s_addk_i32 s73, 512
    buffer_load_dwordx4 v241, s[48:51], s73 offen nt lds
    s_waitcnt vmcnt(55)
    s_addk_i32 m0, 1056
    s_addk_i32 s73, 512
    buffer_load_dwordx4 v241, s[48:51], s73 offen nt lds
    s_addk_i32 m0, 1056
    s_addk_i32 s73, 512
    buffer_load_dwordx4 v241, s[48:51], s73 offen nt lds
    s_addk_i32 m0, 1056
    s_addk_i32 s73, 512
    buffer_load_dwordx4 v241, s[48:51], s73 offen nt lds
    s_mov_b32 m0, 84480
    s_mov_b32 s73, 65536
    buffer_load_dwordx4 v241, s[44:47], s73 offen nt lds
    s_addk_i32 m0, 1056
    s_addk_i32 s73, 512
    buffer_load_dwordx4 v241, s[44:47], s73 offen nt lds
    s_addk_i32 m0, 1056
    s_addk_i32 s73, 512
    buffer_load_dwordx4 v241, s[44:47], s73 offen nt lds
    s_addk_i32 m0, 1056
    s_addk_i32 s73, 512
    buffer_load_dwordx4 v241, s[44:47], s73 offen nt lds
    s_addk_i32 m0, 1056
    s_addk_i32 s73, 512
    buffer_load_dwordx4 v241, s[44:47], s73 offen nt lds
    s_waitcnt vmcnt(55)
    s_addk_i32 m0, 1056
    s_addk_i32 s73, 512
    buffer_load_dwordx4 v241, s[44:47], s73 offen nt lds
    s_addk_i32 m0, 1056
    s_addk_i32 s73, 512
    buffer_load_dwordx4 v241, s[44:47], s73 offen nt lds
    s_addk_i32 m0, 1056
    s_addk_i32 s73, 512
    buffer_load_dwordx4 v241, s[44:47], s73 offen nt lds
    s_addk_i32 m0, 1056
    s_addk_i32 s73, 512
    buffer_load_dwordx4 v241, s[44:47], s73 offen nt lds
    s_addk_i32 m0, 1056
    s_addk_i32 s73, 512
    buffer_load_dwordx4 v241, s[44:47], s73 offen nt lds
    s_addk_i32 m0, 1056
    s_addk_i32 s73, 512
    buffer_load_dwordx4 v241, s[44:47], s73 offen nt lds
    s_addk_i32 m0, 1056
    s_addk_i32 s73, 512
    buffer_load_dwordx4 v241, s[44:47], s73 offen nt lds
    s_addk_i32 m0, 1056
    s_addk_i32 s73, 512
    buffer_load_dwordx4 v241, s[44:47], s73 offen nt lds
    s_waitcnt vmcnt(55)
    s_addk_i32 m0, 1056
    s_addk_i32 s73, 512
    buffer_load_dwordx4 v241, s[44:47], s73 offen nt lds
    s_addk_i32 m0, 1056
    s_addk_i32 s73, 512
    buffer_load_dwordx4 v241, s[44:47], s73 offen nt lds
    s_addk_i32 m0, 1056
    s_addk_i32 s73, 512
    buffer_load_dwordx4 v241, s[44:47], s73 offen nt lds
    s_mov_b32 m0, 137280
    s_mov_b32 s73, 66560
    buffer_load_dwordx4 v241, s[48:51], s73 offen nt lds
    s_addk_i32 m0, 1056
    s_addk_i32 s73, 512
    buffer_load_dwordx4 v241, s[48:51], s73 offen nt lds
    s_addk_i32 m0, 1056
    s_addk_i32 s73, 512
    buffer_load_dwordx4 v241, s[48:51], s73 offen nt lds
    s_addk_i32 m0, 1056
    s_addk_i32 s73, 512
    buffer_load_dwordx4 v241, s[48:51], s73 offen nt lds
    s_addk_i32 m0, 1056
    s_addk_i32 s73, 512
    buffer_load_dwordx4 v241, s[48:51], s73 offen nt lds
    s_waitcnt vmcnt(62)
    s_addk_i32 m0, 1056
    s_addk_i32 s73, 512
    buffer_load_dwordx4 v241, s[48:51], s73 offen nt lds
    s_waitcnt vmcnt(56)
    s_barrier
    s_mov_b32 m0, 101376
    s_mov_b32 s73, 49152
    buffer_load_dwordx4 v241, s[48:51], s73 offen nt lds
    s_addk_i32 m0, 1056
    s_addk_i32 s73, 512
    buffer_load_dwordx4 v241, s[48:51], s73 offen nt lds
    s_addk_i32 m0, 1056
    s_addk_i32 s73, 512
    buffer_load_dwordx4 v241, s[48:51], s73 offen nt lds
    s_addk_i32 m0, 1056
    s_addk_i32 s73, 512
    buffer_load_dwordx4 v241, s[48:51], s73 offen nt lds
    s_addk_i32 m0, 1056
    s_addk_i32 s73, 512
    buffer_load_dwordx4 v241, s[48:51], s73 offen nt lds
    s_addk_i32 m0, 1056
    s_addk_i32 s73, 512
    buffer_load_dwordx4 v241, s[48:51], s73 offen nt lds
    s_addk_i32 m0, 1056
    s_addk_i32 s73, 512
    buffer_load_dwordx4 v241, s[48:51], s73 offen nt lds
    s_waitcnt vmcnt(55)
    s_addk_i32 m0, 1056
    s_addk_i32 s73, 512
    buffer_load_dwordx4 v241, s[48:51], s73 offen nt lds
    s_addk_i32 m0, 1056
    s_addk_i32 s73, 512
    buffer_load_dwordx4 v241, s[48:51], s73 offen nt lds
    s_addk_i32 m0, 1056
    s_addk_i32 s73, 512
    buffer_load_dwordx4 v241, s[48:51], s73 offen nt lds
    s_addk_i32 m0, 1056
    s_addk_i32 s73, 512
    buffer_load_dwordx4 v241, s[48:51], s73 offen nt lds
    s_addk_i32 m0, 1056
    s_addk_i32 s73, 512
    buffer_load_dwordx4 v241, s[48:51], s73 offen nt lds
    s_addk_i32 m0, 1056
    s_addk_i32 s73, 512
    buffer_load_dwordx4 v241, s[48:51], s73 offen nt lds
    s_addk_i32 m0, 1056
    s_addk_i32 s73, 512
    buffer_load_dwordx4 v241, s[48:51], s73 offen nt lds
    s_addk_i32 m0, 1056
    s_addk_i32 s73, 512
    buffer_load_dwordx4 v241, s[48:51], s73 offen nt lds
    s_waitcnt vmcnt(55)
    s_addk_i32 m0, 1056
    s_addk_i32 s73, 512
    buffer_load_dwordx4 v241, s[48:51], s73 offen nt lds
    s_mov_b32 m0, 118272
    s_mov_b32 s73, 81920
    buffer_load_dwordx4 v241, s[44:47], s73 offen nt lds
    s_addk_i32 m0, 1056
    s_addk_i32 s73, 512
    buffer_load_dwordx4 v241, s[44:47], s73 offen nt lds
    s_addk_i32 m0, 1056
    s_addk_i32 s73, 512
    buffer_load_dwordx4 v241, s[44:47], s73 offen nt lds
    s_addk_i32 m0, 1056
    s_addk_i32 s73, 512
    buffer_load_dwordx4 v241, s[44:47], s73 offen nt lds
    s_addk_i32 m0, 1056
    s_addk_i32 s73, 512
    buffer_load_dwordx4 v241, s[44:47], s73 offen nt lds
    s_addk_i32 m0, 1056
    s_addk_i32 s73, 512
    buffer_load_dwordx4 v241, s[44:47], s73 offen nt lds
    s_addk_i32 m0, 1056
    s_addk_i32 s73, 512
    buffer_load_dwordx4 v241, s[44:47], s73 offen nt lds
    s_waitcnt vmcnt(55)
    s_addk_i32 m0, 1056
    s_addk_i32 s73, 512
    buffer_load_dwordx4 v241, s[44:47], s73 offen nt lds
    s_addk_i32 m0, 1056
    s_addk_i32 s73, 512
    buffer_load_dwordx4 v241, s[44:47], s73 offen nt lds
    s_addk_i32 m0, 1056
    s_addk_i32 s73, 512
    buffer_load_dwordx4 v241, s[44:47], s73 offen nt lds
    s_addk_i32 m0, 1056
    s_addk_i32 s73, 512
    buffer_load_dwordx4 v241, s[44:47], s73 offen nt lds
    s_addk_i32 m0, 1056
    s_addk_i32 s73, 512
    buffer_load_dwordx4 v241, s[44:47], s73 offen nt lds
    s_mov_b32 m0, 143616
    s_mov_b32 s73, 69632
    buffer_load_dwordx4 v241, s[48:51], s73 offen nt lds
    s_addk_i32 m0, 1056
    s_addk_i32 s73, 512
    buffer_load_dwordx4 v241, s[48:51], s73 offen nt lds
    s_addk_i32 m0, 1056
    s_addk_i32 s73, 512
    buffer_load_dwordx4 v241, s[48:51], s73 offen nt lds
    s_waitcnt vmcnt(62)
    s_addk_i32 m0, 1056
    s_addk_i32 s73, 512
    buffer_load_dwordx4 v241, s[48:51], s73 offen nt lds
    s_waitcnt vmcnt(54)
    s_barrier
    s_mov_b32 m0, 130944
    s_mov_b32 s73, 88064
    buffer_load_dwordx4 v241, s[44:47], s73 offen nt lds
    s_addk_i32 m0, 1056
    s_addk_i32 s73, 512
    buffer_load_dwordx4 v241, s[44:47], s73 offen nt lds
    s_addk_i32 m0, 1056
    s_addk_i32 s73, 512
    buffer_load_dwordx4 v241, s[44:47], s73 offen nt lds
    s_addk_i32 m0, 1056
    s_addk_i32 s73, 512
    buffer_load_dwordx4 v241, s[44:47], s73 offen nt lds
    s_mov_b32 m0, 0
    s_mov_b32 s73, 98304
    buffer_load_dwordx4 v241, s[44:47], s73 offen nt lds
    s_addk_i32 m0, 1056
    s_addk_i32 s73, 512
    buffer_load_dwordx4 v241, s[44:47], s73 offen nt lds
    s_addk_i32 m0, 1056
    s_addk_i32 s73, 512
    buffer_load_dwordx4 v241, s[44:47], s73 offen nt lds
    s_addk_i32 m0, 1056
    s_addk_i32 s73, 512
    buffer_load_dwordx4 v241, s[44:47], s73 offen nt lds
    s_addk_i32 m0, 1056
    s_addk_i32 s73, 512
    buffer_load_dwordx4 v241, s[44:47], s73 offen nt lds
    s_waitcnt vmcnt(55)
    s_addk_i32 m0, 1056
    s_addk_i32 s73, 512
    buffer_load_dwordx4 v241, s[44:47], s73 offen nt lds
    s_addk_i32 m0, 1056
    s_addk_i32 s73, 512
    buffer_load_dwordx4 v241, s[44:47], s73 offen nt lds
    s_addk_i32 m0, 1056
    s_addk_i32 s73, 512
    buffer_load_dwordx4 v241, s[44:47], s73 offen nt lds
    s_addk_i32 m0, 1056
    s_addk_i32 s73, 512
    buffer_load_dwordx4 v241, s[44:47], s73 offen nt lds
    s_addk_i32 m0, 1056
    s_addk_i32 s73, 512
    buffer_load_dwordx4 v241, s[44:47], s73 offen nt lds
    s_addk_i32 m0, 1056
    s_addk_i32 s73, 512
    buffer_load_dwordx4 v241, s[44:47], s73 offen nt lds
    s_addk_i32 m0, 1056
    s_addk_i32 s73, 512
    buffer_load_dwordx4 v241, s[44:47], s73 offen nt lds
    s_addk_i32 m0, 1056
    s_addk_i32 s73, 512
    buffer_load_dwordx4 v241, s[44:47], s73 offen nt lds
    s_waitcnt vmcnt(55)
    s_addk_i32 m0, 1056
    s_addk_i32 s73, 512
    buffer_load_dwordx4 v241, s[44:47], s73 offen nt lds
    s_addk_i32 m0, 1056
    s_addk_i32 s73, 512
    buffer_load_dwordx4 v241, s[44:47], s73 offen nt lds
    s_addk_i32 m0, 1056
    s_addk_i32 s73, 512
    buffer_load_dwordx4 v241, s[44:47], s73 offen nt lds
    s_mov_b32 m0, 16896
    s_mov_b32 s73, 81920
    buffer_load_dwordx4 v241, s[48:51], s73 offen nt lds
    s_addk_i32 m0, 1056
    s_addk_i32 s73, 512
    buffer_load_dwordx4 v241, s[48:51], s73 offen nt lds
    s_addk_i32 m0, 1056
    s_addk_i32 s73, 512
    buffer_load_dwordx4 v241, s[48:51], s73 offen nt lds
    s_addk_i32 m0, 1056
    s_addk_i32 s73, 512
    buffer_load_dwordx4 v241, s[48:51], s73 offen nt lds
    s_addk_i32 m0, 1056
    s_addk_i32 s73, 512
    buffer_load_dwordx4 v241, s[48:51], s73 offen nt lds
    s_waitcnt vmcnt(56)
    s_addk_i32 m0, 1056
    s_addk_i32 s73, 512
    buffer_load_dwordx4 v241, s[48:51], s73 offen nt lds
    s_addk_i32 m0, 1056
    s_addk_i32 s73, 512
    buffer_load_dwordx4 v241, s[48:51], s73 offen nt lds
    s_addk_i32 m0, 1056
    s_addk_i32 s73, 512
    buffer_load_dwordx4 v241, s[48:51], s73 offen nt lds
    s_mov_b32 m0, 147840
    s_mov_b32 s73, 71680
    buffer_load_dwordx4 v241, s[48:51], s73 offen nt lds
    s_addk_i32 m0, 1056
    s_addk_i32 s73, 512
    buffer_load_dwordx4 v241, s[48:51], s73 offen nt lds
    s_addk_i32 m0, 1056
    s_addk_i32 s73, 512
    buffer_load_dwordx4 v241, s[48:51], s73 offen nt lds
    s_addk_i32 m0, 1056
    s_addk_i32 s73, 512
    buffer_load_dwordx4 v241, s[48:51], s73 offen nt lds
    s_waitcnt vmcnt(48)
    s_barrier
    s_mov_b32 m0, 25344
    s_mov_b32 s73, 86016
    buffer_load_dwordx4 v241, s[48:51], s73 offen nt lds
    s_addk_i32 m0, 1056
    s_addk_i32 s73, 512
    buffer_load_dwordx4 v241, s[48:51], s73 offen nt lds
    s_addk_i32 m0, 1056
    s_addk_i32 s73, 512
    buffer_load_dwordx4 v241, s[48:51], s73 offen nt lds
    s_addk_i32 m0, 1056
    s_addk_i32 s73, 512
    buffer_load_dwordx4 v241, s[48:51], s73 offen nt lds
    s_addk_i32 m0, 1056
    s_addk_i32 s73, 512
    buffer_load_dwordx4 v241, s[48:51], s73 offen nt lds
    s_addk_i32 m0, 1056
    s_addk_i32 s73, 512
    buffer_load_dwordx4 v241, s[48:51], s73 offen nt lds
    s_addk_i32 m0, 1056
    s_addk_i32 s73, 512
    buffer_load_dwordx4 v241, s[48:51], s73 offen nt lds
    s_addk_i32 m0, 1056
    s_addk_i32 s73, 512
    buffer_load_dwordx4 v241, s[48:51], s73 offen nt lds
    s_mov_b32 m0, 33792
    s_mov_b32 s73, 114688
    buffer_load_dwordx4 v241, s[44:47], s73 offen nt lds
    s_addk_i32 m0, 1056
    s_addk_i32 s73, 512
    buffer_load_dwordx4 v241, s[44:47], s73 offen nt lds
    s_addk_i32 m0, 1056
    s_addk_i32 s73, 512
    buffer_load_dwordx4 v241, s[44:47], s73 offen nt lds
    s_addk_i32 m0, 1056
    s_addk_i32 s73, 512
    buffer_load_dwordx4 v241, s[44:47], s73 offen nt lds
    s_addk_i32 m0, 1056
    s_addk_i32 s73, 512
    buffer_load_dwordx4 v241, s[44:47], s73 offen nt lds
    s_addk_i32 m0, 1056
    s_addk_i32 s73, 512
    buffer_load_dwordx4 v241, s[44:47], s73 offen nt lds
    s_addk_i32 m0, 1056
    s_addk_i32 s73, 512
    buffer_load_dwordx4 v241, s[44:47], s73 offen nt lds
    s_waitcnt vmcnt(55)
    s_addk_i32 m0, 1056
    s_addk_i32 s73, 512
    buffer_load_dwordx4 v241, s[44:47], s73 offen nt lds
    s_addk_i32 m0, 1056
    s_addk_i32 s73, 512
    buffer_load_dwordx4 v241, s[44:47], s73 offen nt lds
    s_addk_i32 m0, 1056
    s_addk_i32 s73, 512
    buffer_load_dwordx4 v241, s[44:47], s73 offen nt lds
    s_addk_i32 m0, 1056
    s_addk_i32 s73, 512
    buffer_load_dwordx4 v241, s[44:47], s73 offen nt lds
    s_addk_i32 m0, 1056
    s_addk_i32 s73, 512
    buffer_load_dwordx4 v241, s[44:47], s73 offen nt lds
    s_addk_i32 m0, 1056
    s_addk_i32 s73, 512
    buffer_load_dwordx4 v241, s[44:47], s73 offen nt lds
    s_addk_i32 m0, 1056
    s_addk_i32 s73, 512
    buffer_load_dwordx4 v241, s[44:47], s73 offen nt lds
    s_addk_i32 m0, 1056
    s_addk_i32 s73, 512
    buffer_load_dwordx4 v241, s[44:47], s73 offen nt lds
    s_waitcnt vmcnt(59)
    s_addk_i32 m0, 1056
    s_addk_i32 s73, 512
    buffer_load_dwordx4 v241, s[44:47], s73 offen nt lds
    s_mov_b32 m0, 50688
    s_mov_b32 s73, 98304
    buffer_load_dwordx4 v241, s[48:51], s73 offen nt lds
    s_addk_i32 m0, 1056
    s_addk_i32 s73, 512
    buffer_load_dwordx4 v241, s[48:51], s73 offen nt lds
    s_addk_i32 m0, 1056
    s_addk_i32 s73, 512
    buffer_load_dwordx4 v241, s[48:51], s73 offen nt lds
    s_waitcnt vmcnt(27)
    s_barrier
    s_addk_i32 m0, 1056
    s_addk_i32 s73, 512
    buffer_load_dwordx4 v241, s[48:51], s73 offen nt lds
    s_addk_i32 m0, 1056
    s_addk_i32 s73, 512
    buffer_load_dwordx4 v241, s[48:51], s73 offen nt lds
    s_addk_i32 m0, 1056
    s_addk_i32 s73, 512
    buffer_load_dwordx4 v241, s[48:51], s73 offen nt lds
    s_addk_i32 m0, 1056
    s_addk_i32 s73, 512
    buffer_load_dwordx4 v241, s[48:51], s73 offen nt lds
    s_addk_i32 m0, 1056
    s_addk_i32 s73, 512
    buffer_load_dwordx4 v241, s[48:51], s73 offen nt lds
    s_addk_i32 m0, 1056
    s_addk_i32 s73, 512
    buffer_load_dwordx4 v241, s[48:51], s73 offen nt lds
    s_addk_i32 m0, 1056
    s_addk_i32 s73, 512
    buffer_load_dwordx4 v241, s[48:51], s73 offen nt lds
    s_addk_i32 m0, 1056
    s_addk_i32 s73, 512
    buffer_load_dwordx4 v241, s[48:51], s73 offen nt lds
    s_addk_i32 m0, 1056
    s_addk_i32 s73, 512
    buffer_load_dwordx4 v241, s[48:51], s73 offen nt lds
    s_addk_i32 m0, 1056
    s_addk_i32 s73, 512
    buffer_load_dwordx4 v241, s[48:51], s73 offen nt lds
    s_addk_i32 m0, 1056
    s_addk_i32 s73, 512
    buffer_load_dwordx4 v241, s[48:51], s73 offen nt lds
    s_addk_i32 m0, 1056
    s_addk_i32 s73, 512
    buffer_load_dwordx4 v241, s[48:51], s73 offen nt lds
    s_addk_i32 m0, 1056
    s_addk_i32 s73, 512
    buffer_load_dwordx4 v241, s[48:51], s73 offen nt lds
    s_mov_b32 m0, 67584
    s_mov_b32 s73, 131072
    buffer_load_dwordx4 v241, s[44:47], s73 offen nt lds
    s_addk_i32 m0, 1056
    s_addk_i32 s73, 512
    buffer_load_dwordx4 v241, s[44:47], s73 offen nt lds
    s_addk_i32 m0, 1056
    s_addk_i32 s73, 512
    buffer_load_dwordx4 v241, s[44:47], s73 offen nt lds
    s_addk_i32 m0, 1056
    s_addk_i32 s73, 512
    buffer_load_dwordx4 v241, s[44:47], s73 offen nt lds
    s_addk_i32 m0, 1056
    s_addk_i32 s73, 512
    buffer_load_dwordx4 v241, s[44:47], s73 offen nt lds
    s_addk_i32 m0, 1056
    s_addk_i32 s73, 512
    buffer_load_dwordx4 v241, s[44:47], s73 offen nt lds
    s_addk_i32 m0, 1056
    s_addk_i32 s73, 512
    buffer_load_dwordx4 v241, s[44:47], s73 offen nt lds
    s_addk_i32 m0, 1056
    s_addk_i32 s73, 512
    buffer_load_dwordx4 v241, s[44:47], s73 offen nt lds
    s_addk_i32 m0, 1056
    s_addk_i32 s73, 512
    buffer_load_dwordx4 v241, s[44:47], s73 offen nt lds
    s_addk_i32 m0, 1056
    s_addk_i32 s73, 512
    buffer_load_dwordx4 v241, s[44:47], s73 offen nt lds
    s_addk_i32 m0, 1056
    s_addk_i32 s73, 512
    buffer_load_dwordx4 v241, s[44:47], s73 offen nt lds
    s_addk_i32 m0, 1056
    s_addk_i32 s73, 512
    buffer_load_dwordx4 v241, s[44:47], s73 offen nt lds
    s_addk_i32 m0, 1056
    s_addk_i32 s73, 512
    buffer_load_dwordx4 v241, s[44:47], s73 offen nt lds
    s_addk_i32 m0, 1056
    s_addk_i32 s73, 512
    buffer_load_dwordx4 v241, s[44:47], s73 offen nt lds
    v_and_b32 v155, 15, v240
    v_mov_b32 v136, 0
    v_cmp_eq_u32 vcc, 0, v155
    v_mov_b32 v156, 0x3f80
    s_nop 0
    v_cndmask_b32 v136, v136, v156, vcc
    v_cmp_eq_u32 vcc, 1, v155
    v_mov_b32 v156, 0x3f800000
    s_nop 0
    v_cndmask_b32 v136, v136, v156, vcc
    v_mov_b32 v137, 0
    v_cmp_eq_u32 vcc, 2, v155
    v_mov_b32 v156, 0x3f80
    s_nop 0
    v_cndmask_b32 v137, v137, v156, vcc
    v_cmp_eq_u32 vcc, 3, v155
    v_mov_b32 v156, 0x3f800000
    s_nop 0
    v_cndmask_b32 v137, v137, v156, vcc
    v_mov_b32 v138, 0
    v_cmp_eq_u32 vcc, 4, v155
    v_mov_b32 v156, 0x3f80
    s_nop 0
    v_cndmask_b32 v138, v138, v156, vcc
    v_cmp_eq_u32 vcc, 5, v155
    v_mov_b32 v156, 0x3f800000
    s_nop 0
    v_cndmask_b32 v138, v138, v156, vcc
    v_mov_b32 v139, 0
    v_cmp_eq_u32 vcc, 6, v155
    v_mov_b32 v156, 0x3f80
    s_nop 0
    v_cndmask_b32 v139, v139, v156, vcc
    v_cmp_eq_u32 vcc, 7, v155
    v_mov_b32 v156, 0x3f800000
    s_nop 0
    v_cndmask_b32 v139, v139, v156, vcc
    v_mov_b32 v140, 0
    v_cmp_eq_u32 vcc, 8, v155
    v_mov_b32 v156, 0x3f80
    s_nop 0
    v_cndmask_b32 v140, v140, v156, vcc
    v_cmp_eq_u32 vcc, 9, v155
    v_mov_b32 v156, 0x3f800000
    s_nop 0
    v_cndmask_b32 v140, v140, v156, vcc
    v_mov_b32 v141, 0
    v_cmp_eq_u32 vcc, 10, v155
    v_mov_b32 v156, 0x3f80
    s_nop 0
    v_cndmask_b32 v141, v141, v156, vcc
    v_cmp_eq_u32 vcc, 11, v155
    v_mov_b32 v156, 0x3f800000
    s_nop 0
    v_cndmask_b32 v141, v141, v156, vcc
    v_mov_b32 v142, 0
    v_cmp_eq_u32 vcc, 12, v155
    v_mov_b32 v156, 0x3f80
    s_nop 0
    v_cndmask_b32 v142, v142, v156, vcc
    v_cmp_eq_u32 vcc, 13, v155
    v_mov_b32 v156, 0x3f800000
    s_nop 0
    v_cndmask_b32 v142, v142, v156, vcc
    v_mov_b32 v143, 0
    v_cmp_eq_u32 vcc, 14, v155
    v_mov_b32 v156, 0x3f80
    s_nop 0
    v_cndmask_b32 v143, v143, v156, vcc
    v_cmp_eq_u32 vcc, 15, v155
    v_mov_b32 v156, 0x3f800000
    s_nop 0
    v_cndmask_b32 v143, v143, v156, vcc
    v_lshrrev_b32 v156, 4, v240
    v_mul_u32_u24 v144, 0x31000, v156
    v_lshl_add_u32 v144, v155, 4, v144
    v_mul_u32_u24 v154, 1792, v155
    v_and_b32 v155, 1, v156
    v_lshl_add_u32 v154, v155, 5, v154
    v_lshrrev_b32 v155, 1, v156
    v_lshl_add_u32 v154, v155, 7, v154
    v_and_b32 v155, 32, v240
    v_lshlrev_b32 v155, 2, v155
    v_sub_u32 v154, v154, v155
    s_mul_i32 s29, s26, 7
    v_cmp_le_u32 vcc, 32, v240
    s_add_u32 s30, s29, 0
    s_lshr_b32 s13, s30, 3
    s_mul_i32 s13, s13, 28672
    s_and_b32 s71, s30, 3
    s_lshl_b32 s71, s71, 3
    s_add_u32 s13, s13, s71
    s_and_b32 s71, s30, 4
    s_lshl_b32 s71, s71, 4
    s_add_u32 s13, s13, s71
    s_add_u32 s30, s29, 1
    s_lshr_b32 s14, s30, 3
    s_mul_i32 s14, s14, 28672
    s_and_b32 s71, s30, 3
    s_lshl_b32 s71, s71, 3
    s_add_u32 s14, s14, s71
    s_and_b32 s71, s30, 4
    s_lshl_b32 s71, s71, 4
    s_add_u32 s14, s14, s71
    v_mov_b32 v155, s13
    v_mov_b32 v156, s14
    v_cndmask_b32 v155, v155, v156, vcc
    v_add_u32 v145, v154, v155
    s_add_u32 s30, s29, 2
    s_lshr_b32 s13, s30, 3
    s_mul_i32 s13, s13, 28672
    s_and_b32 s71, s30, 3
    s_lshl_b32 s71, s71, 3
    s_add_u32 s13, s13, s71
    s_and_b32 s71, s30, 4
    s_lshl_b32 s71, s71, 4
    s_add_u32 s13, s13, s71
    s_add_u32 s30, s29, 3
    s_lshr_b32 s14, s30, 3
    s_mul_i32 s14, s14, 28672
    s_and_b32 s71, s30, 3
    s_lshl_b32 s71, s71, 3
    s_add_u32 s14, s14, s71
    s_and_b32 s71, s30, 4
    s_lshl_b32 s71, s71, 4
    s_add_u32 s14, s14, s71
    v_mov_b32 v155, s13
    v_mov_b32 v156, s14
    v_cndmask_b32 v155, v155, v156, vcc
    v_add_u32 v146, v154, v155
    s_add_u32 s30, s29, 4
    s_lshr_b32 s13, s30, 3
    s_mul_i32 s13, s13, 28672
    s_and_b32 s71, s30, 3
    s_lshl_b32 s71, s71, 3
    s_add_u32 s13, s13, s71
    s_and_b32 s71, s30, 4
    s_lshl_b32 s71, s71, 4
    s_add_u32 s13, s13, s71
    s_add_u32 s30, s29, 5
    s_lshr_b32 s14, s30, 3
    s_mul_i32 s14, s14, 28672
    s_and_b32 s71, s30, 3
    s_lshl_b32 s71, s71, 3
    s_add_u32 s14, s14, s71
    s_and_b32 s71, s30, 4
    s_lshl_b32 s71, s71, 4
    s_add_u32 s14, s14, s71
    v_mov_b32 v155, s13
    v_mov_b32 v156, s14
    v_cndmask_b32 v155, v155, v156, vcc
    v_add_u32 v147, v154, v155
    s_add_u32 s30, s29, 6
    s_lshr_b32 s13, s30, 3
    s_mul_i32 s13, s13, 28672
    s_and_b32 s71, s30, 3
    s_lshl_b32 s71, s71, 3
    s_add_u32 s13, s13, s71
    s_and_b32 s71, s30, 4
    s_lshl_b32 s71, s71, 4
    s_add_u32 s13, s13, s71
    s_mov_b32 s14, 0x10000000
    v_mov_b32 v155, s13
    v_mov_b32 v156, s14
    v_cndmask_b32 v155, v155, v156, vcc
    v_add_u32 v148, v154, v155
    s_mul_i32 s9, s26, 1792
    s_add_u32 s9, s9, 0
    s_mul_i32 s10, s26, 1792
    s_add_u32 s10, s10, 802816
    s_mul_i32 s11, s26, 1792
    s_add_u32 s11, s11, 1605632
    s_mul_i32 s12, s26, 1792
    s_add_u32 s12, s12, 2408448
    s_lshr_b32 s13, s29, 4
    s_lshl_b32 s13, s13, 7
    s_add_u32 s14, s29, 6
    s_lshr_b32 s14, s14, 4
    s_lshl_b32 s14, s14, 7
    v_mov_b32 v155, s13
    v_mov_b32 v156, s14
    v_cndmask_b32 v155, v155, v156, vcc
    v_cmp_gt_u32 vcc, 16, v240
    v_mov_b32 v156, 1152
    s_nop 0
    v_cndmask_b32 v155, v155, v156, vcc
    v_and_b32 v149, 15, v240
    v_lshl_add_u32 v149, v149, 2, v155
    v_lshlrev_b32 v151, 16, v240
    s_lshl_b32 s71, s26, 2
    s_add_u32 s71, s71, 1152
    v_add_u32 v151, s71, v151
    s_mov_b32 s20, 0xffff
    s_mov_b32 s21, 0
    s_mov_b32 s22, 0xffff0000
    s_mov_b32 s23, -1
    s_waitcnt vmcnt(46)
    s_barrier
    s_addk_i32 m0, 1056
    s_addk_i32 s73, 512
    buffer_load_dwordx4 v241, s[44:47], s73 offen nt lds
    s_addk_i32 m0, 1056
    s_addk_i32 s73, 512
    buffer_load_dwordx4 v241, s[44:47], s73 offen nt lds
    s_mov_b32 m0, 84480
    s_mov_b32 s73, 114688
    buffer_load_dwordx4 v241, s[48:51], s73 offen nt lds
    s_addk_i32 m0, 1056
    s_addk_i32 s73, 512
    buffer_load_dwordx4 v241, s[48:51], s73 offen nt lds
    s_addk_i32 m0, 1056
    s_addk_i32 s73, 512
    buffer_load_dwordx4 v241, s[48:51], s73 offen nt lds
    s_addk_i32 m0, 1056
    s_addk_i32 s73, 512
    buffer_load_dwordx4 v241, s[48:51], s73 offen nt lds
    s_addk_i32 m0, 1056
    s_addk_i32 s73, 512
    buffer_load_dwordx4 v241, s[48:51], s73 offen nt lds
    s_addk_i32 m0, 1056
    s_addk_i32 s73, 512
    buffer_load_dwordx4 v241, s[48:51], s73 offen nt lds
    s_addk_i32 m0, 1056
    s_addk_i32 s73, 512
    buffer_load_dwordx4 v241, s[48:51], s73 offen nt lds
    s_addk_i32 m0, 1056
    s_addk_i32 s73, 512
    buffer_load_dwordx4 v241, s[48:51], s73 offen nt lds
    s_addk_i32 m0, 1056
    s_addk_i32 s73, 512
    buffer_load_dwordx4 v241, s[48:51], s73 offen nt lds
    s_addk_i32 m0, 1056
    s_addk_i32 s73, 512
    buffer_load_dwordx4 v241, s[48:51], s73 offen nt lds
    s_addk_i32 m0, 1056
    s_addk_i32 s73, 512
    buffer_load_dwordx4 v241, s[48:51], s73 offen nt lds
    s_addk_i32 m0, 1056
    s_addk_i32 s73, 512
    buffer_load_dwordx4 v241, s[48:51], s73 offen nt lds
    s_addk_i32 m0, 1056
    s_addk_i32 s73, 512
    buffer_load_dwordx4 v241, s[48:51], s73 offen nt lds
    s_addk_i32 m0, 1056
    s_addk_i32 s73, 512
    buffer_load_dwordx4 v241, s[48:51], s73 offen nt lds
    s_addk_i32 m0, 1056
    s_addk_i32 s73, 512
    buffer_load_dwordx4 v241, s[48:51], s73 offen nt lds
    s_waitcnt vmcnt(55)
    s_addk_i32 m0, 1056
    s_addk_i32 s73, 512
    buffer_load_dwordx4 v241, s[48:51], s73 offen nt lds
    s_mov_b32 m0, 101376
    s_mov_b32 s73, 147456
    buffer_load_dwordx4 v241, s[44:47], s73 offen nt lds
    s_addk_i32 m0, 1056
    s_addk_i32 s73, 512
    buffer_load_dwordx4 v241, s[44:47], s73 offen nt lds
    s_addk_i32 m0, 1056
    s_addk_i32 s73, 512
    buffer_load_dwordx4 v241, s[44:47], s73 offen nt lds
    s_addk_i32 m0, 1056
    s_addk_i32 s73, 512
    buffer_load_dwordx4 v241, s[44:47], s73 offen nt lds
    s_addk_i32 m0, 1056
    s_addk_i32 s73, 512
    buffer_load_dwordx4 v241, s[44:47], s73 offen nt lds
    s_addk_i32 m0, 1056
    s_addk_i32 s73, 512
    buffer_load_dwordx4 v241, s[44:47], s73 offen nt lds
    s_addk_i32 m0, 1056
    s_addk_i32 s73, 512
    buffer_load_dwordx4 v241, s[44:47], s73 offen nt lds
    s_waitcnt vmcnt(61)
    s_addk_i32 m0, 1056
    s_addk_i32 s73, 512
    buffer_load_dwordx4 v241, s[44:47], s73 offen nt lds
    s_addk_i32 m0, 1056
    s_addk_i32 s73, 512
    buffer_load_dwordx4 v241, s[44:47], s73 offen nt lds
    s_waitcnt vmcnt(41)
    s_barrier
    s_addk_i32 m0, 1056
    s_addk_i32 s73, 512
    buffer_load_dwordx4 v241, s[44:47], s73 offen nt lds
    s_addk_i32 m0, 1056
    s_addk_i32 s73, 512
    buffer_load_dwordx4 v241, s[44:47], s73 offen nt lds
    s_addk_i32 m0, 1056
    s_addk_i32 s73, 512
    buffer_load_dwordx4 v241, s[44:47], s73 offen nt lds
    s_addk_i32 m0, 1056
    s_addk_i32 s73, 512
    buffer_load_dwordx4 v241, s[44:47], s73 offen nt lds
    s_addk_i32 m0, 1056
    s_addk_i32 s73, 512
    buffer_load_dwordx4 v241, s[44:47], s73 offen nt lds
    s_addk_i32 m0, 1056
    s_addk_i32 s73, 512
    buffer_load_dwordx4 v241, s[44:47], s73 offen nt lds
    s_addk_i32 m0, 1056
    s_addk_i32 s73, 512
    buffer_load_dwordx4 v241, s[44:47], s73 offen nt lds
    s_mov_b32 m0, 118272
    s_mov_b32 s73, 131072
    buffer_load_dwordx4 v241, s[48:51], s73 offen nt lds
    s_addk_i32 m0, 1056
    s_addk_i32 s73, 512
    buffer_load_dwordx4 v241, s[48:51], s73 offen nt lds
    s_addk_i32 m0, 1056
    s_addk_i32 s73, 512
    buffer_load_dwordx4 v241, s[48:51], s73 offen nt lds
    s_addk_i32 m0, 1056
    s_addk_i32 s73, 512
    buffer_load_dwordx4 v241, s[48:51], s73 offen nt lds
    s_addk_i32 m0, 1056
    s_addk_i32 s73, 512
    buffer_load_dwordx4 v241, s[48:51], s73 offen nt lds
    s_addk_i32 m0, 1056
    s_addk_i32 s73, 512
    buffer_load_dwordx4 v241, s[48:51], s73 offen nt lds
    s_addk_i32 m0, 1056
    s_addk_i32 s73, 512
    buffer_load_dwordx4 v241, s[48:51], s73 offen nt lds
    s_addk_i32 m0, 1056
    s_addk_i32 s73, 512
    buffer_load_dwordx4 v241, s[48:51], s73 offen nt lds
    s_addk_i32 m0, 1056
    s_addk_i32 s73, 512
    buffer_load_dwordx4 v241, s[48:51], s73 offen nt lds
    s_addk_i32 m0, 1056
    s_addk_i32 s73, 512
    buffer_load_dwordx4 v241, s[48:51], s73 offen nt lds
    s_addk_i32 m0, 1056
    s_addk_i32 s73, 512
    buffer_load_dwordx4 v241, s[48:51], s73 offen nt lds
    s_addk_i32 m0, 1056
    s_addk_i32 s73, 512
    buffer_load_dwordx4 v241, s[48:51], s73 offen nt lds
    s_addk_i32 m0, 1056
    s_addk_i32 s73, 512
    buffer_load_dwordx4 v241, s[48:51], s73 offen nt lds
    s_addk_i32 m0, 1056
    s_addk_i32 s73, 512
    buffer_load_dwordx4 v241, s[48:51], s73 offen nt lds
    s_addk_i32 m0, 1056
    s_addk_i32 s73, 512
    buffer_load_dwordx4 v241, s[48:51], s73 offen nt lds
    s_waitcnt vmcnt(58)
    s_addk_i32 m0, 1056
    s_addk_i32 s73, 512
    buffer_load_dwordx4 v241, s[48:51], s73 offen nt lds
    s_mov_b32 m0, 135168
    s_mov_b32 s73, 163840
    buffer_load_dwordx4 v241, s[44:47], s73 offen nt lds
    s_addk_i32 m0, 1056
    s_addk_i32 s73, 512
    buffer_load_dwordx4 v241, s[44:47], s73 offen nt lds
    s_addk_i32 m0, 1056
    s_addk_i32 s73, 512
    buffer_load_dwordx4 v241, s[44:47], s73 offen nt lds
    s_addk_i32 m0, 1056
    s_addk_i32 s73, 512
    buffer_load_dwordx4 v241, s[44:47], s73 offen nt lds
    s_waitcnt vmcnt(36)
    s_barrier
    s_addk_i32 m0, 1056
    s_addk_i32 s73, 512
    buffer_load_dwordx4 v241, s[44:47], s73 offen nt lds
    s_addk_i32 m0, 1056
    s_addk_i32 s73, 512
    buffer_load_dwordx4 v241, s[44:47], s73 offen nt lds
    s_addk_i32 m0, 1056
    s_addk_i32 s73, 512
    buffer_load_dwordx4 v241, s[44:47], s73 offen nt lds
    s_addk_i32 m0, 1056
    s_addk_i32 s73, 512
    buffer_load_dwordx4 v241, s[44:47], s73 offen nt lds
    s_addk_i32 m0, 1056
    s_addk_i32 s73, 512
    buffer_load_dwordx4 v241, s[44:47], s73 offen nt lds
    s_addk_i32 m0, 1056
    s_addk_i32 s73, 512
    buffer_load_dwordx4 v241, s[44:47], s73 offen nt lds
    s_addk_i32 m0, 1056
    s_addk_i32 s73, 512
    buffer_load_dwordx4 v241, s[44:47], s73 offen nt lds
    s_addk_i32 m0, 1056
    s_addk_i32 s73, 512
    buffer_load_dwordx4 v241, s[44:47], s73 offen nt lds
    s_addk_i32 m0, 1056
    s_addk_i32 s73, 512
    buffer_load_dwordx4 v241, s[44:47], s73 offen nt lds
    s_addk_i32 m0, 1056
    s_addk_i32 s73, 512
    buffer_load_dwordx4 v241, s[44:47], s73 offen nt lds
    s_addk_i32 m0, 1056
    s_addk_i32 s73, 512
    buffer_load_dwordx4 v241, s[44:47], s73 offen nt lds
    s_addk_i32 m0, 1056
    s_addk_i32 s73, 512
    buffer_load_dwordx4 v241, s[44:47], s73 offen nt lds
    s_mov_b32 m0, 0
    s_mov_b32 s73, 147456
    buffer_load_dwordx4 v241, s[48:51], s73 offen nt lds
    s_addk_i32 m0, 1056
    s_addk_i32 s73, 512
    buffer_load_dwordx4 v241, s[48:51], s73 offen nt lds
    s_addk_i32 m0, 1056
    s_addk_i32 s73, 512
    buffer_load_dwordx4 v241, s[48:51], s73 offen nt lds
    s_addk_i32 m0, 1056
    s_addk_i32 s73, 512
    buffer_load_dwordx4 v241, s[48:51], s73 offen nt lds
    s_addk_i32 m0, 1056
    s_addk_i32 s73, 512
    buffer_load_dwordx4 v241, s[48:51], s73 offen nt lds
    s_addk_i32 m0, 1056
    s_addk_i32 s73, 512
    buffer_load_dwordx4 v241, s[48:51], s73 offen nt lds
    s_addk_i32 m0, 1056
    s_addk_i32 s73, 512
    buffer_load_dwordx4 v241, s[48:51], s73 offen nt lds
    s_addk_i32 m0, 1056
    s_addk_i32 s73, 512
    buffer_load_dwordx4 v241, s[48:51], s73 offen nt lds
    s_addk_i32 m0, 1056
    s_addk_i32 s73, 512
    buffer_load_dwordx4 v241, s[48:51], s73 offen nt lds
    s_addk_i32 m0, 1056
    s_addk_i32 s73, 512
    buffer_load_dwordx4 v241, s[48:51], s73 offen nt lds
    s_addk_i32 m0, 1056
    s_addk_i32 s73, 512
    buffer_load_dwordx4 v241, s[48:51], s73 offen nt lds
    s_addk_i32 m0, 1056
    s_addk_i32 s73, 512
    buffer_load_dwordx4 v241, s[48:51], s73 offen nt lds
    s_addk_i32 m0, 1056
    s_addk_i32 s73, 512
    buffer_load_dwordx4 v241, s[48:51], s73 offen nt lds
    s_addk_i32 m0, 1056
    s_addk_i32 s73, 512
    buffer_load_dwordx4 v241, s[48:51], s73 offen nt lds
    s_addk_i32 m0, 1056
    s_addk_i32 s73, 512
    buffer_load_dwordx4 v241, s[48:51], s73 offen nt lds
    s_waitcnt vmcnt(31)
    s_barrier
    s_addk_i32 m0, 1056
    s_addk_i32 s73, 512
    buffer_load_dwordx4 v241, s[48:51], s73 offen nt lds
    s_mov_b32 m0, 16896
    s_mov_b32 s73, 180224
    buffer_load_dwordx4 v241, s[44:47], s73 offen nt lds
    s_addk_i32 m0, 1056
    s_addk_i32 s73, 512
    buffer_load_dwordx4 v241, s[44:47], s73 offen nt lds
    s_addk_i32 m0, 1056
    s_addk_i32 s73, 512
    buffer_load_dwordx4 v241, s[44:47], s73 offen nt lds
    s_addk_i32 m0, 1056
    s_addk_i32 s73, 512
    buffer_load_dwordx4 v241, s[44:47], s73 offen nt lds
    s_addk_i32 m0, 1056
    s_addk_i32 s73, 512
    buffer_load_dwordx4 v241, s[44:47], s73 offen nt lds
    s_addk_i32 m0, 1056
    s_addk_i32 s73, 512
    buffer_load_dwordx4 v241, s[44:47], s73 offen nt lds
    s_addk_i32 m0, 1056
    s_addk_i32 s73, 512
    buffer_load_dwordx4 v241, s[44:47], s73 offen nt lds
    s_addk_i32 m0, 1056
    s_addk_i32 s73, 512
    buffer_load_dwordx4 v241, s[44:47], s73 offen nt lds
    s_addk_i32 m0, 1056
    s_addk_i32 s73, 512
    buffer_load_dwordx4 v241, s[44:47], s73 offen nt lds
    s_addk_i32 m0, 1056
    s_addk_i32 s73, 512
    buffer_load_dwordx4 v241, s[44:47], s73 offen nt lds
    s_addk_i32 m0, 1056
    s_addk_i32 s73, 512
    buffer_load_dwordx4 v241, s[44:47], s73 offen nt lds
    s_addk_i32 m0, 1056
    s_addk_i32 s73, 512
    buffer_load_dwordx4 v241, s[44:47], s73 offen nt lds
    s_addk_i32 m0, 1056
    s_addk_i32 s73, 512
    buffer_load_dwordx4 v241, s[44:47], s73 offen nt lds
    s_addk_i32 m0, 1056
    s_addk_i32 s73, 512
    buffer_load_dwordx4 v241, s[44:47], s73 offen nt lds
    s_addk_i32 m0, 1056
    s_addk_i32 s73, 512
    buffer_load_dwordx4 v241, s[44:47], s73 offen nt lds
    s_addk_i32 m0, 1056
    s_addk_i32 s73, 512
    buffer_load_dwordx4 v241, s[44:47], s73 offen nt lds
    s_mov_b32 m0, 33792
    s_mov_b32 s73, 163840
    buffer_load_dwordx4 v241, s[48:51], s73 offen nt lds
    s_addk_i32 m0, 1056
    s_addk_i32 s73, 512
    buffer_load_dwordx4 v241, s[48:51], s73 offen nt lds
    s_addk_i32 m0, 1056
    s_addk_i32 s73, 512
    buffer_load_dwordx4 v241, s[48:51], s73 offen nt lds
    s_addk_i32 m0, 1056
    s_addk_i32 s73, 512
    buffer_load_dwordx4 v241, s[48:51], s73 offen nt lds
    s_addk_i32 m0, 1056
    s_addk_i32 s73, 512
    buffer_load_dwordx4 v241, s[48:51], s73 offen nt lds
    s_addk_i32 m0, 1056
    s_addk_i32 s73, 512
    buffer_load_dwordx4 v241, s[48:51], s73 offen nt lds
    s_addk_i32 m0, 1056
    s_addk_i32 s73, 512
    buffer_load_dwordx4 v241, s[48:51], s73 offen nt lds
    s_addk_i32 m0, 1056
    s_addk_i32 s73, 512
    buffer_load_dwordx4 v241, s[48:51], s73 offen nt lds
    s_addk_i32 m0, 1056
    s_addk_i32 s73, 512
    buffer_load_dwordx4 v241, s[48:51], s73 offen nt lds
    s_addk_i32 m0, 1056
    s_addk_i32 s73, 512
    buffer_load_dwordx4 v241, s[48:51], s73 offen nt lds
    buffer_load_dword v159, v153, s[92:95], 0 offen sc1
    s_waitcnt vmcnt(27)
    s_barrier
    s_addk_i32 m0, 1056
    s_addk_i32 s73, 512
    buffer_load_dwordx4 v241, s[48:51], s73 offen nt lds
    s_addk_i32 m0, 1056
    s_addk_i32 s73, 512
    buffer_load_dwordx4 v241, s[48:51], s73 offen nt lds
    s_addk_i32 m0, 1056
    s_addk_i32 s73, 512
    buffer_load_dwordx4 v241, s[48:51], s73 offen nt lds
    s_addk_i32 m0, 1056
    s_addk_i32 s73, 512
    buffer_load_dwordx4 v241, s[48:51], s73 offen nt lds
    s_addk_i32 m0, 1056
    s_addk_i32 s73, 512
    buffer_load_dwordx4 v241, s[48:51], s73 offen nt lds
    s_addk_i32 m0, 1056
    s_addk_i32 s73, 512
    buffer_load_dwordx4 v241, s[48:51], s73 offen nt lds
    s_mov_b32 m0, 50688
    s_mov_b32 s73, 196608
    buffer_load_dwordx4 v241, s[44:47], s73 offen nt lds
    s_addk_i32 m0, 1056
    s_addk_i32 s73, 512
    buffer_load_dwordx4 v241, s[44:47], s73 offen nt lds
    s_addk_i32 m0, 1056
    s_addk_i32 s73, 512
    buffer_load_dwordx4 v241, s[44:47], s73 offen nt lds
    s_addk_i32 m0, 1056
    s_addk_i32 s73, 512
    buffer_load_dwordx4 v241, s[44:47], s73 offen nt lds
    s_addk_i32 m0, 1056
    s_addk_i32 s73, 512
    buffer_load_dwordx4 v241, s[44:47], s73 offen nt lds
    s_addk_i32 m0, 1056
    s_addk_i32 s73, 512
    buffer_load_dwordx4 v241, s[44:47], s73 offen nt lds
    s_addk_i32 m0, 1056
    s_addk_i32 s73, 512
    buffer_load_dwordx4 v241, s[44:47], s73 offen nt lds
    s_addk_i32 m0, 1056
    s_addk_i32 s73, 512
    buffer_load_dwordx4 v241, s[44:47], s73 offen nt lds
    s_addk_i32 m0, 1056
    s_addk_i32 s73, 512
    buffer_load_dwordx4 v241, s[44:47], s73 offen nt lds
    s_addk_i32 m0, 1056
    s_addk_i32 s73, 512
    buffer_load_dwordx4 v241, s[44:47], s73 offen nt lds
    s_addk_i32 m0, 1056
    s_addk_i32 s73, 512
    buffer_load_dwordx4 v241, s[44:47], s73 offen nt lds
    s_addk_i32 m0, 1056
    s_addk_i32 s73, 512
    buffer_load_dwordx4 v241, s[44:47], s73 offen nt lds
    s_addk_i32 m0, 1056
    s_addk_i32 s73, 512
    buffer_load_dwordx4 v241, s[44:47], s73 offen nt lds
    s_addk_i32 m0, 1056
    s_addk_i32 s73, 512
    buffer_load_dwordx4 v241, s[44:47], s73 offen nt lds
    s_addk_i32 m0, 1056
    s_addk_i32 s73, 512
    buffer_load_dwordx4 v241, s[44:47], s73 offen nt lds
    s_addk_i32 m0, 1056
    s_addk_i32 s73, 512
    buffer_load_dwordx4 v241, s[44:47], s73 offen nt lds
    s_mov_b32 m0, 67584
    s_mov_b32 s73, 180224
    buffer_load_dwordx4 v241, s[48:51], s73 offen nt lds
    s_addk_i32 m0, 1056
    s_addk_i32 s73, 512
    buffer_load_dwordx4 v241, s[48:51], s73 offen nt lds
    s_addk_i32 m0, 1056
    s_addk_i32 s73, 512
    buffer_load_dwordx4 v241, s[48:51], s73 offen nt lds
    s_addk_i32 m0, 1056
    s_addk_i32 s73, 512
    buffer_load_dwordx4 v241, s[48:51], s73 offen nt lds
    s_addk_i32 m0, 1056
    s_addk_i32 s73, 512
    buffer_load_dwordx4 v241, s[48:51], s73 offen nt lds
    s_waitcnt vmcnt(21)
    s_barrier
    s_addk_i32 m0, 1056
    s_addk_i32 s73, 512
    buffer_load_dwordx4 v241, s[48:51], s73 offen nt lds
    s_addk_i32 m0, 1056
    s_addk_i32 s73, 512
    buffer_load_dwordx4 v241, s[48:51], s73 offen nt lds
    s_addk_i32 m0, 1056
    s_addk_i32 s73, 512
    buffer_load_dwordx4 v241, s[48:51], s73 offen nt lds
    s_addk_i32 m0, 1056
    s_addk_i32 s73, 512
    buffer_load_dwordx4 v241, s[48:51], s73 offen nt lds
    s_addk_i32 m0, 1056
    s_addk_i32 s73, 512
    buffer_load_dwordx4 v241, s[48:51], s73 offen nt lds
    s_addk_i32 m0, 1056
    s_addk_i32 s73, 512
    buffer_load_dwordx4 v241, s[48:51], s73 offen nt lds
    s_addk_i32 m0, 1056
    s_addk_i32 s73, 512
    buffer_load_dwordx4 v241, s[48:51], s73 offen nt lds
    s_addk_i32 m0, 1056
    s_addk_i32 s73, 512
    buffer_load_dwordx4 v241, s[48:51], s73 offen nt lds
    s_addk_i32 m0, 1056
    s_addk_i32 s73, 512
    buffer_load_dwordx4 v241, s[48:51], s73 offen nt lds
    s_addk_i32 m0, 1056
    s_addk_i32 s73, 512
    buffer_load_dwordx4 v241, s[48:51], s73 offen nt lds
    s_addk_i32 m0, 1056
    s_addk_i32 s73, 512
    buffer_load_dwordx4 v241, s[48:51], s73 offen nt lds
    s_mov_b32 m0, 84480
    s_mov_b32 s73, 212992
    buffer_load_dwordx4 v241, s[44:47], s73 offen nt lds
    s_addk_i32 m0, 1056
    s_addk_i32 s73, 512
    buffer_load_dwordx4 v241, s[44:47], s73 offen nt lds
    s_addk_i32 m0, 1056
    s_addk_i32 s73, 512
    buffer_load_dwordx4 v241, s[44:47], s73 offen nt lds
    s_addk_i32 m0, 1056
    s_addk_i32 s73, 512
    buffer_load_dwordx4 v241, s[44:47], s73 offen nt lds
    s_addk_i32 m0, 1056
    s_addk_i32 s73, 512
    buffer_load_dwordx4 v241, s[44:47], s73 offen nt lds
    s_addk_i32 m0, 1056
    s_addk_i32 s73, 512
    buffer_load_dwordx4 v241, s[44:47], s73 offen nt lds
    s_addk_i32 m0, 1056
    s_addk_i32 s73, 512
    buffer_load_dwordx4 v241, s[44:47], s73 offen nt lds
    s_addk_i32 m0, 1056
    s_addk_i32 s73, 512
    buffer_load_dwordx4 v241, s[44:47], s73 offen nt lds
    s_addk_i32 m0, 1056
    s_addk_i32 s73, 512
    buffer_load_dwordx4 v241, s[44:47], s73 offen nt lds
    s_addk_i32 m0, 1056
    s_addk_i32 s73, 512
    buffer_load_dwordx4 v241, s[44:47], s73 offen nt lds
    s_addk_i32 m0, 1056
    s_addk_i32 s73, 512
    buffer_load_dwordx4 v241, s[44:47], s73 offen nt lds
    s_addk_i32 m0, 1056
    s_addk_i32 s73, 512
    buffer_load_dwordx4 v241, s[44:47], s73 offen nt lds
    s_addk_i32 m0, 1056
    s_addk_i32 s73, 512
    buffer_load_dwordx4 v241, s[44:47], s73 offen nt lds
    s_addk_i32 m0, 1056
    s_addk_i32 s73, 512
    buffer_load_dwordx4 v241, s[44:47], s73 offen nt lds
    s_addk_i32 m0, 1056
    s_addk_i32 s73, 512
    buffer_load_dwordx4 v241, s[44:47], s73 offen nt lds
    s_addk_i32 m0, 1056
    s_addk_i32 s73, 512
    buffer_load_dwordx4 v241, s[44:47], s73 offen nt lds
    s_waitcnt vmcnt(16)
    s_barrier
    s_mov_b32 m0, 101376
    s_mov_b32 s73, 196608
    buffer_load_dwordx4 v241, s[48:51], s73 offen nt lds
    s_addk_i32 m0, 1056
    s_addk_i32 s73, 512
    buffer_load_dwordx4 v241, s[48:51], s73 offen nt lds
    s_addk_i32 m0, 1056
    s_addk_i32 s73, 512
    buffer_load_dwordx4 v241, s[48:51], s73 offen nt lds
    s_addk_i32 m0, 1056
    s_addk_i32 s73, 512
    buffer_load_dwordx4 v241, s[48:51], s73 offen nt lds
    s_addk_i32 m0, 1056
    s_addk_i32 s73, 512
    buffer_load_dwordx4 v241, s[48:51], s73 offen nt lds
    s_addk_i32 m0, 1056
    s_addk_i32 s73, 512
    buffer_load_dwordx4 v241, s[48:51], s73 offen nt lds
    s_addk_i32 m0, 1056
    s_addk_i32 s73, 512
    buffer_load_dwordx4 v241, s[48:51], s73 offen nt lds
    s_addk_i32 m0, 1056
    s_addk_i32 s73, 512
    buffer_load_dwordx4 v241, s[48:51], s73 offen nt lds
    s_addk_i32 m0, 1056
    s_addk_i32 s73, 512
    buffer_load_dwordx4 v241, s[48:51], s73 offen nt lds
    s_addk_i32 m0, 1056
    s_addk_i32 s73, 512
    buffer_load_dwordx4 v241, s[48:51], s73 offen nt lds
    s_addk_i32 m0, 1056
    s_addk_i32 s73, 512
    buffer_load_dwordx4 v241, s[48:51], s73 offen nt lds
    s_addk_i32 m0, 1056
    s_addk_i32 s73, 512
    buffer_load_dwordx4 v241, s[48:51], s73 offen nt lds
    s_addk_i32 m0, 1056
    s_addk_i32 s73, 512
    buffer_load_dwordx4 v241, s[48:51], s73 offen nt lds
    s_addk_i32 m0, 1056
    s_addk_i32 s73, 512
    buffer_load_dwordx4 v241, s[48:51], s73 offen nt lds
    s_addk_i32 m0, 1056
    s_addk_i32 s73, 512
    buffer_load_dwordx4 v241, s[48:51], s73 offen nt lds
    s_addk_i32 m0, 1056
    s_addk_i32 s73, 512
    buffer_load_dwordx4 v241, s[48:51], s73 offen nt lds
    s_mov_b32 m0, 118272
    s_mov_b32 s73, 229376
    buffer_load_dwordx4 v241, s[44:47], s73 offen nt lds
    s_addk_i32 m0, 1056
    s_addk_i32 s73, 512
    buffer_load_dwordx4 v241, s[44:47], s73 offen nt lds
    s_addk_i32 m0, 1056
    s_addk_i32 s73, 512
    buffer_load_dwordx4 v241, s[44:47], s73 offen nt lds
    s_addk_i32 m0, 1056
    s_addk_i32 s73, 512
    buffer_load_dwordx4 v241, s[44:47], s73 offen nt lds
    s_addk_i32 m0, 1056
    s_addk_i32 s73, 512
    buffer_load_dwordx4 v241, s[44:47], s73 offen nt lds
    s_addk_i32 m0, 1056
    s_addk_i32 s73, 512
    buffer_load_dwordx4 v241, s[44:47], s73 offen nt lds
    s_addk_i32 m0, 1056
    s_addk_i32 s73, 512
    buffer_load_dwordx4 v241, s[44:47], s73 offen nt lds
    s_addk_i32 m0, 1056
    s_addk_i32 s73, 512
    buffer_load_dwordx4 v241, s[44:47], s73 offen nt lds
    s_addk_i32 m0, 1056
    s_addk_i32 s73, 512
    buffer_load_dwordx4 v241, s[44:47], s73 offen nt lds
    s_addk_i32 m0, 1056
    s_addk_i32 s73, 512
    buffer_load_dwordx4 v241, s[44:47], s73 offen nt lds
    s_addk_i32 m0, 1056
    s_addk_i32 s73, 512
    buffer_load_dwordx4 v241, s[44:47], s73 offen nt lds
    s_waitcnt vmcnt(11)
    s_barrier
    s_addk_i32 m0, 1056
    s_addk_i32 s73, 512
    buffer_load_dwordx4 v241, s[44:47], s73 offen nt lds
    s_addk_i32 m0, 1056
    s_addk_i32 s73, 512
    buffer_load_dwordx4 v241, s[44:47], s73 offen nt lds
    s_addk_i32 m0, 1056
    s_addk_i32 s73, 512
    buffer_load_dwordx4 v241, s[44:47], s73 offen nt lds
    s_addk_i32 m0, 1056
    s_addk_i32 s73, 512
    buffer_load_dwordx4 v241, s[44:47], s73 offen nt lds
    s_addk_i32 m0, 1056
    s_addk_i32 s73, 512
    buffer_load_dwordx4 v241, s[44:47], s73 offen nt lds
    s_mov_b32 m0, 135168
    s_mov_b32 s73, 212992
    buffer_load_dwordx4 v241, s[48:51], s73 offen nt lds
    s_addk_i32 m0, 1056
    s_addk_i32 s73, 512
    buffer_load_dwordx4 v241, s[48:51], s73 offen nt lds
    s_addk_i32 m0, 1056
    s_addk_i32 s73, 512
    buffer_load_dwordx4 v241, s[48:51], s73 offen nt lds
    s_addk_i32 m0, 1056
    s_addk_i32 s73, 512
    buffer_load_dwordx4 v241, s[48:51], s73 offen nt lds
    s_addk_i32 m0, 1056
    s_addk_i32 s73, 512
    buffer_load_dwordx4 v241, s[48:51], s73 offen nt lds
    s_addk_i32 m0, 1056
    s_addk_i32 s73, 512
    buffer_load_dwordx4 v241, s[48:51], s73 offen nt lds
    s_addk_i32 m0, 1056
    s_addk_i32 s73, 512
    buffer_load_dwordx4 v241, s[48:51], s73 offen nt lds
    s_addk_i32 m0, 1056
    s_addk_i32 s73, 512
    buffer_load_dwordx4 v241, s[48:51], s73 offen nt lds
    s_addk_i32 m0, 1056
    s_addk_i32 s73, 512
    buffer_load_dwordx4 v241, s[48:51], s73 offen nt lds
    s_addk_i32 m0, 1056
    s_addk_i32 s73, 512
    buffer_load_dwordx4 v241, s[48:51], s73 offen nt lds
    s_addk_i32 m0, 1056
    s_addk_i32 s73, 512
    buffer_load_dwordx4 v241, s[48:51], s73 offen nt lds
    s_addk_i32 m0, 1056
    s_addk_i32 s73, 512
    buffer_load_dwordx4 v241, s[48:51], s73 offen nt lds
    s_addk_i32 m0, 1056
    s_addk_i32 s73, 512
    buffer_load_dwordx4 v241, s[48:51], s73 offen nt lds
    s_addk_i32 m0, 1056
    s_addk_i32 s73, 512
    buffer_load_dwordx4 v241, s[48:51], s73 offen nt lds
    s_addk_i32 m0, 1056
    s_addk_i32 s73, 512
    buffer_load_dwordx4 v241, s[48:51], s73 offen nt lds
    s_addk_i32 m0, 1056
    s_addk_i32 s73, 512
    buffer_load_dwordx4 v241, s[48:51], s73 offen nt lds
    s_mov_b32 m0, 0
    s_mov_b32 s73, 245760
    buffer_load_dwordx4 v241, s[44:47], s73 offen nt lds
    s_addk_i32 m0, 1056
    s_addk_i32 s73, 512
    buffer_load_dwordx4 v241, s[44:47], s73 offen nt lds
    s_addk_i32 m0, 1056
    s_addk_i32 s73, 512
    buffer_load_dwordx4 v241, s[44:47], s73 offen nt lds
    s_addk_i32 m0, 1056
    s_addk_i32 s73, 512
    buffer_load_dwordx4 v241, s[44:47], s73 offen nt lds
    s_addk_i32 m0, 1056
    s_addk_i32 s73, 512
    buffer_load_dwordx4 v241, s[44:47], s73 offen nt lds
    s_addk_i32 m0, 1056
    s_addk_i32 s73, 512
    buffer_load_dwordx4 v241, s[44:47], s73 offen nt lds
    v_cmp_eq_u32 vcc, s91, v159
    s_nop 1
    s_cmp_eq_u64 vcc, -1
    s_cselect_b32 s91, 1, 0
    v_mov_b32 v155, s91
    v_mov_b32 v156, 160000
    ds_write_b32 v156, v155
    s_waitcnt lgkmcnt(0)
    buffer_load_dword v246, v248, s[4:7], s8 offen
    s_waitcnt vmcnt(7)
    s_barrier
    s_addk_i32 m0, 1056
    s_addk_i32 s73, 512
    buffer_load_dwordx4 v241, s[44:47], s73 offen nt lds
    s_addk_i32 m0, 1056
    s_addk_i32 s73, 512
    buffer_load_dwordx4 v241, s[44:47], s73 offen nt lds
    s_addk_i32 m0, 1056
    s_addk_i32 s73, 512
    buffer_load_dwordx4 v241, s[44:47], s73 offen nt lds
    s_addk_i32 m0, 1056
    s_addk_i32 s73, 512
    buffer_load_dwordx4 v241, s[44:47], s73 offen nt lds
    s_addk_i32 m0, 1056
    s_addk_i32 s73, 512
    buffer_load_dwordx4 v241, s[44:47], s73 offen nt lds
    s_addk_i32 m0, 1056
    s_addk_i32 s73, 512
    buffer_load_dwordx4 v241, s[44:47], s73 offen nt lds
    s_addk_i32 m0, 1056
    s_addk_i32 s73, 512
    buffer_load_dwordx4 v241, s[44:47], s73 offen nt lds
    s_addk_i32 m0, 1056
    s_addk_i32 s73, 512
    buffer_load_dwordx4 v241, s[44:47], s73 offen nt lds
    s_addk_i32 m0, 1056
    s_addk_i32 s73, 512
    buffer_load_dwordx4 v241, s[44:47], s73 offen nt lds
    s_addk_i32 m0, 1056
    s_addk_i32 s73, 512
    buffer_load_dwordx4 v241, s[44:47], s73 offen nt lds
    s_mov_b32 m0, 16896
    s_mov_b32 s73, 229376
    buffer_load_dwordx4 v241, s[48:51], s73 offen nt lds
    s_addk_i32 m0, 1056
    s_addk_i32 s73, 512
    buffer_load_dwordx4 v241, s[48:51], s73 offen nt lds
    s_addk_i32 m0, 1056
    s_addk_i32 s73, 512
    buffer_load_dwordx4 v241, s[48:51], s73 offen nt lds
    s_addk_i32 m0, 1056
    s_addk_i32 s73, 512
    buffer_load_dwordx4 v241, s[48:51], s73 offen nt lds
    s_addk_i32 m0, 1056
    s_addk_i32 s73, 512
    buffer_load_dwordx4 v241, s[48:51], s73 offen nt lds
    s_addk_i32 m0, 1056
    s_addk_i32 s73, 512
    buffer_load_dwordx4 v241, s[48:51], s73 offen nt lds
    s_addk_i32 m0, 1056
    s_addk_i32 s73, 512
    buffer_load_dwordx4 v241, s[48:51], s73 offen nt lds
    s_addk_i32 m0, 1056
    s_addk_i32 s73, 512
    buffer_load_dwordx4 v241, s[48:51], s73 offen nt lds
    s_addk_i32 m0, 1056
    s_addk_i32 s73, 512
    buffer_load_dwordx4 v241, s[48:51], s73 offen nt lds
    s_addk_i32 m0, 1056
    s_addk_i32 s73, 512
    buffer_load_dwordx4 v241, s[48:51], s73 offen nt lds
    s_addk_i32 m0, 1056
    s_addk_i32 s73, 512
    buffer_load_dwordx4 v241, s[48:51], s73 offen nt lds
    s_addk_i32 m0, 1056
    s_addk_i32 s73, 512
    buffer_load_dwordx4 v241, s[48:51], s73 offen nt lds
    s_addk_i32 m0, 1056
    s_addk_i32 s73, 512
    buffer_load_dwordx4 v241, s[48:51], s73 offen nt lds
    s_addk_i32 m0, 1056
    s_addk_i32 s73, 512
    buffer_load_dwordx4 v241, s[48:51], s73 offen nt lds
    s_addk_i32 m0, 1056
    s_addk_i32 s73, 512
    buffer_load_dwordx4 v241, s[48:51], s73 offen nt lds
    s_addk_i32 m0, 1056
    s_addk_i32 s73, 512
    buffer_load_dwordx4 v241, s[48:51], s73 offen nt lds
    s_mov_b32 m0, 33792
    s_mov_b32 s73, 245760
    buffer_load_dwordx4 v241, s[48:51], s73 offen nt lds
    s_lshl_b32 s71, s26, 11
    v_lshlrev_b32 v155, 5, v240
    buffer_load_dword v246, v155, s[92:95], s71 offen
    s_waitcnt vmcnt(2)
    s_barrier
    s_addk_i32 m0, 1056
    s_addk_i32 s73, 512
    buffer_load_dwordx4 v241, s[48:51], s73 offen nt lds
    s_addk_i32 m0, 1056
    s_addk_i32 s73, 512
    buffer_load_dwordx4 v241, s[48:51], s73 offen nt lds
    s_addk_i32 m0, 1056
    s_addk_i32 s73, 512
    buffer_load_dwordx4 v241, s[48:51], s73 offen nt lds
    s_addk_i32 m0, 1056
    s_addk_i32 s73, 512
    buffer_load_dwordx4 v241, s[48:51], s73 offen nt lds
    s_addk_i32 m0, 1056
    s_addk_i32 s73, 512
    buffer_load_dwordx4 v241, s[48:51], s73 offen nt lds
    s_addk_i32 m0, 1056
    s_addk_i32 s73, 512
    buffer_load_dwordx4 v241, s[48:51], s73 offen nt lds
    s_addk_i32 m0, 1056
    s_addk_i32 s73, 512
    buffer_load_dwordx4 v241, s[48:51], s73 offen nt lds
    s_addk_i32 m0, 1056
    s_addk_i32 s73, 512
    buffer_load_dwordx4 v241, s[48:51], s73 offen nt lds
    s_addk_i32 m0, 1056
    s_addk_i32 s73, 512
    buffer_load_dwordx4 v241, s[48:51], s73 offen nt lds
    s_addk_i32 m0, 1056
    s_addk_i32 s73, 512
    buffer_load_dwordx4 v241, s[48:51], s73 offen nt lds
    s_addk_i32 m0, 1056
    s_addk_i32 s73, 512
    buffer_load_dwordx4 v241, s[48:51], s73 offen nt lds
    s_addk_i32 m0, 1056
    s_addk_i32 s73, 512
    buffer_load_dwordx4 v241, s[48:51], s73 offen nt lds
    s_addk_i32 m0, 1056
    s_addk_i32 s73, 512
    buffer_load_dwordx4 v241, s[48:51], s73 offen nt lds
    s_addk_i32 m0, 1056
    s_addk_i32 s73, 512
    buffer_load_dwordx4 v241, s[48:51], s73 offen nt lds
    s_addk_i32 m0, 1056
    s_addk_i32 s73, 512
    buffer_load_dwordx4 v241, s[48:51], s73 offen nt lds
    s_mov_b32 m0, 50688
    s_mov_b32 s73, 0
    buffer_load_dwordx4 v243, s[52:55], s73 offen lds
    s_addk_i32 m0, 1056
    s_addk_i32 s73, 896
    buffer_load_dwordx4 v243, s[52:55], s73 offen lds
    s_addk_i32 m0, 1056
    s_addk_i32 s73, 896
    buffer_load_dwordx4 v243, s[52:55], s73 offen lds
    s_addk_i32 m0, 1056
    s_addk_i32 s73, 896
    buffer_load_dwordx4 v243, s[52:55], s73 offen lds
    s_addk_i32 m0, 1056
    s_addk_i32 s73, 896
    buffer_load_dwordx4 v243, s[52:55], s73 offen lds
    s_addk_i32 m0, 1056
    s_addk_i32 s73, 896
    buffer_load_dwordx4 v243, s[52:55], s73 offen lds
    s_addk_i32 m0, 1056
    s_addk_i32 s73, 896
    buffer_load_dwordx4 v243, s[52:55], s73 offen lds
    s_addk_i32 m0, 1056
    s_addk_i32 s73, 896
    buffer_load_dwordx4 v243, s[52:55], s73 offen lds
    s_addk_i32 m0, 1056
    s_addk_i32 s73, 896
    buffer_load_dwordx4 v243, s[52:55], s73 offen lds
    s_addk_i32 m0, 1056
    s_addk_i32 s73, 896
    buffer_load_dwordx4 v243, s[52:55], s73 offen lds
    s_addk_i32 m0, 1056
    s_addk_i32 s73, 896
    buffer_load_dwordx4 v243, s[52:55], s73 offen lds
    s_addk_i32 m0, 1056
    s_addk_i32 s73, 896
    buffer_load_dwordx4 v243, s[52:55], s73 offen lds
    s_addk_i32 m0, 1056
    s_addk_i32 s73, 896
    buffer_load_dwordx4 v243, s[52:55], s73 offen lds
    s_addk_i32 m0, 1056
    s_addk_i32 s73, 896
    buffer_load_dwordx4 v243, s[52:55], s73 offen lds
    s_addk_i32 m0, 1056
    s_addk_i32 s73, 896
    buffer_load_dwordx4 v243, s[52:55], s73 offen lds
    s_addk_i32 m0, 1056
    s_addk_i32 s73, 896
    buffer_load_dwordx4 v243, s[52:55], s73 offen lds
    s_mov_b32 m0, 67584
    s_mov_b32 s73, 114688
    buffer_load_dwordx4 v243, s[52:55], s73 offen lds
    s_addk_i32 m0, 1056
    s_addk_i32 s73, 896
    buffer_load_dwordx4 v243, s[52:55], s73 offen lds
    s_addk_i32 m0, 1056
    s_addk_i32 s73, 896
    buffer_load_dwordx4 v243, s[52:55], s73 offen lds
    s_addk_i32 m0, 1056
    s_addk_i32 s73, 896
    buffer_load_dwordx4 v243, s[52:55], s73 offen lds
    s_addk_i32 m0, 1056
    s_addk_i32 s73, 896
    buffer_load_dwordx4 v243, s[52:55], s73 offen lds
    s_addk_i32 m0, 1056
    s_addk_i32 s73, 896
    buffer_load_dwordx4 v243, s[52:55], s73 offen lds
    s_addk_i32 m0, 1056
    s_addk_i32 s73, 896
    buffer_load_dwordx4 v243, s[52:55], s73 offen lds
    s_addk_i32 m0, 1056
    s_addk_i32 s73, 896
    buffer_load_dwordx4 v243, s[52:55], s73 offen lds
    s_addk_i32 m0, 1056
    s_addk_i32 s73, 896
    buffer_load_dwordx4 v243, s[52:55], s73 offen lds
    s_waitcnt vmcnt(9)
    s_barrier
    s_addk_i32 m0, 1056
    s_addk_i32 s73, 896
    buffer_load_dwordx4 v243, s[52:55], s73 offen lds
    s_addk_i32 m0, 1056
    s_addk_i32 s73, 896
    buffer_load_dwordx4 v243, s[52:55], s73 offen lds
    s_addk_i32 m0, 1056
    s_addk_i32 s73, 896
    buffer_load_dwordx4 v243, s[52:55], s73 offen lds
    s_addk_i32 m0, 1056
    s_addk_i32 s73, 896
    buffer_load_dwordx4 v243, s[52:55], s73 offen lds
    s_addk_i32 m0, 1056
    s_addk_i32 s73, 896
    buffer_load_dwordx4 v243, s[52:55], s73 offen lds
    s_addk_i32 m0, 1056
    s_addk_i32 s73, 896
    buffer_load_dwordx4 v243, s[52:55], s73 offen lds
    s_addk_i32 m0, 1056
    s_addk_i32 s73, 896
    buffer_load_dwordx4 v243, s[52:55], s73 offen lds
    s_mov_b32 m0, 84480
    s_mov_b32 s73, 128
    buffer_load_dwordx4 v243, s[52:55], s73 offen lds
    s_addk_i32 m0, 1056
    s_addk_i32 s73, 896
    buffer_load_dwordx4 v243, s[52:55], s73 offen lds
    s_addk_i32 m0, 1056
    s_addk_i32 s73, 896
    buffer_load_dwordx4 v243, s[52:55], s73 offen lds
    s_addk_i32 m0, 1056
    s_addk_i32 s73, 896
    buffer_load_dwordx4 v243, s[52:55], s73 offen lds
    s_addk_i32 m0, 1056
    s_addk_i32 s73, 896
    buffer_load_dwordx4 v243, s[52:55], s73 offen lds
    s_addk_i32 m0, 1056
    s_addk_i32 s73, 896
    buffer_load_dwordx4 v243, s[52:55], s73 offen lds
    s_addk_i32 m0, 1056
    s_addk_i32 s73, 896
    buffer_load_dwordx4 v243, s[52:55], s73 offen lds
    s_addk_i32 m0, 1056
    s_addk_i32 s73, 896
    buffer_load_dwordx4 v243, s[52:55], s73 offen lds
    s_addk_i32 m0, 1056
    s_addk_i32 s73, 896
    buffer_load_dwordx4 v243, s[52:55], s73 offen lds
    s_addk_i32 m0, 1056
    s_addk_i32 s73, 896
    buffer_load_dwordx4 v243, s[52:55], s73 offen lds
    s_addk_i32 m0, 1056
    s_addk_i32 s73, 896
    buffer_load_dwordx4 v243, s[52:55], s73 offen lds
    s_addk_i32 m0, 1056
    s_addk_i32 s73, 896
    buffer_load_dwordx4 v243, s[52:55], s73 offen lds
    s_addk_i32 m0, 1056
    s_addk_i32 s73, 896
    buffer_load_dwordx4 v243, s[52:55], s73 offen lds
    s_addk_i32 m0, 1056
    s_addk_i32 s73, 896
    buffer_load_dwordx4 v243, s[52:55], s73 offen lds
    s_addk_i32 m0, 1056
    s_addk_i32 s73, 896
    buffer_load_dwordx4 v243, s[52:55], s73 offen lds
    s_addk_i32 m0, 1056
    s_addk_i32 s73, 896
    buffer_load_dwordx4 v243, s[52:55], s73 offen lds
    s_mov_b32 m0, 101376
    s_mov_b32 s73, 114816
    buffer_load_dwordx4 v243, s[52:55], s73 offen lds
    s_addk_i32 m0, 1056
    s_addk_i32 s73, 896
    buffer_load_dwordx4 v243, s[52:55], s73 offen lds
    s_addk_i32 m0, 1056
    s_addk_i32 s73, 896
    buffer_load_dwordx4 v243, s[52:55], s73 offen lds
    s_addk_i32 m0, 1056
    s_addk_i32 s73, 896
    buffer_load_dwordx4 v243, s[52:55], s73 offen lds
    s_addk_i32 m0, 1056
    s_addk_i32 s73, 896
    buffer_load_dwordx4 v243, s[52:55], s73 offen lds
    s_addk_i32 m0, 1056
    s_addk_i32 s73, 896
    buffer_load_dwordx4 v243, s[52:55], s73 offen lds
    s_addk_i32 m0, 1056
    s_addk_i32 s73, 896
    buffer_load_dwordx4 v243, s[52:55], s73 offen lds
    s_addk_i32 m0, 1056
    s_addk_i32 s73, 896
    buffer_load_dwordx4 v243, s[52:55], s73 offen lds
    s_addk_i32 m0, 1056
    s_addk_i32 s73, 896
    buffer_load_dwordx4 v243, s[52:55], s73 offen lds
    s_addk_i32 m0, 1056
    s_addk_i32 s73, 896
    buffer_load_dwordx4 v243, s[52:55], s73 offen lds
    s_addk_i32 m0, 1056
    s_addk_i32 s73, 896
    buffer_load_dwordx4 v243, s[52:55], s73 offen lds
    s_addk_i32 m0, 1056
    s_addk_i32 s73, 896
    buffer_load_dwordx4 v243, s[52:55], s73 offen lds
    s_addk_i32 m0, 1056
    s_addk_i32 s73, 896
    buffer_load_dwordx4 v243, s[52:55], s73 offen lds
    s_addk_i32 m0, 1056
    s_addk_i32 s73, 896
    buffer_load_dwordx4 v243, s[52:55], s73 offen lds
    s_addk_i32 m0, 1056
    s_addk_i32 s73, 896
    buffer_load_dwordx4 v243, s[52:55], s73 offen lds
    s_addk_i32 m0, 1056
    s_addk_i32 s73, 896
    buffer_load_dwordx4 v243, s[52:55], s73 offen lds
    s_mov_b32 m0, 118272
    s_mov_b32 s73, 256
    buffer_load_dwordx4 v243, s[52:55], s73 offen lds
    v_mul_u32_u24 v160, 128, v240
    s_add_u32 s71, s75, 0
    buffer_load_dword v246, v160, s[56:59], s71 offen
    s_add_u32 s71, s75, 8192
    buffer_load_dword v246, v160, s[56:59], s71 offen
    s_add_u32 s71, s75, 16384
    buffer_load_dword v246, v160, s[56:59], s71 offen
    s_waitcnt vmcnt(20)
    s_barrier
    s_addk_i32 m0, 1056
    s_addk_i32 s73, 896
    buffer_load_dwordx4 v243, s[52:55], s73 offen lds
    s_addk_i32 m0, 1056
    s_addk_i32 s73, 896
    buffer_load_dwordx4 v243, s[52:55], s73 offen lds
    s_addk_i32 m0, 1056
    s_addk_i32 s73, 896
    buffer_load_dwordx4 v243, s[52:55], s73 offen lds
    s_addk_i32 m0, 1056
    s_addk_i32 s73, 896
    buffer_load_dwordx4 v243, s[52:55], s73 offen lds
    s_addk_i32 m0, 1056
    s_addk_i32 s73, 896
    buffer_load_dwordx4 v243, s[52:55], s73 offen lds
    s_addk_i32 m0, 1056
    s_addk_i32 s73, 896
    buffer_load_dwordx4 v243, s[52:55], s73 offen lds
    s_addk_i32 m0, 1056
    s_addk_i32 s73, 896
    buffer_load_dwordx4 v243, s[52:55], s73 offen lds
    s_addk_i32 m0, 1056
    s_addk_i32 s73, 896
    buffer_load_dwordx4 v243, s[52:55], s73 offen lds
    s_addk_i32 m0, 1056
    s_addk_i32 s73, 896
    buffer_load_dwordx4 v243, s[52:55], s73 offen lds
    s_addk_i32 m0, 1056
    s_addk_i32 s73, 896
    buffer_load_dwordx4 v243, s[52:55], s73 offen lds
    s_addk_i32 m0, 1056
    s_addk_i32 s73, 896
    buffer_load_dwordx4 v243, s[52:55], s73 offen lds
    s_addk_i32 m0, 1056
    s_addk_i32 s73, 896
    buffer_load_dwordx4 v243, s[52:55], s73 offen lds
    s_addk_i32 m0, 1056
    s_addk_i32 s73, 896
    buffer_load_dwordx4 v243, s[52:55], s73 offen lds
    s_addk_i32 m0, 1056
    s_addk_i32 s73, 896
    buffer_load_dwordx4 v243, s[52:55], s73 offen lds
    s_addk_i32 m0, 1056
    s_addk_i32 s73, 896
    buffer_load_dwordx4 v243, s[52:55], s73 offen lds
    s_mov_b32 m0, 135168
    s_mov_b32 s73, 114944
    buffer_load_dwordx4 v243, s[52:55], s73 offen lds
    s_addk_i32 m0, 1056
    s_addk_i32 s73, 896
    buffer_load_dwordx4 v243, s[52:55], s73 offen lds
    s_addk_i32 m0, 1056
    s_addk_i32 s73, 896
    buffer_load_dwordx4 v243, s[52:55], s73 offen lds
    s_addk_i32 m0, 1056
    s_addk_i32 s73, 896
    buffer_load_dwordx4 v243, s[52:55], s73 offen lds
    s_addk_i32 m0, 1056
    s_addk_i32 s73, 896
    buffer_load_dwordx4 v243, s[52:55], s73 offen lds
    s_addk_i32 m0, 1056
    s_addk_i32 s73, 896
    buffer_load_dwordx4 v243, s[52:55], s73 offen lds
    s_addk_i32 m0, 1056
    s_addk_i32 s73, 896
    buffer_load_dwordx4 v243, s[52:55], s73 offen lds
    s_addk_i32 m0, 1056
    s_addk_i32 s73, 896
    buffer_load_dwordx4 v243, s[52:55], s73 offen lds
    s_addk_i32 m0, 1056
    s_addk_i32 s73, 896
    buffer_load_dwordx4 v243, s[52:55], s73 offen lds
    s_addk_i32 m0, 1056
    s_addk_i32 s73, 896
    buffer_load_dwordx4 v243, s[52:55], s73 offen lds
    s_addk_i32 m0, 1056
    s_addk_i32 s73, 896
    buffer_load_dwordx4 v243, s[52:55], s73 offen lds
    s_addk_i32 m0, 1056
    s_addk_i32 s73, 896
    buffer_load_dwordx4 v243, s[52:55], s73 offen lds
    s_addk_i32 m0, 1056
    s_addk_i32 s73, 896
    buffer_load_dwordx4 v243, s[52:55], s73 offen lds
    s_addk_i32 m0, 1056
    s_addk_i32 s73, 896
    buffer_load_dwordx4 v243, s[52:55], s73 offen lds
    s_addk_i32 m0, 1056
    s_addk_i32 s73, 896
    buffer_load_dwordx4 v243, s[52:55], s73 offen lds
    s_addk_i32 m0, 1056
    s_addk_i32 s73, 896
    buffer_load_dwordx4 v243, s[52:55], s73 offen lds
    s_mov_b32 m0, 0
    s_mov_b32 s73, 384
    buffer_load_dwordx4 v243, s[52:55], s73 offen lds
    s_addk_i32 m0, 1056
    s_addk_i32 s73, 896
    buffer_load_dwordx4 v243, s[52:55], s73 offen lds
    s_addk_i32 m0, 1056
    s_addk_i32 s73, 896
    buffer_load_dwordx4 v243, s[52:55], s73 offen lds
    s_addk_i32 m0, 1056
    s_addk_i32 s73, 896
    buffer_load_dwordx4 v243, s[52:55], s73 offen lds
    s_addk_i32 m0, 1056
    s_addk_i32 s73, 896
    buffer_load_dwordx4 v243, s[52:55], s73 offen lds
    s_addk_i32 m0, 1056
    s_addk_i32 s73, 896
    buffer_load_dwordx4 v243, s[52:55], s73 offen lds
    s_addk_i32 m0, 1056
    s_addk_i32 s73, 896
    buffer_load_dwordx4 v243, s[52:55], s73 offen lds
    s_addk_i32 m0, 1056
    s_addk_i32 s73, 896
    buffer_load_dwordx4 v243, s[52:55], s73 offen lds
    s_addk_i32 m0, 1056
    s_addk_i32 s73, 896
    buffer_load_dwordx4 v243, s[52:55], s73 offen lds
    s_addk_i32 m0, 1056
    s_addk_i32 s73, 896
    buffer_load_dwordx4 v243, s[52:55], s73 offen lds
    s_addk_i32 m0, 1056
    s_addk_i32 s73, 896
    buffer_load_dwordx4 v243, s[52:55], s73 offen lds
    s_addk_i32 m0, 1056
    s_addk_i32 s73, 896
    buffer_load_dwordx4 v243, s[52:55], s73 offen lds
    s_waitcnt vmcnt(58)
    s_addk_i32 m0, 1056
    s_addk_i32 s73, 896
    buffer_load_dwordx4 v243, s[52:55], s73 offen lds
    s_addk_i32 m0, 1056
    s_addk_i32 s73, 896
    buffer_load_dwordx4 v243, s[52:55], s73 offen lds
    s_addk_i32 m0, 1056
    s_addk_i32 s73, 896
    buffer_load_dwordx4 v243, s[52:55], s73 offen lds
    s_addk_i32 m0, 1056
    s_addk_i32 s73, 896
    buffer_load_dwordx4 v243, s[52:55], s73 offen lds
    s_mov_b32 m0, 16896
    s_mov_b32 s73, 115072
    buffer_load_dwordx4 v243, s[52:55], s73 offen lds
    s_add_u32 s71, s75, 24576
    s_waitcnt vmcnt(62)
    buffer_load_dword v246, v160, s[56:59], s71 offen
    s_add_u32 s71, s75, 32768
    s_waitcnt vmcnt(62)
    buffer_load_dword v246, v160, s[56:59], s71 offen
    s_add_u32 s71, s75, 40960
    s_waitcnt vmcnt(62)
    buffer_load_dword v246, v160, s[56:59], s71 offen
    s_add_u32 s71, s75, 49152
    s_waitcnt vmcnt(62)
    buffer_load_dword v246, v160, s[56:59], s71 offen
    s_waitcnt vmcnt(37)
    s_barrier
    s_addk_i32 m0, 1056
    s_addk_i32 s73, 896
    buffer_load_dwordx4 v243, s[52:55], s73 offen lds
    s_addk_i32 m0, 1056
    s_addk_i32 s73, 896
    buffer_load_dwordx4 v243, s[52:55], s73 offen lds
    s_addk_i32 m0, 1056
    s_addk_i32 s73, 896
    buffer_load_dwordx4 v243, s[52:55], s73 offen lds
    s_addk_i32 m0, 1056
    s_addk_i32 s73, 896
    buffer_load_dwordx4 v243, s[52:55], s73 offen lds
    s_addk_i32 m0, 1056
    s_addk_i32 s73, 896
    buffer_load_dwordx4 v243, s[52:55], s73 offen lds
    s_addk_i32 m0, 1056
    s_addk_i32 s73, 896
    buffer_load_dwordx4 v243, s[52:55], s73 offen lds
    s_addk_i32 m0, 1056
    s_addk_i32 s73, 896
    buffer_load_dwordx4 v243, s[52:55], s73 offen lds
    s_addk_i32 m0, 1056
    s_addk_i32 s73, 896
    buffer_load_dwordx4 v243, s[52:55], s73 offen lds
    s_addk_i32 m0, 1056
    s_addk_i32 s73, 896
    buffer_load_dwordx4 v243, s[52:55], s73 offen lds
    s_addk_i32 m0, 1056
    s_addk_i32 s73, 896
    buffer_load_dwordx4 v243, s[52:55], s73 offen lds
    s_addk_i32 m0, 1056
    s_addk_i32 s73, 896
    buffer_load_dwordx4 v243, s[52:55], s73 offen lds
    s_addk_i32 m0, 1056
    s_addk_i32 s73, 896
    buffer_load_dwordx4 v243, s[52:55], s73 offen lds
    s_addk_i32 m0, 1056
    s_addk_i32 s73, 896
    buffer_load_dwordx4 v243, s[52:55], s73 offen lds
    s_addk_i32 m0, 1056
    s_addk_i32 s73, 896
    buffer_load_dwordx4 v243, s[52:55], s73 offen lds
    s_addk_i32 m0, 1056
    s_addk_i32 s73, 896
    buffer_load_dwordx4 v243, s[52:55], s73 offen lds
    s_mov_b32 m0, 33792
    s_mov_b32 s73, 512
    buffer_load_dwordx4 v243, s[52:55], s73 offen lds
    s_addk_i32 m0, 1056
    s_addk_i32 s73, 896
    buffer_load_dwordx4 v243, s[52:55], s73 offen lds
    s_addk_i32 m0, 1056
    s_addk_i32 s73, 896
    buffer_load_dwordx4 v243, s[52:55], s73 offen lds
    s_addk_i32 m0, 1056
    s_addk_i32 s73, 896
    buffer_load_dwordx4 v243, s[52:55], s73 offen lds
    s_addk_i32 m0, 1056
    s_addk_i32 s73, 896
    buffer_load_dwordx4 v243, s[52:55], s73 offen lds
    s_addk_i32 m0, 1056
    s_addk_i32 s73, 896
    buffer_load_dwordx4 v243, s[52:55], s73 offen lds
    s_addk_i32 m0, 1056
    s_addk_i32 s73, 896
    buffer_load_dwordx4 v243, s[52:55], s73 offen lds
    s_addk_i32 m0, 1056
    s_addk_i32 s73, 896
    buffer_load_dwordx4 v243, s[52:55], s73 offen lds
    s_addk_i32 m0, 1056
    s_addk_i32 s73, 896
    buffer_load_dwordx4 v243, s[52:55], s73 offen lds
    s_addk_i32 m0, 1056
    s_addk_i32 s73, 896
    buffer_load_dwordx4 v243, s[52:55], s73 offen lds
    s_addk_i32 m0, 1056
    s_addk_i32 s73, 896
    buffer_load_dwordx4 v243, s[52:55], s73 offen lds
    s_waitcnt vmcnt(55)
    s_addk_i32 m0, 1056
    s_addk_i32 s73, 896
    buffer_load_dwordx4 v243, s[52:55], s73 offen lds
    s_addk_i32 m0, 1056
    s_addk_i32 s73, 896
    buffer_load_dwordx4 v243, s[52:55], s73 offen lds
    s_addk_i32 m0, 1056
    s_addk_i32 s73, 896
    buffer_load_dwordx4 v243, s[52:55], s73 offen lds
    s_addk_i32 m0, 1056
    s_addk_i32 s73, 896
    buffer_load_dwordx4 v243, s[52:55], s73 offen lds
    s_addk_i32 m0, 1056
    s_addk_i32 s73, 896
    buffer_load_dwordx4 v243, s[52:55], s73 offen lds
    s_mov_b32 m0, 50688
    s_mov_b32 s73, 115200
    buffer_load_dwordx4 v243, s[52:55], s73 offen lds
    s_addk_i32 m0, 1056
    s_addk_i32 s73, 896
    buffer_load_dwordx4 v243, s[52:55], s73 offen lds
    s_addk_i32 m0, 1056
    s_addk_i32 s73, 896
    buffer_load_dwordx4 v243, s[52:55], s73 offen lds
    s_waitcnt vmcnt(55)
    s_addk_i32 m0, 1056
    s_addk_i32 s73, 896
    buffer_load_dwordx4 v243, s[52:55], s73 offen lds
    s_addk_i32 m0, 1056
    s_addk_i32 s73, 896
    buffer_load_dwordx4 v243, s[52:55], s73 offen lds
    s_addk_i32 m0, 1056
    s_addk_i32 s73, 896
    buffer_load_dwordx4 v243, s[52:55], s73 offen lds
    s_addk_i32 m0, 1056
    s_addk_i32 s73, 896
    buffer_load_dwordx4 v243, s[52:55], s73 offen lds
    s_addk_i32 m0, 1056
    s_addk_i32 s73, 896
    buffer_load_dwordx4 v243, s[52:55], s73 offen lds
    s_addk_i32 m0, 1056
    s_addk_i32 s73, 896
    buffer_load_dwordx4 v243, s[52:55], s73 offen lds
    s_addk_i32 m0, 1056
    s_addk_i32 s73, 896
    buffer_load_dwordx4 v243, s[52:55], s73 offen lds
    s_addk_i32 m0, 1056
    s_addk_i32 s73, 896
    buffer_load_dwordx4 v243, s[52:55], s73 offen lds
    s_waitcnt vmcnt(55)
    s_addk_i32 m0, 1056
    s_addk_i32 s73, 896
    buffer_load_dwordx4 v243, s[52:55], s73 offen lds
    s_addk_i32 m0, 1056
    s_addk_i32 s73, 896
    buffer_load_dwordx4 v243, s[52:55], s73 offen lds
    s_addk_i32 m0, 1056
    s_addk_i32 s73, 896
    buffer_load_dwordx4 v243, s[52:55], s73 offen lds
    s_addk_i32 m0, 1056
    s_addk_i32 s73, 896
    buffer_load_dwordx4 v243, s[52:55], s73 offen lds
    s_addk_i32 m0, 1056
    s_addk_i32 s73, 896
    buffer_load_dwordx4 v243, s[52:55], s73 offen lds
    s_mov_b32 m0, 67584
    s_mov_b32 s73, 640
    buffer_load_dwordx4 v243, s[52:55], s73 offen lds
    s_addk_i32 m0, 1056
    s_addk_i32 s73, 896
    buffer_load_dwordx4 v243, s[52:55], s73 offen lds
    s_addk_i32 m0, 1056
    s_addk_i32 s73, 896
    buffer_load_dwordx4 v243, s[52:55], s73 offen lds
    s_waitcnt vmcnt(55)
    s_addk_i32 m0, 1056
    s_addk_i32 s73, 896
    buffer_load_dwordx4 v243, s[52:55], s73 offen lds
    s_addk_i32 m0, 1056
    s_addk_i32 s73, 896
    buffer_load_dwordx4 v243, s[52:55], s73 offen lds
    s_addk_i32 m0, 1056
    s_addk_i32 s73, 896
    buffer_load_dwordx4 v243, s[52:55], s73 offen lds
    s_addk_i32 m0, 1056
    s_addk_i32 s73, 896
    buffer_load_dwordx4 v243, s[52:55], s73 offen lds
    s_addk_i32 m0, 1056
    s_addk_i32 s73, 896
    buffer_load_dwordx4 v243, s[52:55], s73 offen lds
    s_addk_i32 m0, 1056
    s_addk_i32 s73, 896
    buffer_load_dwordx4 v243, s[52:55], s73 offen lds
    s_addk_i32 m0, 1056
    s_addk_i32 s73, 896
    buffer_load_dwordx4 v243, s[52:55], s73 offen lds
    s_addk_i32 m0, 1056
    s_addk_i32 s73, 896
    buffer_load_dwordx4 v243, s[52:55], s73 offen lds
    s_waitcnt vmcnt(58)
    s_addk_i32 m0, 1056
    s_addk_i32 s73, 896
    buffer_load_dwordx4 v243, s[52:55], s73 offen lds
    s_addk_i32 m0, 1056
    s_addk_i32 s73, 896
    buffer_load_dwordx4 v243, s[52:55], s73 offen lds
    s_addk_i32 m0, 1056
    s_addk_i32 s73, 896
    buffer_load_dwordx4 v243, s[52:55], s73 offen lds
    s_addk_i32 m0, 1056
    s_addk_i32 s73, 896
    buffer_load_dwordx4 v243, s[52:55], s73 offen lds
    s_addk_i32 m0, 1056
    s_addk_i32 s73, 896
    buffer_load_dwordx4 v243, s[52:55], s73 offen lds
    s_barrier
    s_add_u32 s13, s9, 0
    s_add_u32 s14, s10, 0
    s_add_u32 s15, s11, 0
    s_add_u32 s16, s12, 0
    s_mov_b32 s69, 400000
    s_add_u32 s72, s90, 1
L_poll2:
    buffer_load_dword v150, v149, s[92:95], 0 offen sc1
    s_sub_u32 s69, s69, 1
    s_cbranch_scc1 L_exit1
    s_waitcnt vmcnt(0)
L_poll2c:
    v_subrev_u32 v157, s72, v150
    v_cmp_lt_u32 vcc, 6, v157
    s_nop 1
    s_and_b64 s[24:25], vcc, s[22:23]
    s_cbranch_scc1 L_poll2
    buffer_load_dwordx4 v[0:3], v144, s[56:59], s13 offen offset:0 sc1
    buffer_load_dwordx4 v[4:7], v144, s[56:59], s14 offen offset:0 sc1
    buffer_load_dwordx4 v[8:11], v144, s[56:59], s15 offen offset:0 sc1
    buffer_load_dwordx4 v[12:15], v144, s[56:59], s16 offen offset:0 sc1
    buffer_load_dwordx4 v[16:19], v144, s[56:59], s13 offen offset:256 sc1
    buffer_load_dwordx4 v[20:23], v144, s[56:59], s14 offen offset:256 sc1
    buffer_load_dwordx4 v[24:27], v144, s[56:59], s15 offen offset:256 sc1
    buffer_load_dwordx4 v[28:31], v144, s[56:59], s16 offen offset:256 sc1
    buffer_load_dwordx4 v[32:35], v144, s[56:59], s13 offen offset:512 sc1
    buffer_load_dwordx4 v[36:39], v144, s[56:59], s14 offen offset:512 sc1
    buffer_load_dwordx4 v[40:43], v144, s[56:59], s15 offen offset:512 sc1
    buffer_load_dwordx4 v[44:47], v144, s[56:59], s16 offen offset:512 sc1
    buffer_load_dwordx4 v[48:51], v144, s[56:59], s13 offen offset:768 sc1
    buffer_load_dwordx4 v[52:55], v144, s[56:59], s14 offen offset:768 sc1
    buffer_load_dwordx4 v[56:59], v144, s[56:59], s15 offen offset:768 sc1
    buffer_load_dwordx4 v[60:63], v144, s[56:59], s16 offen offset:768 sc1
    buffer_load_dwordx4 v[64:67], v144, s[56:59], s13 offen offset:1024 sc1
    buffer_load_dwordx4 v[68:71], v144, s[56:59], s14 offen offset:1024 sc1
    buffer_load_dwordx4 v[72:75], v144, s[56:59], s15 offen offset:1024 sc1
    buffer_load_dwordx4 v[76:79], v144, s[56:59], s16 offen offset:1024 sc1
    buffer_load_dwordx4 v[80:83], v144, s[56:59], s13 offen offset:1280 sc1
    buffer_load_dwordx4 v[84:87], v144, s[56:59], s14 offen offset:1280 sc1
    buffer_load_dwordx4 v[88:91], v144, s[56:59], s15 offen offset:1280 sc1
    buffer_load_dwordx4 v[92:95], v144, s[56:59], s16 offen offset:1280 sc1
    buffer_load_dwordx4 v[96:99], v144, s[56:59], s13 offen offset:1536 sc1
    buffer_load_dwordx4 v[100:103], v144, s[56:59], s14 offen offset:1536 sc1
    buffer_load_dwordx4 v[104:107], v144, s[56:59], s15 offen offset:1536 sc1
    buffer_load_dwordx4 v[108:111], v144, s[56:59], s16 offen offset:1536 sc1
    s_mov_b32 m0, 84480
    s_mov_b32 s73, 115328
    buffer_load_dwordx4 v243, s[52:55], s73 offen lds
    s_addk_i32 m0, 1056
    s_addk_i32 s73, 896
    buffer_load_dwordx4 v243, s[52:55], s73 offen lds
    s_addk_i32 m0, 1056
    s_addk_i32 s73, 896
    buffer_load_dwordx4 v243, s[52:55], s73 offen lds
    s_addk_i32 m0, 1056
    s_addk_i32 s73, 896
    buffer_load_dwordx4 v243, s[52:55], s73 offen lds
    s_addk_i32 m0, 1056
    s_addk_i32 s73, 896
    buffer_load_dwordx4 v243, s[52:55], s73 offen lds
    s_addk_i32 m0, 1056
    s_addk_i32 s73, 896
    buffer_load_dwordx4 v243, s[52:55], s73 offen lds
    s_addk_i32 m0, 1056
    s_addk_i32 s73, 896
    buffer_load_dwordx4 v243, s[52:55], s73 offen lds
    s_addk_i32 m0, 1056
    s_addk_i32 s73, 896
    buffer_load_dwordx4 v243, s[52:55], s73 offen lds
    s_addk_i32 m0, 1056
    s_addk_i32 s73, 896
    buffer_load_dwordx4 v243, s[52:55], s73 offen lds
    s_addk_i32 m0, 1056
    s_addk_i32 s73, 896
    buffer_load_dwordx4 v243, s[52:55], s73 offen lds
    s_addk_i32 m0, 1056
    s_addk_i32 s73, 896
    buffer_load_dwordx4 v243, s[52:55], s73 offen lds
    s_addk_i32 m0, 1056
    s_addk_i32 s73, 896
    buffer_load_dwordx4 v243, s[52:55], s73 offen lds
    s_addk_i32 m0, 1056
    s_addk_i32 s73, 896
    buffer_load_dwordx4 v243, s[52:55], s73 offen lds
    s_addk_i32 m0, 1056
    s_addk_i32 s73, 896
    buffer_load_dwordx4 v243, s[52:55], s73 offen lds
    s_addk_i32 m0, 1056
    s_addk_i32 s73, 896
    buffer_load_dwordx4 v243, s[52:55], s73 offen lds
    s_addk_i32 m0, 1056
    s_addk_i32 s73, 896
    buffer_load_dwordx4 v243, s[52:55], s73 offen lds
    s_waitcnt vmcnt(16)
    s_add_u32 s72, s90, 2
    v_mov_b32 v152, s72
    s_cmp_eq_u32 s91, 1
    s_cbranch_scc1 L_f2l1
    buffer_store_dword v152, v151, s[92:95], 0 offen sc1
    s_branch L_f2d1
L_f2l1:
    buffer_store_dword v152, v151, s[92:95], 0 offen
L_f2d1:
    s_mov_b32 s30, 0
    v_mfma_f32_16x16x32_bf16 v[112:115], v[136:139], v[0:3], 0
    v_mfma_f32_16x16x32_bf16 v[112:115], v[136:139], v[4:7], v[112:115]
    v_mfma_f32_16x16x32_bf16 v[112:115], v[136:139], v[8:11], v[112:115]
    v_mfma_f32_16x16x32_bf16 v[112:115], v[136:139], v[12:15], v[112:115]
    v_mfma_f32_16x16x32_bf16 v[112:115], v[140:143], v[16:19], v[112:115]
    v_mfma_f32_16x16x32_bf16 v[112:115], v[140:143], v[20:23], v[112:115]
    v_mfma_f32_16x16x32_bf16 v[112:115], v[140:143], v[24:27], v[112:115]
    v_mfma_f32_16x16x32_bf16 v[112:115], v[140:143], v[28:31], v[112:115]
    v_mfma_f32_16x16x32_bf16 v[116:119], v[136:139], v[32:35], 0
    v_mfma_f32_16x16x32_bf16 v[116:119], v[136:139], v[36:39], v[116:119]
    v_mfma_f32_16x16x32_bf16 v[116:119], v[136:139], v[40:43], v[116:119]
    v_mfma_f32_16x16x32_bf16 v[116:119], v[136:139], v[44:47], v[116:119]
    v_mfma_f32_16x16x32_bf16 v[116:119], v[140:143], v[48:51], v[116:119]
    v_mfma_f32_16x16x32_bf16 v[116:119], v[140:143], v[52:55], v[116:119]
    v_mfma_f32_16x16x32_bf16 v[116:119], v[140:143], v[56:59], v[116:119]
    v_mfma_f32_16x16x32_bf16 v[116:119], v[140:143], v[60:63], v[116:119]
    buffer_load_dword v150, v149, s[92:95], 0 offen sc1
    v_mfma_f32_16x16x32_bf16 v[120:123], v[136:139], v[64:67], 0
    v_mfma_f32_16x16x32_bf16 v[120:123], v[136:139], v[68:71], v[120:123]
    v_mfma_f32_16x16x32_bf16 v[120:123], v[136:139], v[72:75], v[120:123]
    v_mfma_f32_16x16x32_bf16 v[120:123], v[136:139], v[76:79], v[120:123]
    v_mfma_f32_16x16x32_bf16 v[120:123], v[140:143], v[80:83], v[120:123]
    v_mfma_f32_16x16x32_bf16 v[120:123], v[140:143], v[84:87], v[120:123]
    v_mfma_f32_16x16x32_bf16 v[120:123], v[140:143], v[88:91], v[120:123]
    v_mfma_f32_16x16x32_bf16 v[120:123], v[140:143], v[92:95], v[120:123]
    v_mfma_f32_16x16x32_bf16 v[124:127], v[136:139], v[96:99], 0
    v_mfma_f32_16x16x32_bf16 v[124:127], v[136:139], v[100:103], v[124:127]
    v_mfma_f32_16x16x32_bf16 v[124:127], v[136:139], v[104:107], v[124:127]
    v_mfma_f32_16x16x32_bf16 v[124:127], v[136:139], v[108:111], v[124:127]
    v_cvt_pk_bf16_f32 v128, v112, v113
    v_cvt_pk_bf16_f32 v129, v114, v115
    buffer_store_dwordx2 v[128:129], v145, s[96:99], s30 offen
    v_cvt_pk_bf16_f32 v130, v116, v117
    v_cvt_pk_bf16_f32 v131, v118, v119
    buffer_store_dwordx2 v[130:131], v146, s[96:99], s30 offen
    v_cvt_pk_bf16_f32 v132, v120, v121
    v_cvt_pk_bf16_f32 v133, v122, v123
    buffer_store_dwordx2 v[132:133], v147, s[96:99], s30 offen
    v_cvt_pk_bf16_f32 v134, v124, v125
    v_cvt_pk_bf16_f32 v135, v126, v127
    buffer_store_dwordx2 v[134:135], v148, s[96:99], s30 offen
    s_mov_b32 s69, 400000
    s_add_u32 s72, s90, 2
    s_waitcnt vmcnt(4)
    s_branch L_poll3c
L_poll3:
    buffer_load_dword v150, v149, s[92:95], 0 offen sc1
    s_sub_u32 s69, s69, 1
    s_cbranch_scc1 L_exit1
    s_waitcnt vmcnt(0)
L_poll3c:
    v_subrev_u32 v157, s72, v150
    v_cmp_lt_u32 vcc, 5, v157
    s_nop 1
    s_and_b64 s[24:25], vcc, s[20:21]
    s_cbranch_scc1 L_poll3
    s_barrier
    s_add_u32 s13, s9, 28672
    s_add_u32 s14, s10, 28672
    s_add_u32 s15, s11, 28672
    s_add_u32 s16, s12, 28672
    s_mov_b32 s69, 400000
    s_add_u32 s72, s90, 2
    s_branch L_poll4c
L_poll4:
    buffer_load_dword v150, v149, s[92:95], 0 offen sc1
    s_sub_u32 s69, s69, 1
    s_cbranch_scc1 L_exit1
    s_waitcnt vmcnt(0)
L_poll4c:
    v_subrev_u32 v157, s72, v150
    v_cmp_lt_u32 vcc, 5, v157
    s_nop 1
    s_and_b64 s[24:25], vcc, s[22:23]
    s_cbranch_scc1 L_poll4
    buffer_load_dwordx4 v[0:3], v144, s[56:59], s13 offen offset:0 sc1
    buffer_load_dwordx4 v[4:7], v144, s[56:59], s14 offen offset:0 sc1
    buffer_load_dwordx4 v[8:11], v144, s[56:59], s15 offen offset:0 sc1
    buffer_load_dwordx4 v[12:15], v144, s[56:59], s16 offen offset:0 sc1
    buffer_load_dwordx4 v[16:19], v144, s[56:59], s13 offen offset:256 sc1
    buffer_load_dwordx4 v[20:23], v144, s[56:59], s14 offen offset:256 sc1
    buffer_load_dwordx4 v[24:27], v144, s[56:59], s15 offen offset:256 sc1
    buffer_load_dwordx4 v[28:31], v144, s[56:59], s16 offen offset:256 sc1
    buffer_load_dwordx4 v[32:35], v144, s[56:59], s13 offen offset:512 sc1
    buffer_load_dwordx4 v[36:39], v144, s[56:59], s14 offen offset:512 sc1
    buffer_load_dwordx4 v[40:43], v144, s[56:59], s15 offen offset:512 sc1
    buffer_load_dwordx4 v[44:47], v144, s[56:59], s16 offen offset:512 sc1
    buffer_load_dwordx4 v[48:51], v144, s[56:59], s13 offen offset:768 sc1
    buffer_load_dwordx4 v[52:55], v144, s[56:59], s14 offen offset:768 sc1
    buffer_load_dwordx4 v[56:59], v144, s[56:59], s15 offen offset:768 sc1
    buffer_load_dwordx4 v[60:63], v144, s[56:59], s16 offen offset:768 sc1
    buffer_load_dwordx4 v[64:67], v144, s[56:59], s13 offen offset:1024 sc1
    buffer_load_dwordx4 v[68:71], v144, s[56:59], s14 offen offset:1024 sc1
    buffer_load_dwordx4 v[72:75], v144, s[56:59], s15 offen offset:1024 sc1
    buffer_load_dwordx4 v[76:79], v144, s[56:59], s16 offen offset:1024 sc1
    buffer_load_dwordx4 v[80:83], v144, s[56:59], s13 offen offset:1280 sc1
    buffer_load_dwordx4 v[84:87], v144, s[56:59], s14 offen offset:1280 sc1
    buffer_load_dwordx4 v[88:91], v144, s[56:59], s15 offen offset:1280 sc1
    buffer_load_dwordx4 v[92:95], v144, s[56:59], s16 offen offset:1280 sc1
    buffer_load_dwordx4 v[96:99], v144, s[56:59], s13 offen offset:1536 sc1
    buffer_load_dwordx4 v[100:103], v144, s[56:59], s14 offen offset:1536 sc1
    buffer_load_dwordx4 v[104:107], v144, s[56:59], s15 offen offset:1536 sc1
    buffer_load_dwordx4 v[108:111], v144, s[56:59], s16 offen offset:1536 sc1
    s_mov_b32 m0, 101376
    s_mov_b32 s73, 768
    buffer_load_dwordx4 v243, s[52:55], s73 offen lds
    s_addk_i32 m0, 1056
    s_addk_i32 s73, 896
    buffer_load_dwordx4 v243, s[52:55], s73 offen lds
    s_addk_i32 m0, 1056
    s_addk_i32 s73, 896
    buffer_load_dwordx4 v243, s[52:55], s73 offen lds
    s_addk_i32 m0, 1056
    s_addk_i32 s73, 896
    buffer_load_dwordx4 v243, s[52:55], s73 offen lds
    s_addk_i32 m0, 1056
    s_addk_i32 s73, 896
    buffer_load_dwordx4 v243, s[52:55], s73 offen lds
    s_addk_i32 m0, 1056
    s_addk_i32 s73, 896
    buffer_load_dwordx4 v243, s[52:55], s73 offen lds
    s_addk_i32 m0, 1056
    s_addk_i32 s73, 896
    buffer_load_dwordx4 v243, s[52:55], s73 offen lds
    s_addk_i32 m0, 1056
    s_addk_i32 s73, 896
    buffer_load_dwordx4 v243, s[52:55], s73 offen lds
    s_addk_i32 m0, 1056
    s_addk_i32 s73, 896
    buffer_load_dwordx4 v243, s[52:55], s73 offen lds
    s_addk_i32 m0, 1056
    s_addk_i32 s73, 896
    buffer_load_dwordx4 v243, s[52:55], s73 offen lds
    s_addk_i32 m0, 1056
    s_addk_i32 s73, 896
    buffer_load_dwordx4 v243, s[52:55], s73 offen lds
    s_addk_i32 m0, 1056
    s_addk_i32 s73, 896
    buffer_load_dwordx4 v243, s[52:55], s73 offen lds
    s_addk_i32 m0, 1056
    s_addk_i32 s73, 896
    buffer_load_dwordx4 v243, s[52:55], s73 offen lds
    s_addk_i32 m0, 1056
    s_addk_i32 s73, 896
    buffer_load_dwordx4 v243, s[52:55], s73 offen lds
    s_addk_i32 m0, 1056
    s_addk_i32 s73, 896
    buffer_load_dwordx4 v243, s[52:55], s73 offen lds
    s_addk_i32 m0, 1056
    s_addk_i32 s73, 896
    buffer_load_dwordx4 v243, s[52:55], s73 offen lds
    s_waitcnt vmcnt(16)
    s_add_u32 s72, s90, 3
    v_mov_b32 v152, s72
    s_cmp_eq_u32 s91, 1
    s_cbranch_scc1 L_f2l2
    buffer_store_dword v152, v151, s[92:95], 0 offen sc1
    s_branch L_f2d2
L_f2l2:
    buffer_store_dword v152, v151, s[92:95], 0 offen
L_f2d2:
    s_mov_b32 s30, 128
    v_mfma_f32_16x16x32_bf16 v[112:115], v[136:139], v[0:3], 0
    v_mfma_f32_16x16x32_bf16 v[112:115], v[136:139], v[4:7], v[112:115]
    v_mfma_f32_16x16x32_bf16 v[112:115], v[136:139], v[8:11], v[112:115]
    v_mfma_f32_16x16x32_bf16 v[112:115], v[136:139], v[12:15], v[112:115]
    v_mfma_f32_16x16x32_bf16 v[112:115], v[140:143], v[16:19], v[112:115]
    v_mfma_f32_16x16x32_bf16 v[112:115], v[140:143], v[20:23], v[112:115]
    v_mfma_f32_16x16x32_bf16 v[112:115], v[140:143], v[24:27], v[112:115]
    v_mfma_f32_16x16x32_bf16 v[112:115], v[140:143], v[28:31], v[112:115]
    v_mfma_f32_16x16x32_bf16 v[116:119], v[136:139], v[32:35], 0
    v_mfma_f32_16x16x32_bf16 v[116:119], v[136:139], v[36:39], v[116:119]
    v_mfma_f32_16x16x32_bf16 v[116:119], v[136:139], v[40:43], v[116:119]
    v_mfma_f32_16x16x32_bf16 v[116:119], v[136:139], v[44:47], v[116:119]
    v_mfma_f32_16x16x32_bf16 v[116:119], v[140:143], v[48:51], v[116:119]
    v_mfma_f32_16x16x32_bf16 v[116:119], v[140:143], v[52:55], v[116:119]
    v_mfma_f32_16x16x32_bf16 v[116:119], v[140:143], v[56:59], v[116:119]
    v_mfma_f32_16x16x32_bf16 v[116:119], v[140:143], v[60:63], v[116:119]
    buffer_load_dword v150, v149, s[92:95], 0 offen sc1
    v_mfma_f32_16x16x32_bf16 v[120:123], v[136:139], v[64:67], 0
    v_mfma_f32_16x16x32_bf16 v[120:123], v[136:139], v[68:71], v[120:123]
    v_mfma_f32_16x16x32_bf16 v[120:123], v[136:139], v[72:75], v[120:123]
    v_mfma_f32_16x16x32_bf16 v[120:123], v[136:139], v[76:79], v[120:123]
    v_mfma_f32_16x16x32_bf16 v[120:123], v[140:143], v[80:83], v[120:123]
    v_mfma_f32_16x16x32_bf16 v[120:123], v[140:143], v[84:87], v[120:123]
    v_mfma_f32_16x16x32_bf16 v[120:123], v[140:143], v[88:91], v[120:123]
    v_mfma_f32_16x16x32_bf16 v[120:123], v[140:143], v[92:95], v[120:123]
    v_mfma_f32_16x16x32_bf16 v[124:127], v[136:139], v[96:99], 0
    v_mfma_f32_16x16x32_bf16 v[124:127], v[136:139], v[100:103], v[124:127]
    v_mfma_f32_16x16x32_bf16 v[124:127], v[136:139], v[104:107], v[124:127]
    v_mfma_f32_16x16x32_bf16 v[124:127], v[136:139], v[108:111], v[124:127]
    v_cvt_pk_bf16_f32 v128, v112, v113
    v_cvt_pk_bf16_f32 v129, v114, v115
    buffer_store_dwordx2 v[128:129], v145, s[96:99], s30 offen
    v_cvt_pk_bf16_f32 v130, v116, v117
    v_cvt_pk_bf16_f32 v131, v118, v119
    buffer_store_dwordx2 v[130:131], v146, s[96:99], s30 offen
    v_cvt_pk_bf16_f32 v132, v120, v121
    v_cvt_pk_bf16_f32 v133, v122, v123
    buffer_store_dwordx2 v[132:133], v147, s[96:99], s30 offen
    v_cvt_pk_bf16_f32 v134, v124, v125
    v_cvt_pk_bf16_f32 v135, v126, v127
    buffer_store_dwordx2 v[134:135], v148, s[96:99], s30 offen
    s_mov_b32 s69, 400000
    s_add_u32 s72, s90, 3
    s_waitcnt vmcnt(4)
    s_branch L_poll5c
L_poll5:
    buffer_load_dword v150, v149, s[92:95], 0 offen sc1
    s_sub_u32 s69, s69, 1
    s_cbranch_scc1 L_exit1
    s_waitcnt vmcnt(0)
L_poll5c:
    v_subrev_u32 v157, s72, v150
    v_cmp_lt_u32 vcc, 4, v157
    s_nop 1
    s_and_b64 s[24:25], vcc, s[20:21]
    s_cbranch_scc1 L_poll5
    s_barrier
    s_add_u32 s13, s9, 0
    s_add_u32 s14, s10, 0
    s_add_u32 s15, s11, 0
    s_add_u32 s16, s12, 0
    s_mov_b32 s69, 400000
    s_add_u32 s72, s90, 3
    s_branch L_poll6c
L_poll6:
    buffer_load_dword v150, v149, s[92:95], 0 offen sc1
    s_sub_u32 s69, s69, 1
    s_cbranch_scc1 L_exit1
    s_waitcnt vmcnt(0)
L_poll6c:
    v_subrev_u32 v157, s72, v150
    v_cmp_lt_u32 vcc, 4, v157
    s_nop 1
    s_and_b64 s[24:25], vcc, s[22:23]
    s_cbranch_scc1 L_poll6
    buffer_load_dwordx4 v[0:3], v144, s[56:59], s13 offen offset:0 sc1
    buffer_load_dwordx4 v[4:7], v144, s[56:59], s14 offen offset:0 sc1
    buffer_load_dwordx4 v[8:11], v144, s[56:59], s15 offen offset:0 sc1
    buffer_load_dwordx4 v[12:15], v144, s[56:59], s16 offen offset:0 sc1
    buffer_load_dwordx4 v[16:19], v144, s[56:59], s13 offen offset:256 sc1
    buffer_load_dwordx4 v[20:23], v144, s[56:59], s14 offen offset:256 sc1
    buffer_load_dwordx4 v[24:27], v144, s[56:59], s15 offen offset:256 sc1
    buffer_load_dwordx4 v[28:31], v144, s[56:59], s16 offen offset:256 sc1
    buffer_load_dwordx4 v[32:35], v144, s[56:59], s13 offen offset:512 sc1
    buffer_load_dwordx4 v[36:39], v144, s[56:59], s14 offen offset:512 sc1
    buffer_load_dwordx4 v[40:43], v144, s[56:59], s15 offen offset:512 sc1
    buffer_load_dwordx4 v[44:47], v144, s[56:59], s16 offen offset:512 sc1
    buffer_load_dwordx4 v[48:51], v144, s[56:59], s13 offen offset:768 sc1
    buffer_load_dwordx4 v[52:55], v144, s[56:59], s14 offen offset:768 sc1
    buffer_load_dwordx4 v[56:59], v144, s[56:59], s15 offen offset:768 sc1
    buffer_load_dwordx4 v[60:63], v144, s[56:59], s16 offen offset:768 sc1
    buffer_load_dwordx4 v[64:67], v144, s[56:59], s13 offen offset:1024 sc1
    buffer_load_dwordx4 v[68:71], v144, s[56:59], s14 offen offset:1024 sc1
    buffer_load_dwordx4 v[72:75], v144, s[56:59], s15 offen offset:1024 sc1
    buffer_load_dwordx4 v[76:79], v144, s[56:59], s16 offen offset:1024 sc1
    buffer_load_dwordx4 v[80:83], v144, s[56:59], s13 offen offset:1280 sc1
    buffer_load_dwordx4 v[84:87], v144, s[56:59], s14 offen offset:1280 sc1
    buffer_load_dwordx4 v[88:91], v144, s[56:59], s15 offen offset:1280 sc1
    buffer_load_dwordx4 v[92:95], v144, s[56:59], s16 offen offset:1280 sc1
    buffer_load_dwordx4 v[96:99], v144, s[56:59], s13 offen offset:1536 sc1
    buffer_load_dwordx4 v[100:103], v144, s[56:59], s14 offen offset:1536 sc1
    buffer_load_dwordx4 v[104:107], v144, s[56:59], s15 offen offset:1536 sc1
    buffer_load_dwordx4 v[108:111], v144, s[56:59], s16 offen offset:1536 sc1
    s_mov_b32 m0, 118272
    s_mov_b32 s73, 115456
    buffer_load_dwordx4 v243, s[52:55], s73 offen lds
    s_addk_i32 m0, 1056
    s_addk_i32 s73, 896
    buffer_load_dwordx4 v243, s[52:55], s73 offen lds
    s_addk_i32 m0, 1056
    s_addk_i32 s73, 896
    buffer_load_dwordx4 v243, s[52:55], s73 offen lds
    s_addk_i32 m0, 1056
    s_addk_i32 s73, 896
    buffer_load_dwordx4 v243, s[52:55], s73 offen lds
    s_addk_i32 m0, 1056
    s_addk_i32 s73, 896
    buffer_load_dwordx4 v243, s[52:55], s73 offen lds
    s_addk_i32 m0, 1056
    s_addk_i32 s73, 896
    buffer_load_dwordx4 v243, s[52:55], s73 offen lds
    s_addk_i32 m0, 1056
    s_addk_i32 s73, 896
    buffer_load_dwordx4 v243, s[52:55], s73 offen lds
    s_addk_i32 m0, 1056
    s_addk_i32 s73, 896
    buffer_load_dwordx4 v243, s[52:55], s73 offen lds
    s_addk_i32 m0, 1056
    s_addk_i32 s73, 896
    buffer_load_dwordx4 v243, s[52:55], s73 offen lds
    s_addk_i32 m0, 1056
    s_addk_i32 s73, 896
    buffer_load_dwordx4 v243, s[52:55], s73 offen lds
    s_addk_i32 m0, 1056
    s_addk_i32 s73, 896
    buffer_load_dwordx4 v243, s[52:55], s73 offen lds
    s_addk_i32 m0, 1056
    s_addk_i32 s73, 896
    buffer_load_dwordx4 v243, s[52:55], s73 offen lds
    s_addk_i32 m0, 1056
    s_addk_i32 s73, 896
    buffer_load_dwordx4 v243, s[52:55], s73 offen lds
    s_addk_i32 m0, 1056
    s_addk_i32 s73, 896
    buffer_load_dwordx4 v243, s[52:55], s73 offen lds
    s_addk_i32 m0, 1056
    s_addk_i32 s73, 896
    buffer_load_dwordx4 v243, s[52:55], s73 offen lds
    s_addk_i32 m0, 1056
    s_addk_i32 s73, 896
    buffer_load_dwordx4 v243, s[52:55], s73 offen lds
    s_waitcnt vmcnt(16)
    s_add_u32 s72, s90, 4
    v_mov_b32 v152, s72
    s_cmp_eq_u32 s91, 1
    s_cbranch_scc1 L_f2l3
    buffer_store_dword v152, v151, s[92:95], 0 offen sc1
    s_branch L_f2d3
L_f2l3:
    buffer_store_dword v152, v151, s[92:95], 0 offen
L_f2d3:
    s_mov_b32 s30, 256
    v_mfma_f32_16x16x32_bf16 v[112:115], v[136:139], v[0:3], 0
    v_mfma_f32_16x16x32_bf16 v[112:115], v[136:139], v[4:7], v[112:115]
    v_mfma_f32_16x16x32_bf16 v[112:115], v[136:139], v[8:11], v[112:115]
    v_mfma_f32_16x16x32_bf16 v[112:115], v[136:139], v[12:15], v[112:115]
    v_mfma_f32_16x16x32_bf16 v[112:115], v[140:143], v[16:19], v[112:115]
    v_mfma_f32_16x16x32_bf16 v[112:115], v[140:143], v[20:23], v[112:115]
    v_mfma_f32_16x16x32_bf16 v[112:115], v[140:143], v[24:27], v[112:115]
    v_mfma_f32_16x16x32_bf16 v[112:115], v[140:143], v[28:31], v[112:115]
    v_mfma_f32_16x16x32_bf16 v[116:119], v[136:139], v[32:35], 0
    v_mfma_f32_16x16x32_bf16 v[116:119], v[136:139], v[36:39], v[116:119]
    v_mfma_f32_16x16x32_bf16 v[116:119], v[136:139], v[40:43], v[116:119]
    v_mfma_f32_16x16x32_bf16 v[116:119], v[136:139], v[44:47], v[116:119]
    v_mfma_f32_16x16x32_bf16 v[116:119], v[140:143], v[48:51], v[116:119]
    v_mfma_f32_16x16x32_bf16 v[116:119], v[140:143], v[52:55], v[116:119]
    v_mfma_f32_16x16x32_bf16 v[116:119], v[140:143], v[56:59], v[116:119]
    v_mfma_f32_16x16x32_bf16 v[116:119], v[140:143], v[60:63], v[116:119]
    buffer_load_dword v150, v149, s[92:95], 0 offen sc1
    v_mfma_f32_16x16x32_bf16 v[120:123], v[136:139], v[64:67], 0
    v_mfma_f32_16x16x32_bf16 v[120:123], v[136:139], v[68:71], v[120:123]
    v_mfma_f32_16x16x32_bf16 v[120:123], v[136:139], v[72:75], v[120:123]
    v_mfma_f32_16x16x32_bf16 v[120:123], v[136:139], v[76:79], v[120:123]
    v_mfma_f32_16x16x32_bf16 v[120:123], v[140:143], v[80:83], v[120:123]
    v_mfma_f32_16x16x32_bf16 v[120:123], v[140:143], v[84:87], v[120:123]
    v_mfma_f32_16x16x32_bf16 v[120:123], v[140:143], v[88:91], v[120:123]
    v_mfma_f32_16x16x32_bf16 v[120:123], v[140:143], v[92:95], v[120:123]
    v_mfma_f32_16x16x32_bf16 v[124:127], v[136:139], v[96:99], 0
    v_mfma_f32_16x16x32_bf16 v[124:127], v[136:139], v[100:103], v[124:127]
    v_mfma_f32_16x16x32_bf16 v[124:127], v[136:139], v[104:107], v[124:127]
    v_mfma_f32_16x16x32_bf16 v[124:127], v[136:139], v[108:111], v[124:127]
    v_cvt_pk_bf16_f32 v128, v112, v113
    v_cvt_pk_bf16_f32 v129, v114, v115
    buffer_store_dwordx2 v[128:129], v145, s[96:99], s30 offen
    v_cvt_pk_bf16_f32 v130, v116, v117
    v_cvt_pk_bf16_f32 v131, v118, v119
    buffer_store_dwordx2 v[130:131], v146, s[96:99], s30 offen
    v_cvt_pk_bf16_f32 v132, v120, v121
    v_cvt_pk_bf16_f32 v133, v122, v123
    buffer_store_dwordx2 v[132:133], v147, s[96:99], s30 offen
    v_cvt_pk_bf16_f32 v134, v124, v125
    v_cvt_pk_bf16_f32 v135, v126, v127
    buffer_store_dwordx2 v[134:135], v148, s[96:99], s30 offen
    s_mov_b32 s69, 400000
    s_add_u32 s72, s90, 4
    s_waitcnt vmcnt(4)
    s_branch L_poll7c
L_poll7:
    buffer_load_dword v150, v149, s[92:95], 0 offen sc1
    s_sub_u32 s69, s69, 1
    s_cbranch_scc1 L_exit1
    s_waitcnt vmcnt(0)
L_poll7c:
    v_subrev_u32 v157, s72, v150
    v_cmp_lt_u32 vcc, 3, v157
    s_nop 1
    s_and_b64 s[24:25], vcc, s[20:21]
    s_cbranch_scc1 L_poll7
    s_barrier
    s_add_u32 s13, s9, 28672
    s_add_u32 s14, s10, 28672
    s_add_u32 s15, s11, 28672
    s_add_u32 s16, s12, 28672
    s_mov_b32 s69, 400000
    s_add_u32 s72, s90, 4
    s_branch L_poll8c
L_poll8:
    buffer_load_dword v150, v149, s[92:95], 0 offen sc1
    s_sub_u32 s69, s69, 1
    s_cbranch_scc1 L_exit1
    s_waitcnt vmcnt(0)
L_poll8c:
    v_subrev_u32 v157, s72, v150
    v_cmp_lt_u32 vcc, 3, v157
    s_nop 1
    s_and_b64 s[24:25], vcc, s[22:23]
    s_cbranch_scc1 L_poll8
    buffer_load_dwordx4 v[0:3], v144, s[56:59], s13 offen offset:0 sc1
    buffer_load_dwordx4 v[4:7], v144, s[56:59], s14 offen offset:0 sc1
    buffer_load_dwordx4 v[8:11], v144, s[56:59], s15 offen offset:0 sc1
    buffer_load_dwordx4 v[12:15], v144, s[56:59], s16 offen offset:0 sc1
    buffer_load_dwordx4 v[16:19], v144, s[56:59], s13 offen offset:256 sc1
    buffer_load_dwordx4 v[20:23], v144, s[56:59], s14 offen offset:256 sc1
    buffer_load_dwordx4 v[24:27], v144, s[56:59], s15 offen offset:256 sc1
    buffer_load_dwordx4 v[28:31], v144, s[56:59], s16 offen offset:256 sc1
    buffer_load_dwordx4 v[32:35], v144, s[56:59], s13 offen offset:512 sc1
    buffer_load_dwordx4 v[36:39], v144, s[56:59], s14 offen offset:512 sc1
    buffer_load_dwordx4 v[40:43], v144, s[56:59], s15 offen offset:512 sc1
    buffer_load_dwordx4 v[44:47], v144, s[56:59], s16 offen offset:512 sc1
    buffer_load_dwordx4 v[48:51], v144, s[56:59], s13 offen offset:768 sc1
    buffer_load_dwordx4 v[52:55], v144, s[56:59], s14 offen offset:768 sc1
    buffer_load_dwordx4 v[56:59], v144, s[56:59], s15 offen offset:768 sc1
    buffer_load_dwordx4 v[60:63], v144, s[56:59], s16 offen offset:768 sc1
    buffer_load_dwordx4 v[64:67], v144, s[56:59], s13 offen offset:1024 sc1
    buffer_load_dwordx4 v[68:71], v144, s[56:59], s14 offen offset:1024 sc1
    buffer_load_dwordx4 v[72:75], v144, s[56:59], s15 offen offset:1024 sc1
    buffer_load_dwordx4 v[76:79], v144, s[56:59], s16 offen offset:1024 sc1
    buffer_load_dwordx4 v[80:83], v144, s[56:59], s13 offen offset:1280 sc1
    buffer_load_dwordx4 v[84:87], v144, s[56:59], s14 offen offset:1280 sc1
    buffer_load_dwordx4 v[88:91], v144, s[56:59], s15 offen offset:1280 sc1
    buffer_load_dwordx4 v[92:95], v144, s[56:59], s16 offen offset:1280 sc1
    buffer_load_dwordx4 v[96:99], v144, s[56:59], s13 offen offset:1536 sc1
    buffer_load_dwordx4 v[100:103], v144, s[56:59], s14 offen offset:1536 sc1
    buffer_load_dwordx4 v[104:107], v144, s[56:59], s15 offen offset:1536 sc1
    buffer_load_dwordx4 v[108:111], v144, s[56:59], s16 offen offset:1536 sc1
    s_waitcnt vmcnt(0)
    s_add_u32 s72, s90, 5
    v_mov_b32 v152, s72
    s_cmp_eq_u32 s91, 1
    s_cbranch_scc1 L_f2l4
    buffer_store_dword v152, v151, s[92:95], 0 offen sc1
    s_branch L_f2d4
L_f2l4:
    buffer_store_dword v152, v151, s[92:95], 0 offen
L_f2d4:
    s_mov_b32 s30, 384
    v_mfma_f32_16x16x32_bf16 v[112:115], v[136:139], v[0:3], 0
    v_mfma_f32_16x16x32_bf16 v[112:115], v[136:139], v[4:7], v[112:115]
    v_mfma_f32_16x16x32_bf16 v[112:115], v[136:139], v[8:11], v[112:115]
    v_mfma_f32_16x16x32_bf16 v[112:115], v[136:139], v[12:15], v[112:115]
    v_mfma_f32_16x16x32_bf16 v[112:115], v[140:143], v[16:19], v[112:115]
    v_mfma_f32_16x16x32_bf16 v[112:115], v[140:143], v[20:23], v[112:115]
    v_mfma_f32_16x16x32_bf16 v[112:115], v[140:143], v[24:27], v[112:115]
    v_mfma_f32_16x16x32_bf16 v[112:115], v[140:143], v[28:31], v[112:115]
    v_mfma_f32_16x16x32_bf16 v[116:119], v[136:139], v[32:35], 0
    v_mfma_f32_16x16x32_bf16 v[116:119], v[136:139], v[36:39], v[116:119]
    v_mfma_f32_16x16x32_bf16 v[116:119], v[136:139], v[40:43], v[116:119]
    v_mfma_f32_16x16x32_bf16 v[116:119], v[136:139], v[44:47], v[116:119]
    v_mfma_f32_16x16x32_bf16 v[116:119], v[140:143], v[48:51], v[116:119]
    v_mfma_f32_16x16x32_bf16 v[116:119], v[140:143], v[52:55], v[116:119]
    v_mfma_f32_16x16x32_bf16 v[116:119], v[140:143], v[56:59], v[116:119]
    v_mfma_f32_16x16x32_bf16 v[116:119], v[140:143], v[60:63], v[116:119]
    buffer_load_dword v150, v149, s[92:95], 0 offen sc1
    v_mfma_f32_16x16x32_bf16 v[120:123], v[136:139], v[64:67], 0
    v_mfma_f32_16x16x32_bf16 v[120:123], v[136:139], v[68:71], v[120:123]
    v_mfma_f32_16x16x32_bf16 v[120:123], v[136:139], v[72:75], v[120:123]
    v_mfma_f32_16x16x32_bf16 v[120:123], v[136:139], v[76:79], v[120:123]
    v_mfma_f32_16x16x32_bf16 v[120:123], v[140:143], v[80:83], v[120:123]
    v_mfma_f32_16x16x32_bf16 v[120:123], v[140:143], v[84:87], v[120:123]
    v_mfma_f32_16x16x32_bf16 v[120:123], v[140:143], v[88:91], v[120:123]
    v_mfma_f32_16x16x32_bf16 v[120:123], v[140:143], v[92:95], v[120:123]
    v_mfma_f32_16x16x32_bf16 v[124:127], v[136:139], v[96:99], 0
    v_mfma_f32_16x16x32_bf16 v[124:127], v[136:139], v[100:103], v[124:127]
    v_mfma_f32_16x16x32_bf16 v[124:127], v[136:139], v[104:107], v[124:127]
    v_mfma_f32_16x16x32_bf16 v[124:127], v[136:139], v[108:111], v[124:127]
    v_cvt_pk_bf16_f32 v128, v112, v113
    v_cvt_pk_bf16_f32 v129, v114, v115
    buffer_store_dwordx2 v[128:129], v145, s[96:99], s30 offen
    v_cvt_pk_bf16_f32 v130, v116, v117
    v_cvt_pk_bf16_f32 v131, v118, v119
    buffer_store_dwordx2 v[130:131], v146, s[96:99], s30 offen
    v_cvt_pk_bf16_f32 v132, v120, v121
    v_cvt_pk_bf16_f32 v133, v122, v123
    buffer_store_dwordx2 v[132:133], v147, s[96:99], s30 offen
    v_cvt_pk_bf16_f32 v134, v124, v125
    v_cvt_pk_bf16_f32 v135, v126, v127
    buffer_store_dwordx2 v[134:135], v148, s[96:99], s30 offen
    s_mov_b32 s69, 400000
    s_add_u32 s72, s90, 5
    s_waitcnt vmcnt(4)
    s_branch L_poll9c
L_poll9:
    buffer_load_dword v150, v149, s[92:95], 0 offen sc1
    s_sub_u32 s69, s69, 1
    s_cbranch_scc1 L_exit1
    s_waitcnt vmcnt(0)
L_poll9c:
    v_subrev_u32 v157, s72, v150
    v_cmp_lt_u32 vcc, 2, v157
    s_nop 1
    s_and_b64 s[24:25], vcc, s[20:21]
    s_cbranch_scc1 L_poll9
    s_barrier
    s_add_u32 s13, s9, 0
    s_add_u32 s14, s10, 0
    s_add_u32 s15, s11, 0
    s_add_u32 s16, s12, 0
    s_mov_b32 s69, 400000
    s_add_u32 s72, s90, 5
    s_branch L_poll10c
L_poll10:
    buffer_load_dword v150, v149, s[92:95], 0 offen sc1
    s_sub_u32 s69, s69, 1
    s_cbranch_scc1 L_exit1
    s_waitcnt vmcnt(0)
L_poll10c:
    v_subrev_u32 v157, s72, v150
    v_cmp_lt_u32 vcc, 2, v157
    s_nop 1
    s_and_b64 s[24:25], vcc, s[22:23]
    s_cbranch_scc1 L_poll10
    buffer_load_dwordx4 v[0:3], v144, s[56:59], s13 offen offset:0 sc1
    buffer_load_dwordx4 v[4:7], v144, s[56:59], s14 offen offset:0 sc1
    buffer_load_dwordx4 v[8:11], v144, s[56:59], s15 offen offset:0 sc1
    buffer_load_dwordx4 v[12:15], v144, s[56:59], s16 offen offset:0 sc1
    buffer_load_dwordx4 v[16:19], v144, s[56:59], s13 offen offset:256 sc1
    buffer_load_dwordx4 v[20:23], v144, s[56:59], s14 offen offset:256 sc1
    buffer_load_dwordx4 v[24:27], v144, s[56:59], s15 offen offset:256 sc1
    buffer_load_dwordx4 v[28:31], v144, s[56:59], s16 offen offset:256 sc1
    buffer_load_dwordx4 v[32:35], v144, s[56:59], s13 offen offset:512 sc1
    buffer_load_dwordx4 v[36:39], v144, s[56:59], s14 offen offset:512 sc1
    buffer_load_dwordx4 v[40:43], v144, s[56:59], s15 offen offset:512 sc1
    buffer_load_dwordx4 v[44:47], v144, s[56:59], s16 offen offset:512 sc1
    buffer_load_dwordx4 v[48:51], v144, s[56:59], s13 offen offset:768 sc1
    buffer_load_dwordx4 v[52:55], v144, s[56:59], s14 offen offset:768 sc1
    buffer_load_dwordx4 v[56:59], v144, s[56:59], s15 offen offset:768 sc1
    buffer_load_dwordx4 v[60:63], v144, s[56:59], s16 offen offset:768 sc1
    buffer_load_dwordx4 v[64:67], v144, s[56:59], s13 offen offset:1024 sc1
    buffer_load_dwordx4 v[68:71], v144, s[56:59], s14 offen offset:1024 sc1
    buffer_load_dwordx4 v[72:75], v144, s[56:59], s15 offen offset:1024 sc1
    buffer_load_dwordx4 v[76:79], v144, s[56:59], s16 offen offset:1024 sc1
    buffer_load_dwordx4 v[80:83], v144, s[56:59], s13 offen offset:1280 sc1
    buffer_load_dwordx4 v[84:87], v144, s[56:59], s14 offen offset:1280 sc1
    buffer_load_dwordx4 v[88:91], v144, s[56:59], s15 offen offset:1280 sc1
    buffer_load_dwordx4 v[92:95], v144, s[56:59], s16 offen offset:1280 sc1
    buffer_load_dwordx4 v[96:99], v144, s[56:59], s13 offen offset:1536 sc1
    buffer_load_dwordx4 v[100:103], v144, s[56:59], s14 offen offset:1536 sc1
    buffer_load_dwordx4 v[104:107], v144, s[56:59], s15 offen offset:1536 sc1
    buffer_load_dwordx4 v[108:111], v144, s[56:59], s16 offen offset:1536 sc1
    s_waitcnt vmcnt(0)
    s_add_u32 s72, s90, 6
    v_mov_b32 v152, s72
    s_cmp_eq_u32 s91, 1
    s_cbranch_scc1 L_f2l5
    buffer_store_dword v152, v151, s[92:95], 0 offen sc1
    s_branch L_f2d5
L_f2l5:
    buffer_store_dword v152, v151, s[92:95], 0 offen
L_f2d5:
    s_mov_b32 s30, 512
    v_mfma_f32_16x16x32_bf16 v[112:115], v[136:139], v[0:3], 0
    v_mfma_f32_16x16x32_bf16 v[112:115], v[136:139], v[4:7], v[112:115]
    v_mfma_f32_16x16x32_bf16 v[112:115], v[136:139], v[8:11], v[112:115]
    v_mfma_f32_16x16x32_bf16 v[112:115], v[136:139], v[12:15], v[112:115]
    v_mfma_f32_16x16x32_bf16 v[112:115], v[140:143], v[16:19], v[112:115]
    v_mfma_f32_16x16x32_bf16 v[112:115], v[140:143], v[20:23], v[112:115]
    v_mfma_f32_16x16x32_bf16 v[112:115], v[140:143], v[24:27], v[112:115]
    v_mfma_f32_16x16x32_bf16 v[112:115], v[140:143], v[28:31], v[112:115]
    v_mfma_f32_16x16x32_bf16 v[116:119], v[136:139], v[32:35], 0
    v_mfma_f32_16x16x32_bf16 v[116:119], v[136:139], v[36:39], v[116:119]
    v_mfma_f32_16x16x32_bf16 v[116:119], v[136:139], v[40:43], v[116:119]
    v_mfma_f32_16x16x32_bf16 v[116:119], v[136:139], v[44:47], v[116:119]
    v_mfma_f32_16x16x32_bf16 v[116:119], v[140:143], v[48:51], v[116:119]
    v_mfma_f32_16x16x32_bf16 v[116:119], v[140:143], v[52:55], v[116:119]
    v_mfma_f32_16x16x32_bf16 v[116:119], v[140:143], v[56:59], v[116:119]
    v_mfma_f32_16x16x32_bf16 v[116:119], v[140:143], v[60:63], v[116:119]
    buffer_load_dword v150, v149, s[92:95], 0 offen sc1
    v_mfma_f32_16x16x32_bf16 v[120:123], v[136:139], v[64:67], 0
    v_mfma_f32_16x16x32_bf16 v[120:123], v[136:139], v[68:71], v[120:123]
    v_mfma_f32_16x16x32_bf16 v[120:123], v[136:139], v[72:75], v[120:123]
    v_mfma_f32_16x16x32_bf16 v[120:123], v[136:139], v[76:79], v[120:123]
    v_mfma_f32_16x16x32_bf16 v[120:123], v[140:143], v[80:83], v[120:123]
    v_mfma_f32_16x16x32_bf16 v[120:123], v[140:143], v[84:87], v[120:123]
    v_mfma_f32_16x16x32_bf16 v[120:123], v[140:143], v[88:91], v[120:123]
    v_mfma_f32_16x16x32_bf16 v[120:123], v[140:143], v[92:95], v[120:123]
    v_mfma_f32_16x16x32_bf16 v[124:127], v[136:139], v[96:99], 0
    v_mfma_f32_16x16x32_bf16 v[124:127], v[136:139], v[100:103], v[124:127]
    v_mfma_f32_16x16x32_bf16 v[124:127], v[136:139], v[104:107], v[124:127]
    v_mfma_f32_16x16x32_bf16 v[124:127], v[136:139], v[108:111], v[124:127]
    v_cvt_pk_bf16_f32 v128, v112, v113
    v_cvt_pk_bf16_f32 v129, v114, v115
    buffer_store_dwordx2 v[128:129], v145, s[96:99], s30 offen
    v_cvt_pk_bf16_f32 v130, v116, v117
    v_cvt_pk_bf16_f32 v131, v118, v119
    buffer_store_dwordx2 v[130:131], v146, s[96:99], s30 offen
    v_cvt_pk_bf16_f32 v132, v120, v121
    v_cvt_pk_bf16_f32 v133, v122, v123
    buffer_store_dwordx2 v[132:133], v147, s[96:99], s30 offen
    v_cvt_pk_bf16_f32 v134, v124, v125
    v_cvt_pk_bf16_f32 v135, v126, v127
    buffer_store_dwordx2 v[134:135], v148, s[96:99], s30 offen
    s_mov_b32 s69, 400000
    s_add_u32 s72, s90, 6
    s_waitcnt vmcnt(4)
    s_branch L_poll11c
L_poll11:
    buffer_load_dword v150, v149, s[92:95], 0 offen sc1
    s_sub_u32 s69, s69, 1
    s_cbranch_scc1 L_exit1
    s_waitcnt vmcnt(0)
L_poll11c:
    v_subrev_u32 v157, s72, v150
    v_cmp_lt_u32 vcc, 1, v157
    s_nop 1
    s_and_b64 s[24:25], vcc, s[20:21]
    s_cbranch_scc1 L_poll11
    s_barrier
    s_add_u32 s13, s9, 28672
    s_add_u32 s14, s10, 28672
    s_add_u32 s15, s11, 28672
    s_add_u32 s16, s12, 28672
    s_mov_b32 s69, 400000
    s_add_u32 s72, s90, 6
    s_branch L_poll12c
L_poll12:
    buffer_load_dword v150, v149, s[92:95], 0 offen sc1
    s_sub_u32 s69, s69, 1
    s_cbranch_scc1 L_exit1
    s_waitcnt vmcnt(0)
L_poll12c:
    v_subrev_u32 v157, s72, v150
    v_cmp_lt_u32 vcc, 1, v157
    s_nop 1
    s_and_b64 s[24:25], vcc, s[22:23]
    s_cbranch_scc1 L_poll12
    buffer_load_dwordx4 v[0:3], v144, s[56:59], s13 offen offset:0 sc1
    buffer_load_dwordx4 v[4:7], v144, s[56:59], s14 offen offset:0 sc1
    buffer_load_dwordx4 v[8:11], v144, s[56:59], s15 offen offset:0 sc1
    buffer_load_dwordx4 v[12:15], v144, s[56:59], s16 offen offset:0 sc1
    buffer_load_dwordx4 v[16:19], v144, s[56:59], s13 offen offset:256 sc1
    buffer_load_dwordx4 v[20:23], v144, s[56:59], s14 offen offset:256 sc1
    buffer_load_dwordx4 v[24:27], v144, s[56:59], s15 offen offset:256 sc1
    buffer_load_dwordx4 v[28:31], v144, s[56:59], s16 offen offset:256 sc1
    buffer_load_dwordx4 v[32:35], v144, s[56:59], s13 offen offset:512 sc1
    buffer_load_dwordx4 v[36:39], v144, s[56:59], s14 offen offset:512 sc1
    buffer_load_dwordx4 v[40:43], v144, s[56:59], s15 offen offset:512 sc1
    buffer_load_dwordx4 v[44:47], v144, s[56:59], s16 offen offset:512 sc1
    buffer_load_dwordx4 v[48:51], v144, s[56:59], s13 offen offset:768 sc1
    buffer_load_dwordx4 v[52:55], v144, s[56:59], s14 offen offset:768 sc1
    buffer_load_dwordx4 v[56:59], v144, s[56:59], s15 offen offset:768 sc1
    buffer_load_dwordx4 v[60:63], v144, s[56:59], s16 offen offset:768 sc1
    buffer_load_dwordx4 v[64:67], v144, s[56:59], s13 offen offset:1024 sc1
    buffer_load_dwordx4 v[68:71], v144, s[56:59], s14 offen offset:1024 sc1
    buffer_load_dwordx4 v[72:75], v144, s[56:59], s15 offen offset:1024 sc1
    buffer_load_dwordx4 v[76:79], v144, s[56:59], s16 offen offset:1024 sc1
    buffer_load_dwordx4 v[80:83], v144, s[56:59], s13 offen offset:1280 sc1
    buffer_load_dwordx4 v[84:87], v144, s[56:59], s14 offen offset:1280 sc1
    buffer_load_dwordx4 v[88:91], v144, s[56:59], s15 offen offset:1280 sc1
    buffer_load_dwordx4 v[92:95], v144, s[56:59], s16 offen offset:1280 sc1
    buffer_load_dwordx4 v[96:99], v144, s[56:59], s13 offen offset:1536 sc1
    buffer_load_dwordx4 v[100:103], v144, s[56:59], s14 offen offset:1536 sc1
    buffer_load_dwordx4 v[104:107], v144, s[56:59], s15 offen offset:1536 sc1
    buffer_load_dwordx4 v[108:111], v144, s[56:59], s16 offen offset:1536 sc1
    s_mov_b32 s30, 640
    s_waitcnt vmcnt(24)
    v_mfma_f32_16x16x32_bf16 v[112:115], v[136:139], v[0:3], 0
    v_mfma_f32_16x16x32_bf16 v[112:115], v[136:139], v[4:7], v[112:115]
    v_mfma_f32_16x16x32_bf16 v[112:115], v[136:139], v[8:11], v[112:115]
    v_mfma_f32_16x16x32_bf16 v[112:115], v[136:139], v[12:15], v[112:115]
    s_waitcnt vmcnt(20)
    v_mfma_f32_16x16x32_bf16 v[112:115], v[140:143], v[16:19], v[112:115]
    v_mfma_f32_16x16x32_bf16 v[112:115], v[140:143], v[20:23], v[112:115]
    v_mfma_f32_16x16x32_bf16 v[112:115], v[140:143], v[24:27], v[112:115]
    v_mfma_f32_16x16x32_bf16 v[112:115], v[140:143], v[28:31], v[112:115]
    s_nop 7
    v_cvt_pk_bf16_f32 v128, v112, v113
    v_cvt_pk_bf16_f32 v129, v114, v115
    buffer_store_dwordx2 v[128:129], v145, s[96:99], s30 offen
    s_waitcnt vmcnt(17)
    v_mfma_f32_16x16x32_bf16 v[116:119], v[136:139], v[32:35], 0
    v_mfma_f32_16x16x32_bf16 v[116:119], v[136:139], v[36:39], v[116:119]
    v_mfma_f32_16x16x32_bf16 v[116:119], v[136:139], v[40:43], v[116:119]
    v_mfma_f32_16x16x32_bf16 v[116:119], v[136:139], v[44:47], v[116:119]
    s_waitcnt vmcnt(13)
    v_mfma_f32_16x16x32_bf16 v[116:119], v[140:143], v[48:51], v[116:119]
    v_mfma_f32_16x16x32_bf16 v[116:119], v[140:143], v[52:55], v[116:119]
    v_mfma_f32_16x16x32_bf16 v[116:119], v[140:143], v[56:59], v[116:119]
    v_mfma_f32_16x16x32_bf16 v[116:119], v[140:143], v[60:63], v[116:119]
    s_nop 7
    v_cvt_pk_bf16_f32 v130, v116, v117
    v_cvt_pk_bf16_f32 v131, v118, v119
    buffer_store_dwordx2 v[130:131], v146, s[96:99], s30 offen
    s_waitcnt vmcnt(10)
    v_mfma_f32_16x16x32_bf16 v[120:123], v[136:139], v[64:67], 0
    v_mfma_f32_16x16x32_bf16 v[120:123], v[136:139], v[68:71], v[120:123]
    v_mfma_f32_16x16x32_bf16 v[120:123], v[136:139], v[72:75], v[120:123]
    v_mfma_f32_16x16x32_bf16 v[120:123], v[136:139], v[76:79], v[120:123]
    s_waitcnt vmcnt(6)
    v_mfma_f32_16x16x32_bf16 v[120:123], v[140:143], v[80:83], v[120:123]
    v_mfma_f32_16x16x32_bf16 v[120:123], v[140:143], v[84:87], v[120:123]
    v_mfma_f32_16x16x32_bf16 v[120:123], v[140:143], v[88:91], v[120:123]
    v_mfma_f32_16x16x32_bf16 v[120:123], v[140:143], v[92:95], v[120:123]
    s_nop 7
    v_cvt_pk_bf16_f32 v132, v120, v121
    v_cvt_pk_bf16_f32 v133, v122, v123
    buffer_store_dwordx2 v[132:133], v147, s[96:99], s30 offen
    s_waitcnt vmcnt(3)
    v_mfma_f32_16x16x32_bf16 v[124:127], v[136:139], v[96:99], 0
    v_mfma_f32_16x16x32_bf16 v[124:127], v[136:139], v[100:103], v[124:127]
    v_mfma_f32_16x16x32_bf16 v[124:127], v[136:139], v[104:107], v[124:127]
    v_mfma_f32_16x16x32_bf16 v[124:127], v[136:139], v[108:111], v[124:127]
    s_nop 7
    v_cvt_pk_bf16_f32 v134, v124, v125
    v_cvt_pk_bf16_f32 v135, v126, v127
    buffer_store_dwordx2 v[134:135], v148, s[96:99], s30 offen
    s_endpgm
L_exit1:
    s_endpgm
.section .rodata,"a"
.p2align 6
.amdhsa_kernel concat_heads__mha_block_cached__gqa_block_cached__near_ridge_kernel
  .amdhsa_next_free_vgpr 256
  .amdhsa_next_free_sgpr 100
  .amdhsa_accum_offset 256
  .amdhsa_group_segment_fixed_size 0
  .amdhsa_kernarg_size 104
  .amdhsa_user_sgpr_count 2
  .amdhsa_user_sgpr_kernarg_segment_ptr 1
  .amdhsa_system_sgpr_workgroup_id_x 1
.end_amdhsa_kernel
```
